```python
import torch

def _softmax(x, axis=-1):
    return torch.softmax(x, dim=axis)
def _gelu(x):
    return torch.nn.functional.gelu(x, approximate="tanh")
def _silu(x):
    return torch.nn.functional.silu(x)
def _sigmoid(x):
    return torch.sigmoid(x)
def _layernorm(x, axis=-1, eps=1e-5):
    m = x.mean(dim=axis, keepdim=True)
    v = x.var(dim=axis, keepdim=True, unbiased=False)
    return (x - m) / torch.sqrt(v + eps)
def _scatter_add(tgt, idx, src, axis=0):
    return tgt.clone().index_add_(axis, idx, src)
def _segment_sum(src, seg, n):
    out = torch.zeros((n,) + src.shape[1:], dtype=src.dtype)
    return out.index_add_(0, seg, src)
def _pad(x, pw):
    flat = tuple(v for pair in reversed(pw) for v in pair)
    return torch.nn.functional.pad(x, flat)

kernel_name = 'interleave_layers__spectral_gfnet__dense_activation_gelu__prompt'

def setup_inputs():

    _w = (lambda a: (lambda t: t.to(torch.bfloat16) if t.is_floating_point() else t)(torch.as_tensor(a)))
    def _A_setup():
        B, S, D = 1, 2048, 640
        Df = D // 2 + 1
        return {
            "x": _w((lambda *s: torch.randn(*s, dtype=torch.bfloat16) * 0.05)(B, S, D)),
            "w_r": _w((lambda *s: torch.randn(*s, dtype=torch.bfloat16) * 0.4)(S, Df) * 0.02),
            "w_i": _w((lambda *s: torch.randn(*s, dtype=torch.bfloat16) * 0.4)(S, Df) * 0.02),
        }
    _A_in = _A_setup()

    def _B_setup():
        B, S, D, F = 1, 2048, 640, 1728
        return {
            "x": _w((lambda *s: torch.randn(*s, dtype=torch.bfloat16) * 0.05)(B, S, D)),
            "w1": _w((lambda *s: torch.randn(*s, dtype=torch.bfloat16) * 0.4)(D, F) * (D ** -0.5)),
            "b1": _w((lambda *s: torch.randn(*s, dtype=torch.bfloat16) * 12.8)(F) * 0.01),
            "w2": _w((lambda *s: torch.randn(*s, dtype=torch.bfloat16) * 0.1)(F, D) * (F ** -0.5)),
            "b2": _w((lambda *s: torch.randn(*s, dtype=torch.bfloat16) * 0.8)(D) * 0.01),
        }
    _B_in = _B_setup()

    return {
        "A_x": _A_in["x"],
        "A_w_r": _A_in["w_r"],
        "A_w_i": _A_in["w_i"],
        "B_x": _B_in["x"],
        "B_w1": _B_in["w1"],
        "B_b1": _B_in["b1"],
        "B_w2": _B_in["w2"],
        "B_b2": _B_in["b2"],
    }

def reference(A_x, A_w_r, A_w_i, B_x, B_w1, B_b1, B_w2, B_b2):
    def _A_ref(x, w_r, w_i):
        B, S, D = x.shape
        X = (lambda x, axes=(-2,-1): torch.fft.rfft2(x.float(), dim=axes))(x, axes=(-2, -1))
        W = w_r + 1j * w_i
        X = X * W
        y = (lambda x, s, axes=(-2,-1): torch.fft.irfft2(x, s=s, dim=axes).to(torch.bfloat16))(X, (S, D), axes=(-2, -1))
        return y

    def _B_ref(x, w1, b1, w2, b2):
        h = torch.einsum("bsd,df->bsf", x, w1) + b1
        h = _gelu(h)
        return torch.einsum("bsf,fd->bsd", h, w2) + b2

    x = A_x
    x = x + _A_ref(_layernorm(x, axis=-1), A_w_r, A_w_i)
    x = x + _B_ref(_layernorm(x, axis=-1), B_w1, B_b1, B_w2, B_b2)
    x = x + _A_ref(_layernorm(x, axis=-1), A_w_r, A_w_i)
    x = x + _B_ref(_layernorm(x, axis=-1), B_w1, B_b1, B_w2, B_b2)
    return x
```

```asm
; @launch kernel=rf1_kernel grid=(988,1,1) block=(512,1,1) lds=20608
; @launch kernel=col1_kernel grid=(321,1,1) block=(256,1,1) lds=32768
; @launch kernel=ri1_kernel grid=(256,1,1) block=(512,1,1) lds=20608
; @launch kernel=g1a_kernel grid=(256,1,1) block=(256,1,1) lds=82944
; @launch kernel=g2a_kernel grid=(256,1,1) block=(256,1,1) lds=41472
; @launch kernel=rf2_kernel grid=(256,1,1) block=(512,1,1) lds=20608
; @launch kernel=col2_kernel grid=(321,1,1) block=(256,1,1) lds=32768
; @launch kernel=ri2_kernel grid=(256,1,1) block=(512,1,1) lds=20608
; @launch kernel=g1b_kernel grid=(256,1,1) block=(256,1,1) lds=82944
; @launch kernel=g2b_kernel grid=(256,1,1) block=(256,1,1) lds=41472
.amdgcn_target "amdgcn-amd-amdhsa--gfx950"
.text
.globl rf1_kernel
.p2align 8
.type rf1_kernel,@function
rf1_kernel:
    s_cmp_ge_u32 s2, 988
    s_cbranch_scc1 L_end_rf1_kernel
    s_load_dwordx16 s[4:19], s[0:1], 0
    s_load_dwordx4 s[20:23], s[0:1], 64
    s_load_dwordx2 s[24:25], s[0:1], 80
    s_waitcnt lgkmcnt(0)
    s_cmp_ge_u32 s2, 256
    s_cbranch_scc1 L_prep_rf1_kernel
    s_add_u32 s28, s4, 0x0
    s_addc_u32 s29, s5, 0
    s_mov_b32 s30, 0x280000
    s_mov_b32 s31, 0x00020000
    s_add_u32 s32, s24, 0x0
    s_addc_u32 s33, s25, 0
    s_mov_b32 s34, 0x504000
    s_mov_b32 s35, 0x00020000
    v_and_b32 v1, 63, v0
    v_lshrrev_b32 v2, 6, v0
    s_nop 1
    v_readfirstlane_b32 s26, v2
    s_nop 3
    s_lshl_b32 s27, s2, 3
    s_add_u32 s27, s27, s26
    s_mul_i32 s27, s27, 1280
    v_lshlrev_b32 v2, 2, v1
    buffer_load_dword v3, v2, s[28:31], s27 offen offset:0
    buffer_load_dword v4, v2, s[28:31], s27 offen offset:256
    buffer_load_dword v5, v2, s[28:31], s27 offen offset:512
    buffer_load_dword v6, v2, s[28:31], s27 offen offset:768
    buffer_load_dword v7, v2, s[28:31], s27 offen offset:1024
    s_waitcnt vmcnt(0)
    v_lshlrev_b32 v8, 16, v3
    v_and_b32 v3, 0xffff0000, v3
    v_lshlrev_b32 v9, 16, v4
    v_and_b32 v4, 0xffff0000, v4
    v_lshlrev_b32 v10, 16, v5
    v_and_b32 v5, 0xffff0000, v5
    v_lshlrev_b32 v11, 16, v6
    v_and_b32 v6, 0xffff0000, v6
    v_lshlrev_b32 v12, 16, v7
    v_and_b32 v7, 0xffff0000, v7
    v_add_f32 v13, v8, v3
    v_add_f32 v13, v13, v9
    v_add_f32 v13, v13, v4
    v_add_f32 v13, v13, v10
    v_add_f32 v13, v13, v5
    v_add_f32 v13, v13, v11
    v_add_f32 v13, v13, v6
    v_add_f32 v13, v13, v12
    v_add_f32 v13, v13, v7
    ds_swizzle_b32 v16, v13 offset:0x41f
    s_waitcnt lgkmcnt(0)
    v_add_f32 v13, v13, v16
    ds_swizzle_b32 v16, v13 offset:0x81f
    s_waitcnt lgkmcnt(0)
    v_add_f32 v13, v13, v16
    ds_swizzle_b32 v16, v13 offset:0x101f
    s_waitcnt lgkmcnt(0)
    v_add_f32 v13, v13, v16
    ds_swizzle_b32 v16, v13 offset:0x201f
    s_waitcnt lgkmcnt(0)
    v_add_f32 v13, v13, v16
    ds_swizzle_b32 v16, v13 offset:0x401f
    s_waitcnt lgkmcnt(0)
    v_add_f32 v13, v13, v16
    s_nop 1
    v_readlane_b32 s60, v13, 32
    s_nop 3
    v_add_f32 v13, s60, v13
    s_nop 1
    v_readlane_b32 s60, v13, 0
    s_nop 3
    v_mov_b32 v15, s60
    v_mul_f32 v15, 0x3acccccd, v15
    v_mov_b32 v13, 0
    v_sub_f32 v14, v8, v15
    v_fmac_f32 v13, v14, v14
    v_sub_f32 v14, v3, v15
    v_fmac_f32 v13, v14, v14
    v_sub_f32 v14, v9, v15
    v_fmac_f32 v13, v14, v14
    v_sub_f32 v14, v4, v15
    v_fmac_f32 v13, v14, v14
    v_sub_f32 v14, v10, v15
    v_fmac_f32 v13, v14, v14
    v_sub_f32 v14, v5, v15
    v_fmac_f32 v13, v14, v14
    v_sub_f32 v14, v11, v15
    v_fmac_f32 v13, v14, v14
    v_sub_f32 v14, v6, v15
    v_fmac_f32 v13, v14, v14
    v_sub_f32 v14, v12, v15
    v_fmac_f32 v13, v14, v14
    v_sub_f32 v14, v7, v15
    v_fmac_f32 v13, v14, v14
    ds_swizzle_b32 v16, v13 offset:0x41f
    s_waitcnt lgkmcnt(0)
    v_add_f32 v13, v13, v16
    ds_swizzle_b32 v16, v13 offset:0x81f
    s_waitcnt lgkmcnt(0)
    v_add_f32 v13, v13, v16
    ds_swizzle_b32 v16, v13 offset:0x101f
    s_waitcnt lgkmcnt(0)
    v_add_f32 v13, v13, v16
    ds_swizzle_b32 v16, v13 offset:0x201f
    s_waitcnt lgkmcnt(0)
    v_add_f32 v13, v13, v16
    ds_swizzle_b32 v16, v13 offset:0x401f
    s_waitcnt lgkmcnt(0)
    v_add_f32 v13, v13, v16
    s_nop 1
    v_readlane_b32 s60, v13, 32
    s_nop 3
    v_add_f32 v13, s60, v13
    s_nop 1
    v_readlane_b32 s60, v13, 0
    s_nop 3
    v_mov_b32 v13, s60
    v_mul_f32 v13, 0x3acccccd, v13
    v_cvt_pk_bf16_f32 v15, v15, v15
    v_lshlrev_b32 v15, 16, v15
    v_cvt_pk_bf16_f32 v13, v13, v13
    v_lshlrev_b32 v13, 16, v13
    v_add_f32 v13, 0x3727c5ac, v13
    v_cvt_pk_bf16_f32 v13, v13, v13
    v_lshlrev_b32 v13, 16, v13
    v_sqrt_f32 v13, v13
    s_nop 0
    v_cvt_pk_bf16_f32 v13, v13, v13
    v_lshlrev_b32 v13, 16, v13
    v_rcp_f32 v13, v13
    s_nop 0
    v_sub_f32 v8, v8, v15
    v_cvt_pk_bf16_f32 v8, v8, v8
    v_lshlrev_b32 v8, 16, v8
    v_mul_f32 v8, v8, v13
    v_cvt_pk_bf16_f32 v8, v8, v8
    v_lshlrev_b32 v8, 16, v8
    v_sub_f32 v3, v3, v15
    v_cvt_pk_bf16_f32 v3, v3, v3
    v_lshlrev_b32 v3, 16, v3
    v_mul_f32 v3, v3, v13
    v_cvt_pk_bf16_f32 v3, v3, v3
    v_lshlrev_b32 v3, 16, v3
    v_sub_f32 v9, v9, v15
    v_cvt_pk_bf16_f32 v9, v9, v9
    v_lshlrev_b32 v9, 16, v9
    v_mul_f32 v9, v9, v13
    v_cvt_pk_bf16_f32 v9, v9, v9
    v_lshlrev_b32 v9, 16, v9
    v_sub_f32 v4, v4, v15
    v_cvt_pk_bf16_f32 v4, v4, v4
    v_lshlrev_b32 v4, 16, v4
    v_mul_f32 v4, v4, v13
    v_cvt_pk_bf16_f32 v4, v4, v4
    v_lshlrev_b32 v4, 16, v4
    v_sub_f32 v10, v10, v15
    v_cvt_pk_bf16_f32 v10, v10, v10
    v_lshlrev_b32 v10, 16, v10
    v_mul_f32 v10, v10, v13
    v_cvt_pk_bf16_f32 v10, v10, v10
    v_lshlrev_b32 v10, 16, v10
    v_sub_f32 v5, v5, v15
    v_cvt_pk_bf16_f32 v5, v5, v5
    v_lshlrev_b32 v5, 16, v5
    v_mul_f32 v5, v5, v13
    v_cvt_pk_bf16_f32 v5, v5, v5
    v_lshlrev_b32 v5, 16, v5
    v_sub_f32 v11, v11, v15
    v_cvt_pk_bf16_f32 v11, v11, v11
    v_lshlrev_b32 v11, 16, v11
    v_mul_f32 v11, v11, v13
    v_cvt_pk_bf16_f32 v11, v11, v11
    v_lshlrev_b32 v11, 16, v11
    v_sub_f32 v6, v6, v15
    v_cvt_pk_bf16_f32 v6, v6, v6
    v_lshlrev_b32 v6, 16, v6
    v_mul_f32 v6, v6, v13
    v_cvt_pk_bf16_f32 v6, v6, v6
    v_lshlrev_b32 v6, 16, v6
    v_sub_f32 v12, v12, v15
    v_cvt_pk_bf16_f32 v12, v12, v12
    v_lshlrev_b32 v12, 16, v12
    v_mul_f32 v12, v12, v13
    v_cvt_pk_bf16_f32 v12, v12, v12
    v_lshlrev_b32 v12, 16, v12
    v_sub_f32 v7, v7, v15
    v_cvt_pk_bf16_f32 v7, v7, v7
    v_lshlrev_b32 v7, 16, v7
    v_mul_f32 v7, v7, v13
    v_cvt_pk_bf16_f32 v7, v7, v7
    v_lshlrev_b32 v7, 16, v7
    v_add_f32 v13, v9, v12
    v_add_f32 v14, v4, v7
    v_add_f32 v15, v10, v11
    v_add_f32 v16, v5, v6
    v_sub_f32 v17, v9, v12
    v_sub_f32 v18, v4, v7
    v_sub_f32 v19, v10, v11
    v_sub_f32 v20, v5, v6
    v_add_f32 v21, v8, v13
    v_add_f32 v22, v3, v14
    v_add_f32 v23, v21, v15
    v_add_f32 v24, v22, v16
    v_mov_b32 v21, v8
    v_fmac_f32 v21, 0x3e9e377a, v13
    v_fmac_f32 v21, 0xbf4f1bbd, v15
    v_mov_b32 v25, v8
    v_fmac_f32 v25, 0xbf4f1bbd, v13
    v_fmac_f32 v25, 0x3e9e377a, v15
    v_mul_f32 v27, 0x3f737871, v17
    v_fmac_f32 v27, 0x3f167918, v19
    v_mul_f32 v29, 0x3f167918, v17
    v_fmac_f32 v29, 0xbf737871, v19
    v_mov_b32 v22, v3
    v_fmac_f32 v22, 0x3e9e377a, v14
    v_fmac_f32 v22, 0xbf4f1bbd, v16
    v_mov_b32 v26, v3
    v_fmac_f32 v26, 0xbf4f1bbd, v14
    v_fmac_f32 v26, 0x3e9e377a, v16
    v_mul_f32 v28, 0x3f737871, v18
    v_fmac_f32 v28, 0x3f167918, v20
    v_mul_f32 v30, 0x3f167918, v18
    v_fmac_f32 v30, 0xbf737871, v20
    v_add_f32 v3, v21, v28
    v_sub_f32 v4, v22, v27
    v_sub_f32 v5, v21, v28
    v_add_f32 v6, v22, v27
    v_add_f32 v7, v25, v30
    v_sub_f32 v8, v26, v29
    v_sub_f32 v9, v25, v30
    v_add_f32 v10, v26, v29
    s_mul_i32 s27, s26, 2576
    v_mul_u32_u24 v11, 40, v1
    v_add_u32 v11, s27, v11
    v_mov_b32 v12, v23
    v_mov_b32 v13, v24
    ds_write_b64 v11, v[12:13] offset:0
    v_mov_b32 v12, v3
    v_mov_b32 v13, v4
    ds_write_b64 v11, v[12:13] offset:8
    v_mov_b32 v12, v7
    v_mov_b32 v13, v8
    ds_write_b64 v11, v[12:13] offset:16
    v_mov_b32 v12, v9
    v_mov_b32 v13, v10
    ds_write_b64 v11, v[12:13] offset:24
    v_mov_b32 v12, v5
    v_mov_b32 v13, v6
    ds_write_b64 v11, v[12:13] offset:32
    s_waitcnt lgkmcnt(0)
    s_mov_b64 s[40:41], exec
    s_mov_b32 s42, -1
    s_mov_b32 s43, 0xff
    s_mov_b64 exec, s[42:43]
    v_lshlrev_b32 v3, 3, v1
    v_add_u32 v3, s27, v3
    ds_read_b64 v[4:5], v3 offset:0
    ds_read_b64 v[6:7], v3 offset:320
    ds_read_b64 v[8:9], v3 offset:640
    ds_read_b64 v[12:13], v3 offset:960
    ds_read_b64 v[14:15], v3 offset:1280
    ds_read_b64 v[16:17], v3 offset:1600
    ds_read_b64 v[18:19], v3 offset:1920
    ds_read_b64 v[20:21], v3 offset:2240
    s_waitcnt lgkmcnt(0)
    v_mul_u32_u24 v10, 205, v1
    v_lshrrev_b32 v10, 10, v10
    v_mul_u32_u24 v22, 5, v10
    v_sub_u32 v22, v1, v22
    v_mul_u32_u24 v10, 40, v10
    v_add_u32 v10, v10, v22
    v_lshlrev_b32 v10, 3, v10
    v_add_u32 v10, s27, v10
    v_cvt_f32_u32 v22, v22
    v_mul_f32 v22, 0x3ccccccd, v22
    v_mul_f32 v23, 0x3f800000, v22
    v_cos_f32 v24, v23
    v_sin_f32 v25, v23
    s_nop 0
    v_mul_f32 v26, v6, v24
    v_fma_f32 v26, v7, v25, v26
    v_mul_f32 v27, v7, v24
    v_fma_f32 v27, -v6, v25, v27
    v_mul_f32 v6, 0x40000000, v22
    v_cos_f32 v7, v6
    v_sin_f32 v23, v6
    s_nop 0
    v_mul_f32 v24, v8, v7
    v_fma_f32 v24, v9, v23, v24
    v_mul_f32 v25, v9, v7
    v_fma_f32 v25, -v8, v23, v25
    v_mul_f32 v6, 0x40400000, v22
    v_cos_f32 v7, v6
    v_sin_f32 v8, v6
    s_nop 0
    v_mul_f32 v9, v12, v7
    v_fma_f32 v9, v13, v8, v9
    v_mul_f32 v23, v13, v7
    v_fma_f32 v23, -v12, v8, v23
    v_mul_f32 v6, 0x40800000, v22
    v_cos_f32 v7, v6
    v_sin_f32 v8, v6
    s_nop 0
    v_mul_f32 v12, v14, v7
    v_fma_f32 v12, v15, v8, v12
    v_mul_f32 v13, v15, v7
    v_fma_f32 v13, -v14, v8, v13
    v_mul_f32 v6, 0x40a00000, v22
    v_cos_f32 v7, v6
    v_sin_f32 v8, v6
    s_nop 0
    v_mul_f32 v14, v16, v7
    v_fma_f32 v14, v17, v8, v14
    v_mul_f32 v15, v17, v7
    v_fma_f32 v15, -v16, v8, v15
    v_mul_f32 v6, 0x40c00000, v22
    v_cos_f32 v7, v6
    v_sin_f32 v8, v6
    s_nop 0
    v_mul_f32 v16, v18, v7
    v_fma_f32 v16, v19, v8, v16
    v_mul_f32 v17, v19, v7
    v_fma_f32 v17, -v18, v8, v17
    v_mul_f32 v6, 0x40e00000, v22
    v_cos_f32 v7, v6
    v_sin_f32 v8, v6
    s_nop 0
    v_mul_f32 v18, v20, v7
    v_fma_f32 v18, v21, v8, v18
    v_mul_f32 v19, v21, v7
    v_fma_f32 v19, -v20, v8, v19
    v_add_f32 v6, v4, v12
    v_add_f32 v7, v5, v13
    v_sub_f32 v8, v4, v12
    v_sub_f32 v20, v5, v13
    v_add_f32 v21, v24, v16
    v_add_f32 v28, v25, v17
    v_sub_f32 v29, v24, v16
    v_sub_f32 v30, v25, v17
    v_add_f32 v4, v6, v21
    v_add_f32 v5, v7, v28
    v_sub_f32 v12, v6, v21
    v_sub_f32 v13, v7, v28
    v_add_f32 v16, v8, v30
    v_sub_f32 v17, v20, v29
    v_sub_f32 v24, v8, v30
    v_add_f32 v25, v20, v29
    v_add_f32 v6, v26, v14
    v_add_f32 v7, v27, v15
    v_sub_f32 v8, v26, v14
    v_sub_f32 v20, v27, v15
    v_add_f32 v21, v9, v18
    v_add_f32 v28, v23, v19
    v_sub_f32 v29, v9, v18
    v_sub_f32 v30, v23, v19
    v_add_f32 v9, v6, v21
    v_add_f32 v14, v7, v28
    v_sub_f32 v15, v6, v21
    v_sub_f32 v18, v7, v28
    v_add_f32 v19, v8, v30
    v_sub_f32 v23, v20, v29
    v_sub_f32 v26, v8, v30
    v_add_f32 v27, v20, v29
    v_add_f32 v6, v19, v23
    v_sub_f32 v7, v23, v19
    v_mul_f32 v6, 0x3f3504f3, v6
    v_mul_f32 v7, 0x3f3504f3, v7
    v_add_f32 v8, v26, v27
    v_sub_f32 v19, v27, v26
    v_mul_f32 v8, 0x3f3504f3, v8
    v_mul_f32 v19, 0x3f3504f3, v19
    v_add_f32 v20, v4, v9
    v_add_f32 v21, v5, v14
    v_sub_f32 v23, v4, v9
    v_sub_f32 v26, v5, v14
    v_add_f32 v27, v16, v6
    v_add_f32 v28, v17, v7
    v_sub_f32 v29, v16, v6
    v_sub_f32 v30, v17, v7
    v_add_f32 v31, v12, v18
    v_sub_f32 v32, v13, v15
    v_sub_f32 v33, v12, v18
    v_add_f32 v34, v13, v15
    v_add_f32 v35, v24, v19
    v_sub_f32 v36, v25, v8
    v_sub_f32 v37, v24, v19
    v_add_f32 v38, v25, v8
    v_mov_b32 v4, v20
    v_mov_b32 v5, v21
    ds_write_b64 v10, v[4:5] offset:0
    v_mov_b32 v4, v27
    v_mov_b32 v5, v28
    ds_write_b64 v10, v[4:5] offset:40
    v_mov_b32 v4, v31
    v_mov_b32 v5, v32
    ds_write_b64 v10, v[4:5] offset:80
    v_mov_b32 v4, v35
    v_mov_b32 v5, v36
    ds_write_b64 v10, v[4:5] offset:120
    v_mov_b32 v4, v23
    v_mov_b32 v5, v26
    ds_write_b64 v10, v[4:5] offset:160
    v_mov_b32 v4, v29
    v_mov_b32 v5, v30
    ds_write_b64 v10, v[4:5] offset:200
    v_mov_b32 v4, v33
    v_mov_b32 v5, v34
    ds_write_b64 v10, v[4:5] offset:240
    v_mov_b32 v4, v37
    v_mov_b32 v5, v38
    ds_write_b64 v10, v[4:5] offset:280
    s_waitcnt lgkmcnt(0)
    ds_read_b64 v[4:5], v3 offset:0
    ds_read_b64 v[6:7], v3 offset:320
    ds_read_b64 v[8:9], v3 offset:640
    ds_read_b64 v[12:13], v3 offset:960
    ds_read_b64 v[14:15], v3 offset:1280
    ds_read_b64 v[16:17], v3 offset:1600
    ds_read_b64 v[18:19], v3 offset:1920
    ds_read_b64 v[20:21], v3 offset:2240
    s_waitcnt lgkmcnt(0)
    v_mov_b32 v22, v1
    v_cvt_f32_u32 v22, v22
    v_mul_f32 v22, 0x3b4ccccd, v22
    v_mul_f32 v23, 0x3f800000, v22
    v_cos_f32 v24, v23
    v_sin_f32 v25, v23
    s_nop 0
    v_mul_f32 v26, v6, v24
    v_fma_f32 v26, v7, v25, v26
    v_mul_f32 v27, v7, v24
    v_fma_f32 v27, -v6, v25, v27
    v_mul_f32 v6, 0x40000000, v22
    v_cos_f32 v7, v6
    v_sin_f32 v23, v6
    s_nop 0
    v_mul_f32 v24, v8, v7
    v_fma_f32 v24, v9, v23, v24
    v_mul_f32 v25, v9, v7
    v_fma_f32 v25, -v8, v23, v25
    v_mul_f32 v6, 0x40400000, v22
    v_cos_f32 v7, v6
    v_sin_f32 v8, v6
    s_nop 0
    v_mul_f32 v9, v12, v7
    v_fma_f32 v9, v13, v8, v9
    v_mul_f32 v23, v13, v7
    v_fma_f32 v23, -v12, v8, v23
    v_mul_f32 v6, 0x40800000, v22
    v_cos_f32 v7, v6
    v_sin_f32 v8, v6
    s_nop 0
    v_mul_f32 v12, v14, v7
    v_fma_f32 v12, v15, v8, v12
    v_mul_f32 v13, v15, v7
    v_fma_f32 v13, -v14, v8, v13
    v_mul_f32 v6, 0x40a00000, v22
    v_cos_f32 v7, v6
    v_sin_f32 v8, v6
    s_nop 0
    v_mul_f32 v14, v16, v7
    v_fma_f32 v14, v17, v8, v14
    v_mul_f32 v15, v17, v7
    v_fma_f32 v15, -v16, v8, v15
    v_mul_f32 v6, 0x40c00000, v22
    v_cos_f32 v7, v6
    v_sin_f32 v8, v6
    s_nop 0
    v_mul_f32 v16, v18, v7
    v_fma_f32 v16, v19, v8, v16
    v_mul_f32 v17, v19, v7
    v_fma_f32 v17, -v18, v8, v17
    v_mul_f32 v6, 0x40e00000, v22
    v_cos_f32 v7, v6
    v_sin_f32 v8, v6
    s_nop 0
    v_mul_f32 v18, v20, v7
    v_fma_f32 v18, v21, v8, v18
    v_mul_f32 v19, v21, v7
    v_fma_f32 v19, -v20, v8, v19
    v_add_f32 v6, v4, v12
    v_add_f32 v7, v5, v13
    v_sub_f32 v8, v4, v12
    v_sub_f32 v20, v5, v13
    v_add_f32 v21, v24, v16
    v_add_f32 v28, v25, v17
    v_sub_f32 v29, v24, v16
    v_sub_f32 v30, v25, v17
    v_add_f32 v4, v6, v21
    v_add_f32 v5, v7, v28
    v_sub_f32 v12, v6, v21
    v_sub_f32 v13, v7, v28
    v_add_f32 v16, v8, v30
    v_sub_f32 v17, v20, v29
    v_sub_f32 v24, v8, v30
    v_add_f32 v25, v20, v29
    v_add_f32 v6, v26, v14
    v_add_f32 v7, v27, v15
    v_sub_f32 v8, v26, v14
    v_sub_f32 v20, v27, v15
    v_add_f32 v21, v9, v18
    v_add_f32 v28, v23, v19
    v_sub_f32 v29, v9, v18
    v_sub_f32 v30, v23, v19
    v_add_f32 v9, v6, v21
    v_add_f32 v14, v7, v28
    v_sub_f32 v15, v6, v21
    v_sub_f32 v18, v7, v28
    v_add_f32 v19, v8, v30
    v_sub_f32 v23, v20, v29
    v_sub_f32 v26, v8, v30
    v_add_f32 v27, v20, v29
    v_add_f32 v6, v19, v23
    v_sub_f32 v7, v23, v19
    v_mul_f32 v6, 0x3f3504f3, v6
    v_mul_f32 v7, 0x3f3504f3, v7
    v_add_f32 v8, v26, v27
    v_sub_f32 v19, v27, v26
    v_mul_f32 v8, 0x3f3504f3, v8
    v_mul_f32 v19, 0x3f3504f3, v19
    v_add_f32 v20, v4, v9
    v_add_f32 v21, v5, v14
    v_sub_f32 v23, v4, v9
    v_sub_f32 v26, v5, v14
    v_add_f32 v27, v16, v6
    v_add_f32 v28, v17, v7
    v_sub_f32 v29, v16, v6
    v_sub_f32 v30, v17, v7
    v_add_f32 v31, v12, v18
    v_sub_f32 v32, v13, v15
    v_sub_f32 v33, v12, v18
    v_add_f32 v34, v13, v15
    v_add_f32 v35, v24, v19
    v_sub_f32 v36, v25, v8
    v_sub_f32 v37, v24, v19
    v_add_f32 v38, v25, v8
    v_mov_b32 v4, v20
    v_mov_b32 v5, v21
    ds_write_b64 v3, v[4:5] offset:0
    v_mov_b32 v4, v27
    v_mov_b32 v5, v28
    ds_write_b64 v3, v[4:5] offset:320
    v_mov_b32 v4, v31
    v_mov_b32 v5, v32
    ds_write_b64 v3, v[4:5] offset:640
    v_mov_b32 v4, v35
    v_mov_b32 v5, v36
    ds_write_b64 v3, v[4:5] offset:960
    v_mov_b32 v4, v23
    v_mov_b32 v5, v26
    ds_write_b64 v3, v[4:5] offset:1280
    v_mov_b32 v4, v29
    v_mov_b32 v5, v30
    ds_write_b64 v3, v[4:5] offset:1600
    v_mov_b32 v4, v33
    v_mov_b32 v5, v34
    ds_write_b64 v3, v[4:5] offset:1920
    v_mov_b32 v4, v37
    v_mov_b32 v5, v38
    ds_write_b64 v3, v[4:5] offset:2240
    s_mov_b64 exec, s[40:41]
    s_waitcnt lgkmcnt(0)
    s_barrier
    v_and_b32 v4, 7, v0
    v_lshrrev_b32 v5, 3, v0
    v_mul_u32_u24 v6, 2576, v4
    s_lshl_b32 s27, s2, 3
    v_add_u32 v4, s27, v4
    v_add_u32 v7, 0, v5
    v_cmp_eq_u32 vcc, 320, v7
    v_cndmask_b32 v8, v7, 0, vcc
    v_sub_u32 v9, 320, v7
    v_cmp_eq_u32 vcc, 0, v7
    v_cndmask_b32 v9, v9, 0, vcc
    v_lshlrev_b32 v8, 3, v8
    v_add_u32 v8, v8, v6
    v_lshlrev_b32 v9, 3, v9
    v_add_u32 v9, v9, v6
    ds_read_b64 v[12:13], v8 offset:0
    s_waitcnt lgkmcnt(0)
    ds_read_b64 v[14:15], v9 offset:0
    s_waitcnt lgkmcnt(0)
    v_add_f32 v16, v12, v14
    v_sub_f32 v17, v13, v15
    v_sub_f32 v18, v12, v14
    v_add_f32 v19, v13, v15
    v_mov_b32 v8, v7
    v_cvt_f32_u32 v8, v8
    v_mul_f32 v8, 0x3acccccd, v8
    v_cos_f32 v20, v8
    v_sin_f32 v21, v8
    s_nop 0
    v_fma_f32 v24, -v21, v18, v16
    v_fma_f32 v24, v20, v19, v24
    v_fma_f32 v25, -v21, v19, v17
    v_fma_f32 v25, -v20, v18, v25
    v_mul_f32 v24, 0.5, v24
    v_mul_f32 v25, 0.5, v25
    v_lshlrev_b32 v7, 11, v7
    v_add_u32 v7, v7, v4
    v_lshlrev_b32 v7, 3, v7
    buffer_store_dwordx2 v[24:25], v7, s[32:35], 0 offen
    s_nop 1
    v_add_u32 v7, 64, v5
    v_cmp_eq_u32 vcc, 320, v7
    v_cndmask_b32 v8, v7, 0, vcc
    v_sub_u32 v9, 320, v7
    v_cmp_eq_u32 vcc, 0, v7
    v_cndmask_b32 v9, v9, 0, vcc
    v_lshlrev_b32 v8, 3, v8
    v_add_u32 v8, v8, v6
    v_lshlrev_b32 v9, 3, v9
    v_add_u32 v9, v9, v6
    ds_read_b64 v[12:13], v8 offset:0
    s_waitcnt lgkmcnt(0)
    ds_read_b64 v[14:15], v9 offset:0
    s_waitcnt lgkmcnt(0)
    v_add_f32 v16, v12, v14
    v_sub_f32 v17, v13, v15
    v_sub_f32 v18, v12, v14
    v_add_f32 v19, v13, v15
    v_mov_b32 v8, v7
    v_cvt_f32_u32 v8, v8
    v_mul_f32 v8, 0x3acccccd, v8
    v_cos_f32 v20, v8
    v_sin_f32 v21, v8
    s_nop 0
    v_fma_f32 v24, -v21, v18, v16
    v_fma_f32 v24, v20, v19, v24
    v_fma_f32 v25, -v21, v19, v17
    v_fma_f32 v25, -v20, v18, v25
    v_mul_f32 v24, 0.5, v24
    v_mul_f32 v25, 0.5, v25
    v_lshlrev_b32 v7, 11, v7
    v_add_u32 v7, v7, v4
    v_lshlrev_b32 v7, 3, v7
    buffer_store_dwordx2 v[24:25], v7, s[32:35], 0 offen
    s_nop 1
    v_add_u32 v7, 128, v5
    v_cmp_eq_u32 vcc, 320, v7
    v_cndmask_b32 v8, v7, 0, vcc
    v_sub_u32 v9, 320, v7
    v_cmp_eq_u32 vcc, 0, v7
    v_cndmask_b32 v9, v9, 0, vcc
    v_lshlrev_b32 v8, 3, v8
    v_add_u32 v8, v8, v6
    v_lshlrev_b32 v9, 3, v9
    v_add_u32 v9, v9, v6
    ds_read_b64 v[12:13], v8 offset:0
    s_waitcnt lgkmcnt(0)
    ds_read_b64 v[14:15], v9 offset:0
    s_waitcnt lgkmcnt(0)
    v_add_f32 v16, v12, v14
    v_sub_f32 v17, v13, v15
    v_sub_f32 v18, v12, v14
    v_add_f32 v19, v13, v15
    v_mov_b32 v8, v7
    v_cvt_f32_u32 v8, v8
    v_mul_f32 v8, 0x3acccccd, v8
    v_cos_f32 v20, v8
    v_sin_f32 v21, v8
    s_nop 0
    v_fma_f32 v24, -v21, v18, v16
    v_fma_f32 v24, v20, v19, v24
    v_fma_f32 v25, -v21, v19, v17
    v_fma_f32 v25, -v20, v18, v25
    v_mul_f32 v24, 0.5, v24
    v_mul_f32 v25, 0.5, v25
    v_lshlrev_b32 v7, 11, v7
    v_add_u32 v7, v7, v4
    v_lshlrev_b32 v7, 3, v7
    buffer_store_dwordx2 v[24:25], v7, s[32:35], 0 offen
    s_nop 1
    v_add_u32 v7, 192, v5
    v_cmp_eq_u32 vcc, 320, v7
    v_cndmask_b32 v8, v7, 0, vcc
    v_sub_u32 v9, 320, v7
    v_cmp_eq_u32 vcc, 0, v7
    v_cndmask_b32 v9, v9, 0, vcc
    v_lshlrev_b32 v8, 3, v8
    v_add_u32 v8, v8, v6
    v_lshlrev_b32 v9, 3, v9
    v_add_u32 v9, v9, v6
    ds_read_b64 v[12:13], v8 offset:0
    s_waitcnt lgkmcnt(0)
    ds_read_b64 v[14:15], v9 offset:0
    s_waitcnt lgkmcnt(0)
    v_add_f32 v16, v12, v14
    v_sub_f32 v17, v13, v15
    v_sub_f32 v18, v12, v14
    v_add_f32 v19, v13, v15
    v_mov_b32 v8, v7
    v_cvt_f32_u32 v8, v8
    v_mul_f32 v8, 0x3acccccd, v8
    v_cos_f32 v20, v8
    v_sin_f32 v21, v8
    s_nop 0
    v_fma_f32 v24, -v21, v18, v16
    v_fma_f32 v24, v20, v19, v24
    v_fma_f32 v25, -v21, v19, v17
    v_fma_f32 v25, -v20, v18, v25
    v_mul_f32 v24, 0.5, v24
    v_mul_f32 v25, 0.5, v25
    v_lshlrev_b32 v7, 11, v7
    v_add_u32 v7, v7, v4
    v_lshlrev_b32 v7, 3, v7
    buffer_store_dwordx2 v[24:25], v7, s[32:35], 0 offen
    s_nop 1
    v_add_u32 v7, 256, v5
    v_cmp_eq_u32 vcc, 320, v7
    v_cndmask_b32 v8, v7, 0, vcc
    v_sub_u32 v9, 320, v7
    v_cmp_eq_u32 vcc, 0, v7
    v_cndmask_b32 v9, v9, 0, vcc
    v_lshlrev_b32 v8, 3, v8
    v_add_u32 v8, v8, v6
    v_lshlrev_b32 v9, 3, v9
    v_add_u32 v9, v9, v6
    ds_read_b64 v[12:13], v8 offset:0
    s_waitcnt lgkmcnt(0)
    ds_read_b64 v[14:15], v9 offset:0
    s_waitcnt lgkmcnt(0)
    v_add_f32 v16, v12, v14
    v_sub_f32 v17, v13, v15
    v_sub_f32 v18, v12, v14
    v_add_f32 v19, v13, v15
    v_mov_b32 v8, v7
    v_cvt_f32_u32 v8, v8
    v_mul_f32 v8, 0x3acccccd, v8
    v_cos_f32 v20, v8
    v_sin_f32 v21, v8
    s_nop 0
    v_fma_f32 v24, -v21, v18, v16
    v_fma_f32 v24, v20, v19, v24
    v_fma_f32 v25, -v21, v19, v17
    v_fma_f32 v25, -v20, v18, v25
    v_mul_f32 v24, 0.5, v24
    v_mul_f32 v25, 0.5, v25
    v_lshlrev_b32 v7, 11, v7
    v_add_u32 v7, v7, v4
    v_lshlrev_b32 v7, 3, v7
    buffer_store_dwordx2 v[24:25], v7, s[32:35], 0 offen
    s_nop 1
    v_add_u32 v7, 320, v5
    v_cmp_eq_u32 vcc, 320, v7
    s_and_saveexec_b64 s[40:41], vcc
    v_cmp_eq_u32 vcc, 320, v7
    v_cndmask_b32 v8, v7, 0, vcc
    v_sub_u32 v9, 320, v7
    v_cmp_eq_u32 vcc, 0, v7
    v_cndmask_b32 v9, v9, 0, vcc
    v_lshlrev_b32 v8, 3, v8
    v_add_u32 v8, v8, v6
    v_lshlrev_b32 v9, 3, v9
    v_add_u32 v9, v9, v6
    ds_read_b64 v[12:13], v8 offset:0
    s_waitcnt lgkmcnt(0)
    ds_read_b64 v[14:15], v9 offset:0
    s_waitcnt lgkmcnt(0)
    v_add_f32 v16, v12, v14
    v_sub_f32 v17, v13, v15
    v_sub_f32 v18, v12, v14
    v_add_f32 v19, v13, v15
    v_mov_b32 v8, v7
    v_cvt_f32_u32 v8, v8
    v_mul_f32 v8, 0x3acccccd, v8
    v_cos_f32 v20, v8
    v_sin_f32 v21, v8
    s_nop 0
    v_fma_f32 v24, -v21, v18, v16
    v_fma_f32 v24, v20, v19, v24
    v_fma_f32 v25, -v21, v19, v17
    v_fma_f32 v25, -v20, v18, v25
    v_mul_f32 v24, 0.5, v24
    v_mul_f32 v25, 0.5, v25
    v_lshlrev_b32 v7, 11, v7
    v_add_u32 v7, v7, v4
    v_lshlrev_b32 v7, 3, v7
    buffer_store_dwordx2 v[24:25], v7, s[32:35], 0 offen
    s_nop 1
    s_endpgm
L_prep_rf1_kernel:
    v_lshrrev_b32 v1, 8, v0
    s_nop 1
    v_readfirstlane_b32 s26, v1
    s_nop 3
    s_cmp_ge_u32 s26, 1
    s_cbranch_scc1 L_end_rf1_kernel
    s_sub_u32 s2, s2, 256
    v_lshrrev_b32 v1, 5, v0
    v_and_b32 v2, 31, v0
    s_cmp_ge_u32 s2, 540
    s_cbranch_scc1 L_W_rf1_kernelp
    s_cmp_ge_u32 s2, 270
    s_cbranch_scc1 L_w2_rf1_kernelp
    s_add_u32 s28, s12, 0x0
    s_addc_u32 s29, s13, 0
    s_mov_b32 s30, 0x21c000
    s_mov_b32 s31, 0x00020000
    s_add_u32 s32, s24, 0x900000
    s_addc_u32 s33, s25, 0
    s_mov_b32 s34, 0x21c000
    s_mov_b32 s35, 0x00020000
    s_sub_u32 s27, s2, 0
    s_mov_b32 s40, 0x1999999a
    s_mul_hi_u32 s41, s27, s40
    s_mul_i32 s42, s41, 10
    s_sub_u32 s42, s27, s42
    s_mul_i32 s43, s42, 221184
    s_lshl_b32 s44, s41, 7
    s_add_u32 s43, s43, s44
    s_mul_i32 s45, s41, 81920
    s_lshl_b32 s44, s42, 7
    s_add_u32 s45, s45, s44
    s_mov_b32 s40, 3456
    v_mul_lo_u32 v3, s40, v1
    v_lshlrev_b32 v21, 2, v2
    v_add_u32 v3, v3, v21
    v_mul_u32_u24 v4, 132, v1
    v_add_u32 v4, v4, v21
    s_add_u32 s46, s43, 0
    buffer_load_dword v5, v3, s[28:31], s46 offen
    s_add_u32 s46, s43, 27648
    buffer_load_dword v6, v3, s[28:31], s46 offen
    s_add_u32 s46, s43, 55296
    buffer_load_dword v7, v3, s[28:31], s46 offen
    s_add_u32 s46, s43, 82944
    buffer_load_dword v8, v3, s[28:31], s46 offen
    s_add_u32 s46, s43, 110592
    buffer_load_dword v9, v3, s[28:31], s46 offen
    s_add_u32 s46, s43, 138240
    buffer_load_dword v10, v3, s[28:31], s46 offen
    s_add_u32 s46, s43, 165888
    buffer_load_dword v11, v3, s[28:31], s46 offen
    s_add_u32 s46, s43, 193536
    buffer_load_dword v12, v3, s[28:31], s46 offen
    s_waitcnt vmcnt(0)
    ds_write_b32 v4, v5 offset:0
    ds_write_b32 v4, v6 offset:1056
    ds_write_b32 v4, v7 offset:2112
    ds_write_b32 v4, v8 offset:3168
    ds_write_b32 v4, v9 offset:4224
    ds_write_b32 v4, v10 offset:5280
    ds_write_b32 v4, v11 offset:6336
    ds_write_b32 v4, v12 offset:7392
    s_waitcnt lgkmcnt(0)
    s_barrier
    v_mul_u32_u24 v4, 264, v2
    v_lshlrev_b32 v3, 1, v1
    v_add_u32 v4, v4, v3
    ds_read_u16 v5, v4 offset:0
    ds_read_u16 v13, v4 offset:132
    ds_read_u16 v6, v4 offset:16
    ds_read_u16 v14, v4 offset:148
    ds_read_u16 v7, v4 offset:32
    ds_read_u16 v15, v4 offset:164
    ds_read_u16 v8, v4 offset:48
    ds_read_u16 v16, v4 offset:180
    ds_read_u16 v9, v4 offset:64
    ds_read_u16 v17, v4 offset:196
    ds_read_u16 v10, v4 offset:80
    ds_read_u16 v18, v4 offset:212
    ds_read_u16 v11, v4 offset:96
    ds_read_u16 v19, v4 offset:228
    ds_read_u16 v12, v4 offset:112
    ds_read_u16 v20, v4 offset:244
    s_mov_b32 s40, 1280
    v_mul_lo_u32 v3, s40, v1
    v_add_u32 v3, v3, v21
    s_waitcnt lgkmcnt(0)
    v_lshl_or_b32 v5, v13, 16, v5
    s_add_u32 s46, s45, 0
    buffer_store_dword v5, v3, s[32:35], s46 offen
    v_lshl_or_b32 v6, v14, 16, v6
    s_add_u32 s46, s45, 10240
    buffer_store_dword v6, v3, s[32:35], s46 offen
    v_lshl_or_b32 v7, v15, 16, v7
    s_add_u32 s46, s45, 20480
    buffer_store_dword v7, v3, s[32:35], s46 offen
    v_lshl_or_b32 v8, v16, 16, v8
    s_add_u32 s46, s45, 30720
    buffer_store_dword v8, v3, s[32:35], s46 offen
    v_lshl_or_b32 v9, v17, 16, v9
    s_add_u32 s46, s45, 40960
    buffer_store_dword v9, v3, s[32:35], s46 offen
    v_lshl_or_b32 v10, v18, 16, v10
    s_add_u32 s46, s45, 51200
    buffer_store_dword v10, v3, s[32:35], s46 offen
    v_lshl_or_b32 v11, v19, 16, v11
    s_add_u32 s46, s45, 61440
    buffer_store_dword v11, v3, s[32:35], s46 offen
    v_lshl_or_b32 v12, v20, 16, v12
    s_add_u32 s46, s45, 71680
    buffer_store_dword v12, v3, s[32:35], s46 offen
    s_endpgm
L_w2_rf1_kernelp:
    s_add_u32 s28, s16, 0x0
    s_addc_u32 s29, s17, 0
    s_mov_b32 s30, 0x21c000
    s_mov_b32 s31, 0x00020000
    s_add_u32 s32, s24, 0xc00000
    s_addc_u32 s33, s25, 0
    s_mov_b32 s34, 0x21c000
    s_mov_b32 s35, 0x00020000
    s_sub_u32 s27, s2, 270
    s_mov_b32 s40, 0x97b425f
    s_mul_hi_u32 s41, s27, s40
    s_mul_i32 s42, s41, 27
    s_sub_u32 s42, s27, s42
    s_mul_i32 s43, s42, 81920
    s_lshl_b32 s44, s41, 7
    s_add_u32 s43, s43, s44
    s_mul_i32 s45, s41, 221184
    s_lshl_b32 s44, s42, 7
    s_add_u32 s45, s45, s44
    s_mov_b32 s40, 1280
    v_mul_lo_u32 v3, s40, v1
    v_lshlrev_b32 v21, 2, v2
    v_add_u32 v3, v3, v21
    v_mul_u32_u24 v4, 132, v1
    v_add_u32 v4, v4, v21
    s_add_u32 s46, s43, 0
    buffer_load_dword v5, v3, s[28:31], s46 offen
    s_add_u32 s46, s43, 10240
    buffer_load_dword v6, v3, s[28:31], s46 offen
    s_add_u32 s46, s43, 20480
    buffer_load_dword v7, v3, s[28:31], s46 offen
    s_add_u32 s46, s43, 30720
    buffer_load_dword v8, v3, s[28:31], s46 offen
    s_add_u32 s46, s43, 40960
    buffer_load_dword v9, v3, s[28:31], s46 offen
    s_add_u32 s46, s43, 51200
    buffer_load_dword v10, v3, s[28:31], s46 offen
    s_add_u32 s46, s43, 61440
    buffer_load_dword v11, v3, s[28:31], s46 offen
    s_add_u32 s46, s43, 71680
    buffer_load_dword v12, v3, s[28:31], s46 offen
    s_waitcnt vmcnt(0)
    ds_write_b32 v4, v5 offset:0
    ds_write_b32 v4, v6 offset:1056
    ds_write_b32 v4, v7 offset:2112
    ds_write_b32 v4, v8 offset:3168
    ds_write_b32 v4, v9 offset:4224
    ds_write_b32 v4, v10 offset:5280
    ds_write_b32 v4, v11 offset:6336
    ds_write_b32 v4, v12 offset:7392
    s_waitcnt lgkmcnt(0)
    s_barrier
    v_mul_u32_u24 v4, 264, v2
    v_lshlrev_b32 v3, 1, v1
    v_add_u32 v4, v4, v3
    ds_read_u16 v5, v4 offset:0
    ds_read_u16 v13, v4 offset:132
    ds_read_u16 v6, v4 offset:16
    ds_read_u16 v14, v4 offset:148
    ds_read_u16 v7, v4 offset:32
    ds_read_u16 v15, v4 offset:164
    ds_read_u16 v8, v4 offset:48
    ds_read_u16 v16, v4 offset:180
    ds_read_u16 v9, v4 offset:64
    ds_read_u16 v17, v4 offset:196
    ds_read_u16 v10, v4 offset:80
    ds_read_u16 v18, v4 offset:212
    ds_read_u16 v11, v4 offset:96
    ds_read_u16 v19, v4 offset:228
    ds_read_u16 v12, v4 offset:112
    ds_read_u16 v20, v4 offset:244
    s_mov_b32 s40, 3456
    v_mul_lo_u32 v3, s40, v1
    v_add_u32 v3, v3, v21
    s_waitcnt lgkmcnt(0)
    v_lshl_or_b32 v5, v13, 16, v5
    s_add_u32 s46, s45, 0
    buffer_store_dword v5, v3, s[32:35], s46 offen
    v_lshl_or_b32 v6, v14, 16, v6
    s_add_u32 s46, s45, 27648
    buffer_store_dword v6, v3, s[32:35], s46 offen
    v_lshl_or_b32 v7, v15, 16, v7
    s_add_u32 s46, s45, 55296
    buffer_store_dword v7, v3, s[32:35], s46 offen
    v_lshl_or_b32 v8, v16, 16, v8
    s_add_u32 s46, s45, 82944
    buffer_store_dword v8, v3, s[32:35], s46 offen
    v_lshl_or_b32 v9, v17, 16, v9
    s_add_u32 s46, s45, 110592
    buffer_store_dword v9, v3, s[32:35], s46 offen
    v_lshl_or_b32 v10, v18, 16, v10
    s_add_u32 s46, s45, 138240
    buffer_store_dword v10, v3, s[32:35], s46 offen
    v_lshl_or_b32 v11, v19, 16, v11
    s_add_u32 s46, s45, 165888
    buffer_store_dword v11, v3, s[32:35], s46 offen
    v_lshl_or_b32 v12, v20, 16, v12
    s_add_u32 s46, s45, 193536
    buffer_store_dword v12, v3, s[32:35], s46 offen
    s_endpgm
L_W_rf1_kernelp:
    s_add_u32 s28, s6, 0x0
    s_addc_u32 s29, s7, 0
    s_mov_b32 s30, 0x141000
    s_mov_b32 s31, 0x00020000
    s_add_u32 s36, s8, 0x0
    s_addc_u32 s37, s9, 0
    s_mov_b32 s38, 0x141000
    s_mov_b32 s39, 0x00020000
    s_add_u32 s32, s24, 0x600000
    s_addc_u32 s33, s25, 0
    s_mov_b32 s34, 0x282000
    s_mov_b32 s35, 0x00020000
    s_sub_u32 s27, s2, 540
    s_and_b32 s41, s27, 31
    s_lshr_b32 s42, s27, 5
    v_lshrrev_b32 v1, 6, v0
    v_and_b32 v2, 63, v0
    s_mul_i32 s43, s41, 41088
    s_lshl_b32 s44, s42, 7
    s_add_u32 s43, s43, s44
    v_mul_u32_u24 v3, 642, v1
    v_lshlrev_b32 v21, 1, v2
    v_add_u32 v3, v3, v21
    v_mul_u32_u24 v4, 260, v1
    v_lshlrev_b32 v21, 2, v2
    v_add_u32 v4, v4, v21
    s_add_u32 s46, s43, 0
    buffer_load_ushort v5, v3, s[28:31], s46 offen
    buffer_load_ushort v13, v3, s[36:39], s46 offen
    s_add_u32 s46, s43, 2568
    buffer_load_ushort v6, v3, s[28:31], s46 offen
    buffer_load_ushort v14, v3, s[36:39], s46 offen
    s_add_u32 s46, s43, 5136
    buffer_load_ushort v7, v3, s[28:31], s46 offen
    buffer_load_ushort v15, v3, s[36:39], s46 offen
    s_add_u32 s46, s43, 7704
    buffer_load_ushort v8, v3, s[28:31], s46 offen
    buffer_load_ushort v16, v3, s[36:39], s46 offen
    s_add_u32 s46, s43, 10272
    buffer_load_ushort v9, v3, s[28:31], s46 offen
    buffer_load_ushort v17, v3, s[36:39], s46 offen
    s_add_u32 s46, s43, 12840
    buffer_load_ushort v10, v3, s[28:31], s46 offen
    buffer_load_ushort v18, v3, s[36:39], s46 offen
    s_add_u32 s46, s43, 15408
    buffer_load_ushort v11, v3, s[28:31], s46 offen
    buffer_load_ushort v19, v3, s[36:39], s46 offen
    s_add_u32 s46, s43, 17976
    buffer_load_ushort v12, v3, s[28:31], s46 offen
    buffer_load_ushort v20, v3, s[36:39], s46 offen
    s_waitcnt vmcnt(0)
    v_lshl_or_b32 v5, v13, 16, v5
    ds_write_b32 v4, v5 offset:0
    v_lshl_or_b32 v6, v14, 16, v6
    ds_write_b32 v4, v6 offset:1040
    v_lshl_or_b32 v7, v15, 16, v7
    ds_write_b32 v4, v7 offset:2080
    v_lshl_or_b32 v8, v16, 16, v8
    ds_write_b32 v4, v8 offset:3120
    v_lshl_or_b32 v9, v17, 16, v9
    ds_write_b32 v4, v9 offset:4160
    v_lshl_or_b32 v10, v18, 16, v10
    ds_write_b32 v4, v10 offset:5200
    v_lshl_or_b32 v11, v19, 16, v11
    ds_write_b32 v4, v11 offset:6240
    v_lshl_or_b32 v12, v20, 16, v12
    ds_write_b32 v4, v12 offset:7280
    s_add_u32 s46, s43, 20544
    buffer_load_ushort v5, v3, s[28:31], s46 offen
    buffer_load_ushort v13, v3, s[36:39], s46 offen
    s_add_u32 s46, s43, 23112
    buffer_load_ushort v6, v3, s[28:31], s46 offen
    buffer_load_ushort v14, v3, s[36:39], s46 offen
    s_add_u32 s46, s43, 25680
    buffer_load_ushort v7, v3, s[28:31], s46 offen
    buffer_load_ushort v15, v3, s[36:39], s46 offen
    s_add_u32 s46, s43, 28248
    buffer_load_ushort v8, v3, s[28:31], s46 offen
    buffer_load_ushort v16, v3, s[36:39], s46 offen
    s_add_u32 s46, s43, 30816
    buffer_load_ushort v9, v3, s[28:31], s46 offen
    buffer_load_ushort v17, v3, s[36:39], s46 offen
    s_add_u32 s46, s43, 33384
    buffer_load_ushort v10, v3, s[28:31], s46 offen
    buffer_load_ushort v18, v3, s[36:39], s46 offen
    s_add_u32 s46, s43, 35952
    buffer_load_ushort v11, v3, s[28:31], s46 offen
    buffer_load_ushort v19, v3, s[36:39], s46 offen
    s_add_u32 s46, s43, 38520
    buffer_load_ushort v12, v3, s[28:31], s46 offen
    buffer_load_ushort v20, v3, s[36:39], s46 offen
    s_waitcnt vmcnt(0)
    v_lshl_or_b32 v5, v13, 16, v5
    ds_write_b32 v4, v5 offset:8320
    v_lshl_or_b32 v6, v14, 16, v6
    ds_write_b32 v4, v6 offset:9360
    v_lshl_or_b32 v7, v15, 16, v7
    ds_write_b32 v4, v7 offset:10400
    v_lshl_or_b32 v8, v16, 16, v8
    ds_write_b32 v4, v8 offset:11440
    v_lshl_or_b32 v9, v17, 16, v9
    ds_write_b32 v4, v9 offset:12480
    v_lshl_or_b32 v10, v18, 16, v10
    ds_write_b32 v4, v10 offset:13520
    v_lshl_or_b32 v11, v19, 16, v11
    ds_write_b32 v4, v11 offset:14560
    v_lshl_or_b32 v12, v20, 16, v12
    ds_write_b32 v4, v12 offset:15600
    s_waitcnt lgkmcnt(0)
    s_barrier
    v_mul_u32_u24 v4, 260, v2
    v_lshlrev_b32 v21, 2, v1
    v_add_u32 v4, v4, v21
    ds_read_b32 v5, v4 offset:0
    ds_read_b32 v6, v4 offset:16
    ds_read_b32 v7, v4 offset:32
    ds_read_b32 v8, v4 offset:48
    ds_read_b32 v9, v4 offset:64
    ds_read_b32 v10, v4 offset:80
    ds_read_b32 v11, v4 offset:96
    ds_read_b32 v12, v4 offset:112
    ds_read_b32 v13, v4 offset:128
    ds_read_b32 v14, v4 offset:144
    ds_read_b32 v15, v4 offset:160
    ds_read_b32 v16, v4 offset:176
    ds_read_b32 v17, v4 offset:192
    ds_read_b32 v18, v4 offset:208
    ds_read_b32 v19, v4 offset:224
    ds_read_b32 v20, v4 offset:240
    s_mul_i32 s45, s42, 524288
    s_lshl_b32 s44, s41, 8
    s_add_u32 s45, s45, s44
    v_lshlrev_b32 v3, 13, v1
    v_lshlrev_b32 v21, 2, v2
    v_add_u32 v3, v3, v21
    s_waitcnt lgkmcnt(0)
    s_add_u32 s46, s45, 0
    buffer_store_dword v5, v3, s[32:35], s46 offen
    s_add_u32 s46, s45, 32768
    buffer_store_dword v6, v3, s[32:35], s46 offen
    s_add_u32 s46, s45, 65536
    buffer_store_dword v7, v3, s[32:35], s46 offen
    s_add_u32 s46, s45, 98304
    buffer_store_dword v8, v3, s[32:35], s46 offen
    s_add_u32 s46, s45, 131072
    buffer_store_dword v9, v3, s[32:35], s46 offen
    s_add_u32 s46, s45, 163840
    buffer_store_dword v10, v3, s[32:35], s46 offen
    s_add_u32 s46, s45, 196608
    buffer_store_dword v11, v3, s[32:35], s46 offen
    s_add_u32 s46, s45, 229376
    buffer_store_dword v12, v3, s[32:35], s46 offen
    s_add_u32 s46, s45, 262144
    buffer_store_dword v13, v3, s[32:35], s46 offen
    s_add_u32 s46, s45, 294912
    buffer_store_dword v14, v3, s[32:35], s46 offen
    s_add_u32 s46, s45, 327680
    buffer_store_dword v15, v3, s[32:35], s46 offen
    s_add_u32 s46, s45, 360448
    buffer_store_dword v16, v3, s[32:35], s46 offen
    s_add_u32 s46, s45, 393216
    buffer_store_dword v17, v3, s[32:35], s46 offen
    s_add_u32 s46, s45, 425984
    buffer_store_dword v18, v3, s[32:35], s46 offen
    s_add_u32 s46, s45, 458752
    buffer_store_dword v19, v3, s[32:35], s46 offen
    s_add_u32 s46, s45, 491520
    buffer_store_dword v20, v3, s[32:35], s46 offen
L_end_rf1_kernel:
    s_endpgm
.globl col1_kernel
.p2align 8
.type col1_kernel,@function
col1_kernel:
    s_cmp_ge_u32 s2, 321
    s_cbranch_scc1 L_end_col1_kernel
    s_load_dwordx16 s[4:19], s[0:1], 0
    s_load_dwordx4 s[20:23], s[0:1], 64
    s_load_dwordx2 s[24:25], s[0:1], 80
    s_waitcnt lgkmcnt(0)
    s_mul_i32 s27, s2, 16384
    s_lshl_b32 s26, s2, 13
    s_add_u32 s28, s24, 0x0
    s_addc_u32 s29, s25, 0
    s_mov_b32 s30, 0x504000
    s_mov_b32 s31, 0x00020000
    s_add_u32 s32, s24, 0x600000
    s_addc_u32 s33, s25, 0
    s_mov_b32 s34, 0x282000
    s_mov_b32 s35, 0x00020000
    v_lshlrev_b32 v1, 3, v0
    s_add_u32 s40, s27, 0
    buffer_load_dwordx2 v[2:3], v1, s[28:31], s40 offen
    s_add_u32 s40, s27, 2048
    buffer_load_dwordx2 v[4:5], v1, s[28:31], s40 offen
    s_add_u32 s40, s27, 4096
    buffer_load_dwordx2 v[6:7], v1, s[28:31], s40 offen
    s_add_u32 s40, s27, 6144
    buffer_load_dwordx2 v[8:9], v1, s[28:31], s40 offen
    s_add_u32 s40, s27, 8192
    buffer_load_dwordx2 v[10:11], v1, s[28:31], s40 offen
    s_add_u32 s40, s27, 10240
    buffer_load_dwordx2 v[12:13], v1, s[28:31], s40 offen
    s_add_u32 s40, s27, 12288
    buffer_load_dwordx2 v[14:15], v1, s[28:31], s40 offen
    s_add_u32 s40, s27, 14336
    buffer_load_dwordx2 v[16:17], v1, s[28:31], s40 offen
    v_lshlrev_b32 v18, 2, v0
    s_add_u32 s40, s26, 0
    buffer_load_dword v19, v18, s[32:35], s40 offen
    s_add_u32 s40, s26, 1024
    buffer_load_dword v20, v18, s[32:35], s40 offen
    s_add_u32 s40, s26, 2048
    buffer_load_dword v21, v18, s[32:35], s40 offen
    s_add_u32 s40, s26, 3072
    buffer_load_dword v22, v18, s[32:35], s40 offen
    s_add_u32 s40, s26, 4096
    buffer_load_dword v23, v18, s[32:35], s40 offen
    s_add_u32 s40, s26, 5120
    buffer_load_dword v24, v18, s[32:35], s40 offen
    s_add_u32 s40, s26, 6144
    buffer_load_dword v25, v18, s[32:35], s40 offen
    s_add_u32 s40, s26, 7168
    buffer_load_dword v26, v18, s[32:35], s40 offen
    s_waitcnt vmcnt(8)
    v_add_f32 v27, v2, v10
    v_add_f32 v28, v3, v11
    v_sub_f32 v29, v2, v10
    v_sub_f32 v30, v3, v11
    v_add_f32 v31, v6, v14
    v_add_f32 v32, v7, v15
    v_sub_f32 v33, v6, v14
    v_sub_f32 v34, v7, v15
    v_add_f32 v2, v27, v31
    v_add_f32 v3, v28, v32
    v_sub_f32 v6, v27, v31
    v_sub_f32 v7, v28, v32
    v_add_f32 v10, v29, v34
    v_sub_f32 v11, v30, v33
    v_sub_f32 v14, v29, v34
    v_add_f32 v15, v30, v33
    v_add_f32 v27, v4, v12
    v_add_f32 v28, v5, v13
    v_sub_f32 v29, v4, v12
    v_sub_f32 v30, v5, v13
    v_add_f32 v31, v8, v16
    v_add_f32 v32, v9, v17
    v_sub_f32 v33, v8, v16
    v_sub_f32 v34, v9, v17
    v_add_f32 v4, v27, v31
    v_add_f32 v5, v28, v32
    v_sub_f32 v8, v27, v31
    v_sub_f32 v9, v28, v32
    v_add_f32 v12, v29, v34
    v_sub_f32 v13, v30, v33
    v_sub_f32 v16, v29, v34
    v_add_f32 v17, v30, v33
    v_add_f32 v27, v12, v13
    v_sub_f32 v28, v13, v12
    v_mul_f32 v27, 0x3f3504f3, v27
    v_mul_f32 v28, 0x3f3504f3, v28
    v_add_f32 v12, v16, v17
    v_sub_f32 v13, v17, v16
    v_mul_f32 v12, 0x3f3504f3, v12
    v_mul_f32 v13, 0x3f3504f3, v13
    v_add_f32 v16, v2, v4
    v_add_f32 v17, v3, v5
    v_sub_f32 v29, v2, v4
    v_sub_f32 v30, v3, v5
    v_add_f32 v31, v10, v27
    v_add_f32 v32, v11, v28
    v_sub_f32 v33, v10, v27
    v_sub_f32 v34, v11, v28
    v_add_f32 v35, v6, v9
    v_sub_f32 v36, v7, v8
    v_sub_f32 v37, v6, v9
    v_add_f32 v38, v7, v8
    v_add_f32 v39, v14, v13
    v_sub_f32 v40, v15, v12
    v_sub_f32 v41, v14, v13
    v_add_f32 v42, v15, v12
    v_and_b32 v3, 0, v0
    v_lshrrev_b32 v2, 0, v0
    v_lshlrev_b32 v2, 3, v2
    v_add_u32 v2, v2, v3
    v_lshlrev_b32 v2, 3, v2
    v_mov_b32 v4, v16
    v_mov_b32 v5, v17
    ds_write_b64 v2, v[4:5] offset:0
    v_mov_b32 v4, v31
    v_mov_b32 v5, v32
    ds_write_b64 v2, v[4:5] offset:8
    v_mov_b32 v4, v35
    v_mov_b32 v5, v36
    ds_write_b64 v2, v[4:5] offset:16
    v_mov_b32 v4, v39
    v_mov_b32 v5, v40
    ds_write_b64 v2, v[4:5] offset:24
    v_mov_b32 v4, v29
    v_mov_b32 v5, v30
    ds_write_b64 v2, v[4:5] offset:32
    v_mov_b32 v4, v33
    v_mov_b32 v5, v34
    ds_write_b64 v2, v[4:5] offset:40
    v_mov_b32 v4, v37
    v_mov_b32 v5, v38
    ds_write_b64 v2, v[4:5] offset:48
    v_mov_b32 v4, v41
    v_mov_b32 v5, v42
    ds_write_b64 v2, v[4:5] offset:56
    s_waitcnt lgkmcnt(0)
    s_barrier
    ds_read_b64 v[2:3], v1 offset:0
    ds_read_b64 v[4:5], v1 offset:2048
    ds_read_b64 v[6:7], v1 offset:4096
    ds_read_b64 v[8:9], v1 offset:6144
    ds_read_b64 v[10:11], v1 offset:8192
    ds_read_b64 v[12:13], v1 offset:10240
    ds_read_b64 v[14:15], v1 offset:12288
    ds_read_b64 v[16:17], v1 offset:14336
    s_waitcnt lgkmcnt(0)
    v_and_b32 v27, 7, v0
    v_cvt_f32_u32 v27, v27
    v_mul_f32 v27, 0x3c800000, v27
    v_mul_f32 v28, 0x3f800000, v27
    v_cos_f32 v29, v28
    v_sin_f32 v30, v28
    s_nop 0
    v_mul_f32 v31, v4, v29
    v_fma_f32 v31, v5, v30, v31
    v_mul_f32 v32, v5, v29
    v_fma_f32 v32, -v4, v30, v32
    v_mul_f32 v4, 0x40000000, v27
    v_cos_f32 v5, v4
    v_sin_f32 v28, v4
    s_nop 0
    v_mul_f32 v29, v6, v5
    v_fma_f32 v29, v7, v28, v29
    v_mul_f32 v30, v7, v5
    v_fma_f32 v30, -v6, v28, v30
    v_mul_f32 v4, 0x40400000, v27
    v_cos_f32 v5, v4
    v_sin_f32 v6, v4
    s_nop 0
    v_mul_f32 v7, v8, v5
    v_fma_f32 v7, v9, v6, v7
    v_mul_f32 v28, v9, v5
    v_fma_f32 v28, -v8, v6, v28
    v_mul_f32 v4, 0x40800000, v27
    v_cos_f32 v5, v4
    v_sin_f32 v6, v4
    s_nop 0
    v_mul_f32 v8, v10, v5
    v_fma_f32 v8, v11, v6, v8
    v_mul_f32 v9, v11, v5
    v_fma_f32 v9, -v10, v6, v9
    v_mul_f32 v4, 0x40a00000, v27
    v_cos_f32 v5, v4
    v_sin_f32 v6, v4
    s_nop 0
    v_mul_f32 v10, v12, v5
    v_fma_f32 v10, v13, v6, v10
    v_mul_f32 v11, v13, v5
    v_fma_f32 v11, -v12, v6, v11
    v_mul_f32 v4, 0x40c00000, v27
    v_cos_f32 v5, v4
    v_sin_f32 v6, v4
    s_nop 0
    v_mul_f32 v12, v14, v5
    v_fma_f32 v12, v15, v6, v12
    v_mul_f32 v13, v15, v5
    v_fma_f32 v13, -v14, v6, v13
    v_mul_f32 v4, 0x40e00000, v27
    v_cos_f32 v5, v4
    v_sin_f32 v6, v4
    s_nop 0
    v_mul_f32 v14, v16, v5
    v_fma_f32 v14, v17, v6, v14
    v_mul_f32 v15, v17, v5
    v_fma_f32 v15, -v16, v6, v15
    v_add_f32 v4, v2, v8
    v_add_f32 v5, v3, v9
    v_sub_f32 v6, v2, v8
    v_sub_f32 v16, v3, v9
    v_add_f32 v17, v29, v12
    v_add_f32 v27, v30, v13
    v_sub_f32 v33, v29, v12
    v_sub_f32 v34, v30, v13
    v_add_f32 v2, v4, v17
    v_add_f32 v3, v5, v27
    v_sub_f32 v8, v4, v17
    v_sub_f32 v9, v5, v27
    v_add_f32 v12, v6, v34
    v_sub_f32 v13, v16, v33
    v_sub_f32 v29, v6, v34
    v_add_f32 v30, v16, v33
    v_add_f32 v4, v31, v10
    v_add_f32 v5, v32, v11
    v_sub_f32 v6, v31, v10
    v_sub_f32 v16, v32, v11
    v_add_f32 v17, v7, v14
    v_add_f32 v27, v28, v15
    v_sub_f32 v33, v7, v14
    v_sub_f32 v34, v28, v15
    v_add_f32 v7, v4, v17
    v_add_f32 v10, v5, v27
    v_sub_f32 v11, v4, v17
    v_sub_f32 v14, v5, v27
    v_add_f32 v15, v6, v34
    v_sub_f32 v28, v16, v33
    v_sub_f32 v31, v6, v34
    v_add_f32 v32, v16, v33
    v_add_f32 v4, v15, v28
    v_sub_f32 v5, v28, v15
    v_mul_f32 v4, 0x3f3504f3, v4
    v_mul_f32 v5, 0x3f3504f3, v5
    v_add_f32 v6, v31, v32
    v_sub_f32 v15, v32, v31
    v_mul_f32 v6, 0x3f3504f3, v6
    v_mul_f32 v15, 0x3f3504f3, v15
    v_add_f32 v16, v2, v7
    v_add_f32 v17, v3, v10
    v_sub_f32 v27, v2, v7
    v_sub_f32 v28, v3, v10
    v_add_f32 v31, v12, v4
    v_add_f32 v32, v13, v5
    v_sub_f32 v33, v12, v4
    v_sub_f32 v34, v13, v5
    v_add_f32 v35, v8, v14
    v_sub_f32 v36, v9, v11
    v_sub_f32 v37, v8, v14
    v_add_f32 v38, v9, v11
    v_add_f32 v39, v29, v15
    v_sub_f32 v40, v30, v6
    v_sub_f32 v41, v29, v15
    v_add_f32 v42, v30, v6
    v_and_b32 v3, 7, v0
    v_lshrrev_b32 v2, 3, v0
    v_lshlrev_b32 v2, 6, v2
    v_add_u32 v2, v2, v3
    v_lshlrev_b32 v2, 3, v2
    v_mov_b32 v4, v16
    v_mov_b32 v5, v17
    ds_write_b64 v2, v[4:5] offset:16384
    v_mov_b32 v4, v31
    v_mov_b32 v5, v32
    ds_write_b64 v2, v[4:5] offset:16448
    v_mov_b32 v4, v35
    v_mov_b32 v5, v36
    ds_write_b64 v2, v[4:5] offset:16512
    v_mov_b32 v4, v39
    v_mov_b32 v5, v40
    ds_write_b64 v2, v[4:5] offset:16576
    v_mov_b32 v4, v27
    v_mov_b32 v5, v28
    ds_write_b64 v2, v[4:5] offset:16640
    v_mov_b32 v4, v33
    v_mov_b32 v5, v34
    ds_write_b64 v2, v[4:5] offset:16704
    v_mov_b32 v4, v37
    v_mov_b32 v5, v38
    ds_write_b64 v2, v[4:5] offset:16768
    v_mov_b32 v4, v41
    v_mov_b32 v5, v42
    ds_write_b64 v2, v[4:5] offset:16832
    s_waitcnt lgkmcnt(0)
    s_barrier
    ds_read_b64 v[2:3], v1 offset:16384
    ds_read_b64 v[4:5], v1 offset:18432
    ds_read_b64 v[6:7], v1 offset:20480
    ds_read_b64 v[8:9], v1 offset:22528
    ds_read_b64 v[10:11], v1 offset:24576
    ds_read_b64 v[12:13], v1 offset:26624
    ds_read_b64 v[14:15], v1 offset:28672
    ds_read_b64 v[16:17], v1 offset:30720
    s_waitcnt lgkmcnt(0)
    v_and_b32 v27, 63, v0
    v_cvt_f32_u32 v27, v27
    v_mul_f32 v27, 0x3b000000, v27
    v_mul_f32 v28, 0x3f800000, v27
    v_cos_f32 v29, v28
    v_sin_f32 v30, v28
    s_nop 0
    v_mul_f32 v31, v4, v29
    v_fma_f32 v31, v5, v30, v31
    v_mul_f32 v32, v5, v29
    v_fma_f32 v32, -v4, v30, v32
    v_mul_f32 v4, 0x40000000, v27
    v_cos_f32 v5, v4
    v_sin_f32 v28, v4
    s_nop 0
    v_mul_f32 v29, v6, v5
    v_fma_f32 v29, v7, v28, v29
    v_mul_f32 v30, v7, v5
    v_fma_f32 v30, -v6, v28, v30
    v_mul_f32 v4, 0x40400000, v27
    v_cos_f32 v5, v4
    v_sin_f32 v6, v4
    s_nop 0
    v_mul_f32 v7, v8, v5
    v_fma_f32 v7, v9, v6, v7
    v_mul_f32 v28, v9, v5
    v_fma_f32 v28, -v8, v6, v28
    v_mul_f32 v4, 0x40800000, v27
    v_cos_f32 v5, v4
    v_sin_f32 v6, v4
    s_nop 0
    v_mul_f32 v8, v10, v5
    v_fma_f32 v8, v11, v6, v8
    v_mul_f32 v9, v11, v5
    v_fma_f32 v9, -v10, v6, v9
    v_mul_f32 v4, 0x40a00000, v27
    v_cos_f32 v5, v4
    v_sin_f32 v6, v4
    s_nop 0
    v_mul_f32 v10, v12, v5
    v_fma_f32 v10, v13, v6, v10
    v_mul_f32 v11, v13, v5
    v_fma_f32 v11, -v12, v6, v11
    v_mul_f32 v4, 0x40c00000, v27
    v_cos_f32 v5, v4
    v_sin_f32 v6, v4
    s_nop 0
    v_mul_f32 v12, v14, v5
    v_fma_f32 v12, v15, v6, v12
    v_mul_f32 v13, v15, v5
    v_fma_f32 v13, -v14, v6, v13
    v_mul_f32 v4, 0x40e00000, v27
    v_cos_f32 v5, v4
    v_sin_f32 v6, v4
    s_nop 0
    v_mul_f32 v14, v16, v5
    v_fma_f32 v14, v17, v6, v14
    v_mul_f32 v15, v17, v5
    v_fma_f32 v15, -v16, v6, v15
    v_add_f32 v4, v2, v8
    v_add_f32 v5, v3, v9
    v_sub_f32 v6, v2, v8
    v_sub_f32 v16, v3, v9
    v_add_f32 v17, v29, v12
    v_add_f32 v27, v30, v13
    v_sub_f32 v33, v29, v12
    v_sub_f32 v34, v30, v13
    v_add_f32 v2, v4, v17
    v_add_f32 v3, v5, v27
    v_sub_f32 v8, v4, v17
    v_sub_f32 v9, v5, v27
    v_add_f32 v12, v6, v34
    v_sub_f32 v13, v16, v33
    v_sub_f32 v29, v6, v34
    v_add_f32 v30, v16, v33
    v_add_f32 v4, v31, v10
    v_add_f32 v5, v32, v11
    v_sub_f32 v6, v31, v10
    v_sub_f32 v16, v32, v11
    v_add_f32 v17, v7, v14
    v_add_f32 v27, v28, v15
    v_sub_f32 v33, v7, v14
    v_sub_f32 v34, v28, v15
    v_add_f32 v7, v4, v17
    v_add_f32 v10, v5, v27
    v_sub_f32 v11, v4, v17
    v_sub_f32 v14, v5, v27
    v_add_f32 v15, v6, v34
    v_sub_f32 v28, v16, v33
    v_sub_f32 v31, v6, v34
    v_add_f32 v32, v16, v33
    v_add_f32 v4, v15, v28
    v_sub_f32 v5, v28, v15
    v_mul_f32 v4, 0x3f3504f3, v4
    v_mul_f32 v5, 0x3f3504f3, v5
    v_add_f32 v6, v31, v32
    v_sub_f32 v15, v32, v31
    v_mul_f32 v6, 0x3f3504f3, v6
    v_mul_f32 v15, 0x3f3504f3, v15
    v_add_f32 v16, v2, v7
    v_add_f32 v17, v3, v10
    v_sub_f32 v27, v2, v7
    v_sub_f32 v28, v3, v10
    v_add_f32 v31, v12, v4
    v_add_f32 v32, v13, v5
    v_sub_f32 v33, v12, v4
    v_sub_f32 v34, v13, v5
    v_add_f32 v35, v8, v14
    v_sub_f32 v36, v9, v11
    v_sub_f32 v37, v8, v14
    v_add_f32 v38, v9, v11
    v_add_f32 v39, v29, v15
    v_sub_f32 v40, v30, v6
    v_sub_f32 v41, v29, v15
    v_add_f32 v42, v30, v6
    v_and_b32 v3, 63, v0
    v_lshrrev_b32 v2, 6, v0
    v_lshlrev_b32 v2, 9, v2
    v_add_u32 v2, v2, v3
    v_lshlrev_b32 v2, 3, v2
    v_mov_b32 v4, v16
    v_mov_b32 v5, v17
    ds_write_b64 v2, v[4:5] offset:0
    v_mov_b32 v4, v31
    v_mov_b32 v5, v32
    ds_write_b64 v2, v[4:5] offset:512
    v_mov_b32 v4, v35
    v_mov_b32 v5, v36
    ds_write_b64 v2, v[4:5] offset:1024
    v_mov_b32 v4, v39
    v_mov_b32 v5, v40
    ds_write_b64 v2, v[4:5] offset:1536
    v_mov_b32 v4, v27
    v_mov_b32 v5, v28
    ds_write_b64 v2, v[4:5] offset:2048
    v_mov_b32 v4, v33
    v_mov_b32 v5, v34
    ds_write_b64 v2, v[4:5] offset:2560
    v_mov_b32 v4, v37
    v_mov_b32 v5, v38
    ds_write_b64 v2, v[4:5] offset:3072
    v_mov_b32 v4, v41
    v_mov_b32 v5, v42
    ds_write_b64 v2, v[4:5] offset:3584
    s_waitcnt lgkmcnt(0)
    s_barrier
    ds_read_b64 v[2:3], v1 offset:0
    ds_read_b64 v[4:5], v1 offset:4096
    ds_read_b64 v[6:7], v1 offset:8192
    ds_read_b64 v[8:9], v1 offset:12288
    s_waitcnt lgkmcnt(0)
    v_add_u32 v10, 0, v0
    v_cvt_f32_u32 v10, v10
    v_mul_f32 v10, 0x3a000000, v10
    v_mul_f32 v11, 0x3f800000, v10
    v_cos_f32 v12, v11
    v_sin_f32 v13, v11
    s_nop 0
    v_mul_f32 v14, v4, v12
    v_fma_f32 v14, v5, v13, v14
    v_mul_f32 v15, v5, v12
    v_fma_f32 v15, -v4, v13, v15
    v_mul_f32 v4, 0x40000000, v10
    v_cos_f32 v5, v4
    v_sin_f32 v11, v4
    s_nop 0
    v_mul_f32 v12, v6, v5
    v_fma_f32 v12, v7, v11, v12
    v_mul_f32 v13, v7, v5
    v_fma_f32 v13, -v6, v11, v13
    v_mul_f32 v4, 0x40400000, v10
    v_cos_f32 v5, v4
    v_sin_f32 v6, v4
    s_nop 0
    v_mul_f32 v7, v8, v5
    v_fma_f32 v7, v9, v6, v7
    v_mul_f32 v11, v9, v5
    v_fma_f32 v11, -v8, v6, v11
    v_add_f32 v4, v2, v12
    v_add_f32 v5, v3, v13
    v_sub_f32 v6, v2, v12
    v_sub_f32 v8, v3, v13
    v_add_f32 v9, v14, v7
    v_add_f32 v10, v15, v11
    v_sub_f32 v16, v14, v7
    v_sub_f32 v17, v15, v11
    v_add_f32 v2, v4, v9
    v_add_f32 v3, v5, v10
    v_sub_f32 v7, v4, v9
    v_sub_f32 v11, v5, v10
    v_add_f32 v12, v6, v17
    v_sub_f32 v13, v8, v16
    v_sub_f32 v14, v6, v17
    v_add_f32 v15, v8, v16
    ds_read_b64 v[4:5], v1 offset:2048
    ds_read_b64 v[8:9], v1 offset:6144
    ds_read_b64 v[16:17], v1 offset:10240
    ds_read_b64 v[28:29], v1 offset:14336
    s_waitcnt lgkmcnt(0)
    v_add_u32 v6, 256, v0
    v_cvt_f32_u32 v6, v6
    v_mul_f32 v6, 0x3a000000, v6
    v_mul_f32 v10, 0x3f800000, v6
    v_cos_f32 v27, v10
    v_sin_f32 v30, v10
    s_nop 0
    v_mul_f32 v31, v8, v27
    v_fma_f32 v31, v9, v30, v31
    v_mul_f32 v32, v9, v27
    v_fma_f32 v32, -v8, v30, v32
    v_mul_f32 v8, 0x40000000, v6
    v_cos_f32 v9, v8
    v_sin_f32 v10, v8
    s_nop 0
    v_mul_f32 v27, v16, v9
    v_fma_f32 v27, v17, v10, v27
    v_mul_f32 v30, v17, v9
    v_fma_f32 v30, -v16, v10, v30
    v_mul_f32 v8, 0x40400000, v6
    v_cos_f32 v9, v8
    v_sin_f32 v10, v8
    s_nop 0
    v_mul_f32 v16, v28, v9
    v_fma_f32 v16, v29, v10, v16
    v_mul_f32 v17, v29, v9
    v_fma_f32 v17, -v28, v10, v17
    v_add_f32 v6, v4, v27
    v_add_f32 v8, v5, v30
    v_sub_f32 v9, v4, v27
    v_sub_f32 v10, v5, v30
    v_add_f32 v28, v31, v16
    v_add_f32 v29, v32, v17
    v_sub_f32 v33, v31, v16
    v_sub_f32 v34, v32, v17
    v_add_f32 v4, v6, v28
    v_add_f32 v5, v8, v29
    v_sub_f32 v16, v6, v28
    v_sub_f32 v17, v8, v29
    v_add_f32 v27, v9, v34
    v_sub_f32 v30, v10, v33
    v_sub_f32 v31, v9, v34
    v_add_f32 v32, v10, v33
    s_waitcnt vmcnt(0)
    v_lshlrev_b32 v6, 16, v19
    v_and_b32 v8, 0xffff0000, v19
    v_mul_f32 v6, 0x354ccccd, v6
    v_mul_f32 v8, 0x354ccccd, v8
    v_mul_f32 v9, v2, v6
    v_fma_f32 v9, -v3, v8, v9
    v_mul_f32 v10, v3, v6
    v_fma_f32 v10, v2, v8, v10
    v_lshlrev_b32 v2, 16, v20
    v_and_b32 v3, 0xffff0000, v20
    v_mul_f32 v2, 0x354ccccd, v2
    v_mul_f32 v3, 0x354ccccd, v3
    v_mul_f32 v6, v4, v2
    v_fma_f32 v6, -v5, v3, v6
    v_mul_f32 v8, v5, v2
    v_fma_f32 v8, v4, v3, v8
    v_lshlrev_b32 v2, 16, v21
    v_and_b32 v3, 0xffff0000, v21
    v_mul_f32 v2, 0x354ccccd, v2
    v_mul_f32 v3, 0x354ccccd, v3
    v_mul_f32 v4, v12, v2
    v_fma_f32 v4, -v13, v3, v4
    v_mul_f32 v5, v13, v2
    v_fma_f32 v5, v12, v3, v5
    v_lshlrev_b32 v2, 16, v22
    v_and_b32 v3, 0xffff0000, v22
    v_mul_f32 v2, 0x354ccccd, v2
    v_mul_f32 v3, 0x354ccccd, v3
    v_mul_f32 v12, v27, v2
    v_fma_f32 v12, -v30, v3, v12
    v_mul_f32 v13, v30, v2
    v_fma_f32 v13, v27, v3, v13
    v_lshlrev_b32 v2, 16, v23
    v_and_b32 v3, 0xffff0000, v23
    v_mul_f32 v2, 0x354ccccd, v2
    v_mul_f32 v3, 0x354ccccd, v3
    v_mul_f32 v27, v7, v2
    v_fma_f32 v27, -v11, v3, v27
    v_mul_f32 v28, v11, v2
    v_fma_f32 v28, v7, v3, v28
    v_lshlrev_b32 v2, 16, v24
    v_and_b32 v3, 0xffff0000, v24
    v_mul_f32 v2, 0x354ccccd, v2
    v_mul_f32 v3, 0x354ccccd, v3
    v_mul_f32 v7, v16, v2
    v_fma_f32 v7, -v17, v3, v7
    v_mul_f32 v11, v17, v2
    v_fma_f32 v11, v16, v3, v11
    v_lshlrev_b32 v2, 16, v25
    v_and_b32 v3, 0xffff0000, v25
    v_mul_f32 v2, 0x354ccccd, v2
    v_mul_f32 v3, 0x354ccccd, v3
    v_mul_f32 v16, v14, v2
    v_fma_f32 v16, -v15, v3, v16
    v_mul_f32 v17, v15, v2
    v_fma_f32 v17, v14, v3, v17
    v_lshlrev_b32 v2, 16, v26
    v_and_b32 v3, 0xffff0000, v26
    v_mul_f32 v2, 0x354ccccd, v2
    v_mul_f32 v3, 0x354ccccd, v3
    v_mul_f32 v14, v31, v2
    v_fma_f32 v14, -v32, v3, v14
    v_mul_f32 v15, v32, v2
    v_fma_f32 v15, v31, v3, v15
    v_add_f32 v2, v9, v27
    v_add_f32 v3, v10, v28
    v_sub_f32 v29, v9, v27
    v_sub_f32 v30, v10, v28
    v_add_f32 v31, v4, v16
    v_add_f32 v32, v5, v17
    v_sub_f32 v33, v4, v16
    v_sub_f32 v34, v5, v17
    v_add_f32 v4, v2, v31
    v_add_f32 v5, v3, v32
    v_sub_f32 v9, v2, v31
    v_sub_f32 v10, v3, v32
    v_sub_f32 v16, v29, v34
    v_add_f32 v17, v30, v33
    v_add_f32 v27, v29, v34
    v_sub_f32 v28, v30, v33
    v_add_f32 v2, v6, v7
    v_add_f32 v3, v8, v11
    v_sub_f32 v29, v6, v7
    v_sub_f32 v30, v8, v11
    v_add_f32 v31, v12, v14
    v_add_f32 v32, v13, v15
    v_sub_f32 v33, v12, v14
    v_sub_f32 v34, v13, v15
    v_add_f32 v6, v2, v31
    v_add_f32 v7, v3, v32
    v_sub_f32 v8, v2, v31
    v_sub_f32 v11, v3, v32
    v_sub_f32 v12, v29, v34
    v_add_f32 v13, v30, v33
    v_add_f32 v14, v29, v34
    v_sub_f32 v15, v30, v33
    v_sub_f32 v2, v12, v13
    v_add_f32 v3, v13, v12
    v_mul_f32 v2, 0x3f3504f3, v2
    v_mul_f32 v3, 0x3f3504f3, v3
    v_sub_f32 v12, v14, v15
    v_add_f32 v13, v15, v14
    v_mul_f32 v12, 0x3f3504f3, v12
    v_mul_f32 v13, 0x3f3504f3, v13
    v_add_f32 v14, v4, v6
    v_add_f32 v15, v5, v7
    v_sub_f32 v29, v4, v6
    v_sub_f32 v30, v5, v7
    v_add_f32 v31, v16, v2
    v_add_f32 v32, v17, v3
    v_sub_f32 v33, v16, v2
    v_sub_f32 v34, v17, v3
    v_sub_f32 v35, v9, v11
    v_add_f32 v36, v10, v8
    v_add_f32 v37, v9, v11
    v_sub_f32 v38, v10, v8
    v_sub_f32 v39, v27, v13
    v_add_f32 v40, v28, v12
    v_add_f32 v41, v27, v13
    v_sub_f32 v42, v28, v12
    v_and_b32 v3, 0, v0
    v_lshrrev_b32 v2, 0, v0
    v_lshlrev_b32 v2, 3, v2
    v_add_u32 v2, v2, v3
    v_lshlrev_b32 v2, 3, v2
    v_mov_b32 v4, v14
    v_mov_b32 v5, v15
    ds_write_b64 v2, v[4:5] offset:16384
    v_mov_b32 v4, v31
    v_mov_b32 v5, v32
    ds_write_b64 v2, v[4:5] offset:16392
    v_mov_b32 v4, v35
    v_mov_b32 v5, v36
    ds_write_b64 v2, v[4:5] offset:16400
    v_mov_b32 v4, v39
    v_mov_b32 v5, v40
    ds_write_b64 v2, v[4:5] offset:16408
    v_mov_b32 v4, v29
    v_mov_b32 v5, v30
    ds_write_b64 v2, v[4:5] offset:16416
    v_mov_b32 v4, v33
    v_mov_b32 v5, v34
    ds_write_b64 v2, v[4:5] offset:16424
    v_mov_b32 v4, v37
    v_mov_b32 v5, v38
    ds_write_b64 v2, v[4:5] offset:16432
    v_mov_b32 v4, v41
    v_mov_b32 v5, v42
    ds_write_b64 v2, v[4:5] offset:16440
    s_waitcnt lgkmcnt(0)
    s_barrier
    ds_read_b64 v[2:3], v1 offset:16384
    ds_read_b64 v[4:5], v1 offset:18432
    ds_read_b64 v[6:7], v1 offset:20480
    ds_read_b64 v[8:9], v1 offset:22528
    ds_read_b64 v[10:11], v1 offset:24576
    ds_read_b64 v[12:13], v1 offset:26624
    ds_read_b64 v[14:15], v1 offset:28672
    ds_read_b64 v[16:17], v1 offset:30720
    s_waitcnt lgkmcnt(0)
    v_and_b32 v27, 7, v0
    v_cvt_f32_u32 v27, v27
    v_mul_f32 v27, 0x3c800000, v27
    v_mul_f32 v28, 0x3f800000, v27
    v_cos_f32 v29, v28
    v_sin_f32 v30, v28
    s_nop 0
    v_mul_f32 v31, v4, v29
    v_fma_f32 v31, -v5, v30, v31
    v_mul_f32 v32, v5, v29
    v_fma_f32 v32, v4, v30, v32
    v_mul_f32 v4, 0x40000000, v27
    v_cos_f32 v5, v4
    v_sin_f32 v28, v4
    s_nop 0
    v_mul_f32 v29, v6, v5
    v_fma_f32 v29, -v7, v28, v29
    v_mul_f32 v30, v7, v5
    v_fma_f32 v30, v6, v28, v30
    v_mul_f32 v4, 0x40400000, v27
    v_cos_f32 v5, v4
    v_sin_f32 v6, v4
    s_nop 0
    v_mul_f32 v7, v8, v5
    v_fma_f32 v7, -v9, v6, v7
    v_mul_f32 v28, v9, v5
    v_fma_f32 v28, v8, v6, v28
    v_mul_f32 v4, 0x40800000, v27
    v_cos_f32 v5, v4
    v_sin_f32 v6, v4
    s_nop 0
    v_mul_f32 v8, v10, v5
    v_fma_f32 v8, -v11, v6, v8
    v_mul_f32 v9, v11, v5
    v_fma_f32 v9, v10, v6, v9
    v_mul_f32 v4, 0x40a00000, v27
    v_cos_f32 v5, v4
    v_sin_f32 v6, v4
    s_nop 0
    v_mul_f32 v10, v12, v5
    v_fma_f32 v10, -v13, v6, v10
    v_mul_f32 v11, v13, v5
    v_fma_f32 v11, v12, v6, v11
    v_mul_f32 v4, 0x40c00000, v27
    v_cos_f32 v5, v4
    v_sin_f32 v6, v4
    s_nop 0
    v_mul_f32 v12, v14, v5
    v_fma_f32 v12, -v15, v6, v12
    v_mul_f32 v13, v15, v5
    v_fma_f32 v13, v14, v6, v13
    v_mul_f32 v4, 0x40e00000, v27
    v_cos_f32 v5, v4
    v_sin_f32 v6, v4
    s_nop 0
    v_mul_f32 v14, v16, v5
    v_fma_f32 v14, -v17, v6, v14
    v_mul_f32 v15, v17, v5
    v_fma_f32 v15, v16, v6, v15
    v_add_f32 v4, v2, v8
    v_add_f32 v5, v3, v9
    v_sub_f32 v6, v2, v8
    v_sub_f32 v16, v3, v9
    v_add_f32 v17, v29, v12
    v_add_f32 v27, v30, v13
    v_sub_f32 v33, v29, v12
    v_sub_f32 v34, v30, v13
    v_add_f32 v2, v4, v17
    v_add_f32 v3, v5, v27
    v_sub_f32 v8, v4, v17
    v_sub_f32 v9, v5, v27
    v_sub_f32 v12, v6, v34
    v_add_f32 v13, v16, v33
    v_add_f32 v29, v6, v34
    v_sub_f32 v30, v16, v33
    v_add_f32 v4, v31, v10
    v_add_f32 v5, v32, v11
    v_sub_f32 v6, v31, v10
    v_sub_f32 v16, v32, v11
    v_add_f32 v17, v7, v14
    v_add_f32 v27, v28, v15
    v_sub_f32 v33, v7, v14
    v_sub_f32 v34, v28, v15
    v_add_f32 v7, v4, v17
    v_add_f32 v10, v5, v27
    v_sub_f32 v11, v4, v17
    v_sub_f32 v14, v5, v27
    v_sub_f32 v15, v6, v34
    v_add_f32 v28, v16, v33
    v_add_f32 v31, v6, v34
    v_sub_f32 v32, v16, v33
    v_sub_f32 v4, v15, v28
    v_add_f32 v5, v28, v15
    v_mul_f32 v4, 0x3f3504f3, v4
    v_mul_f32 v5, 0x3f3504f3, v5
    v_sub_f32 v6, v31, v32
    v_add_f32 v15, v32, v31
    v_mul_f32 v6, 0x3f3504f3, v6
    v_mul_f32 v15, 0x3f3504f3, v15
    v_add_f32 v16, v2, v7
    v_add_f32 v17, v3, v10
    v_sub_f32 v27, v2, v7
    v_sub_f32 v28, v3, v10
    v_add_f32 v31, v12, v4
    v_add_f32 v32, v13, v5
    v_sub_f32 v33, v12, v4
    v_sub_f32 v34, v13, v5
    v_sub_f32 v35, v8, v14
    v_add_f32 v36, v9, v11
    v_add_f32 v37, v8, v14
    v_sub_f32 v38, v9, v11
    v_sub_f32 v39, v29, v15
    v_add_f32 v40, v30, v6
    v_add_f32 v41, v29, v15
    v_sub_f32 v42, v30, v6
    v_and_b32 v3, 7, v0
    v_lshrrev_b32 v2, 3, v0
    v_lshlrev_b32 v2, 6, v2
    v_add_u32 v2, v2, v3
    v_lshlrev_b32 v2, 3, v2
    v_mov_b32 v4, v16
    v_mov_b32 v5, v17
    ds_write_b64 v2, v[4:5] offset:0
    v_mov_b32 v4, v31
    v_mov_b32 v5, v32
    ds_write_b64 v2, v[4:5] offset:64
    v_mov_b32 v4, v35
    v_mov_b32 v5, v36
    ds_write_b64 v2, v[4:5] offset:128
    v_mov_b32 v4, v39
    v_mov_b32 v5, v40
    ds_write_b64 v2, v[4:5] offset:192
    v_mov_b32 v4, v27
    v_mov_b32 v5, v28
    ds_write_b64 v2, v[4:5] offset:256
    v_mov_b32 v4, v33
    v_mov_b32 v5, v34
    ds_write_b64 v2, v[4:5] offset:320
    v_mov_b32 v4, v37
    v_mov_b32 v5, v38
    ds_write_b64 v2, v[4:5] offset:384
    v_mov_b32 v4, v41
    v_mov_b32 v5, v42
    ds_write_b64 v2, v[4:5] offset:448
    s_waitcnt lgkmcnt(0)
    s_barrier
    ds_read_b64 v[2:3], v1 offset:0
    ds_read_b64 v[4:5], v1 offset:2048
    ds_read_b64 v[6:7], v1 offset:4096
    ds_read_b64 v[8:9], v1 offset:6144
    ds_read_b64 v[10:11], v1 offset:8192
    ds_read_b64 v[12:13], v1 offset:10240
    ds_read_b64 v[14:15], v1 offset:12288
    ds_read_b64 v[16:17], v1 offset:14336
    s_waitcnt lgkmcnt(0)
    v_and_b32 v27, 63, v0
    v_cvt_f32_u32 v27, v27
    v_mul_f32 v27, 0x3b000000, v27
    v_mul_f32 v28, 0x3f800000, v27
    v_cos_f32 v29, v28
    v_sin_f32 v30, v28
    s_nop 0
    v_mul_f32 v31, v4, v29
    v_fma_f32 v31, -v5, v30, v31
    v_mul_f32 v32, v5, v29
    v_fma_f32 v32, v4, v30, v32
    v_mul_f32 v4, 0x40000000, v27
    v_cos_f32 v5, v4
    v_sin_f32 v28, v4
    s_nop 0
    v_mul_f32 v29, v6, v5
    v_fma_f32 v29, -v7, v28, v29
    v_mul_f32 v30, v7, v5
    v_fma_f32 v30, v6, v28, v30
    v_mul_f32 v4, 0x40400000, v27
    v_cos_f32 v5, v4
    v_sin_f32 v6, v4
    s_nop 0
    v_mul_f32 v7, v8, v5
    v_fma_f32 v7, -v9, v6, v7
    v_mul_f32 v28, v9, v5
    v_fma_f32 v28, v8, v6, v28
    v_mul_f32 v4, 0x40800000, v27
    v_cos_f32 v5, v4
    v_sin_f32 v6, v4
    s_nop 0
    v_mul_f32 v8, v10, v5
    v_fma_f32 v8, -v11, v6, v8
    v_mul_f32 v9, v11, v5
    v_fma_f32 v9, v10, v6, v9
    v_mul_f32 v4, 0x40a00000, v27
    v_cos_f32 v5, v4
    v_sin_f32 v6, v4
    s_nop 0
    v_mul_f32 v10, v12, v5
    v_fma_f32 v10, -v13, v6, v10
    v_mul_f32 v11, v13, v5
    v_fma_f32 v11, v12, v6, v11
    v_mul_f32 v4, 0x40c00000, v27
    v_cos_f32 v5, v4
    v_sin_f32 v6, v4
    s_nop 0
    v_mul_f32 v12, v14, v5
    v_fma_f32 v12, -v15, v6, v12
    v_mul_f32 v13, v15, v5
    v_fma_f32 v13, v14, v6, v13
    v_mul_f32 v4, 0x40e00000, v27
    v_cos_f32 v5, v4
    v_sin_f32 v6, v4
    s_nop 0
    v_mul_f32 v14, v16, v5
    v_fma_f32 v14, -v17, v6, v14
    v_mul_f32 v15, v17, v5
    v_fma_f32 v15, v16, v6, v15
    v_add_f32 v4, v2, v8
    v_add_f32 v5, v3, v9
    v_sub_f32 v6, v2, v8
    v_sub_f32 v16, v3, v9
    v_add_f32 v17, v29, v12
    v_add_f32 v27, v30, v13
    v_sub_f32 v33, v29, v12
    v_sub_f32 v34, v30, v13
    v_add_f32 v2, v4, v17
    v_add_f32 v3, v5, v27
    v_sub_f32 v8, v4, v17
    v_sub_f32 v9, v5, v27
    v_sub_f32 v12, v6, v34
    v_add_f32 v13, v16, v33
    v_add_f32 v29, v6, v34
    v_sub_f32 v30, v16, v33
    v_add_f32 v4, v31, v10
    v_add_f32 v5, v32, v11
    v_sub_f32 v6, v31, v10
    v_sub_f32 v16, v32, v11
    v_add_f32 v17, v7, v14
    v_add_f32 v27, v28, v15
    v_sub_f32 v33, v7, v14
    v_sub_f32 v34, v28, v15
    v_add_f32 v7, v4, v17
    v_add_f32 v10, v5, v27
    v_sub_f32 v11, v4, v17
    v_sub_f32 v14, v5, v27
    v_sub_f32 v15, v6, v34
    v_add_f32 v28, v16, v33
    v_add_f32 v31, v6, v34
    v_sub_f32 v32, v16, v33
    v_sub_f32 v4, v15, v28
    v_add_f32 v5, v28, v15
    v_mul_f32 v4, 0x3f3504f3, v4
    v_mul_f32 v5, 0x3f3504f3, v5
    v_sub_f32 v6, v31, v32
    v_add_f32 v15, v32, v31
    v_mul_f32 v6, 0x3f3504f3, v6
    v_mul_f32 v15, 0x3f3504f3, v15
    v_add_f32 v16, v2, v7
    v_add_f32 v17, v3, v10
    v_sub_f32 v27, v2, v7
    v_sub_f32 v28, v3, v10
    v_add_f32 v31, v12, v4
    v_add_f32 v32, v13, v5
    v_sub_f32 v33, v12, v4
    v_sub_f32 v34, v13, v5
    v_sub_f32 v35, v8, v14
    v_add_f32 v36, v9, v11
    v_add_f32 v37, v8, v14
    v_sub_f32 v38, v9, v11
    v_sub_f32 v39, v29, v15
    v_add_f32 v40, v30, v6
    v_add_f32 v41, v29, v15
    v_sub_f32 v42, v30, v6
    v_and_b32 v3, 63, v0
    v_lshrrev_b32 v2, 6, v0
    v_lshlrev_b32 v2, 9, v2
    v_add_u32 v2, v2, v3
    v_lshlrev_b32 v2, 3, v2
    v_mov_b32 v4, v16
    v_mov_b32 v5, v17
    ds_write_b64 v2, v[4:5] offset:16384
    v_mov_b32 v4, v31
    v_mov_b32 v5, v32
    ds_write_b64 v2, v[4:5] offset:16896
    v_mov_b32 v4, v35
    v_mov_b32 v5, v36
    ds_write_b64 v2, v[4:5] offset:17408
    v_mov_b32 v4, v39
    v_mov_b32 v5, v40
    ds_write_b64 v2, v[4:5] offset:17920
    v_mov_b32 v4, v27
    v_mov_b32 v5, v28
    ds_write_b64 v2, v[4:5] offset:18432
    v_mov_b32 v4, v33
    v_mov_b32 v5, v34
    ds_write_b64 v2, v[4:5] offset:18944
    v_mov_b32 v4, v37
    v_mov_b32 v5, v38
    ds_write_b64 v2, v[4:5] offset:19456
    v_mov_b32 v4, v41
    v_mov_b32 v5, v42
    ds_write_b64 v2, v[4:5] offset:19968
    s_waitcnt lgkmcnt(0)
    s_barrier
    ds_read_b64 v[2:3], v1 offset:16384
    ds_read_b64 v[4:5], v1 offset:20480
    ds_read_b64 v[6:7], v1 offset:24576
    ds_read_b64 v[8:9], v1 offset:28672
    s_waitcnt lgkmcnt(0)
    v_add_u32 v10, 0, v0
    v_cvt_f32_u32 v10, v10
    v_mul_f32 v10, 0x3a000000, v10
    v_mul_f32 v11, 0x3f800000, v10
    v_cos_f32 v12, v11
    v_sin_f32 v13, v11
    s_nop 0
    v_mul_f32 v14, v4, v12
    v_fma_f32 v14, -v5, v13, v14
    v_mul_f32 v15, v5, v12
    v_fma_f32 v15, v4, v13, v15
    v_mul_f32 v4, 0x40000000, v10
    v_cos_f32 v5, v4
    v_sin_f32 v11, v4
    s_nop 0
    v_mul_f32 v12, v6, v5
    v_fma_f32 v12, -v7, v11, v12
    v_mul_f32 v13, v7, v5
    v_fma_f32 v13, v6, v11, v13
    v_mul_f32 v4, 0x40400000, v10
    v_cos_f32 v5, v4
    v_sin_f32 v6, v4
    s_nop 0
    v_mul_f32 v7, v8, v5
    v_fma_f32 v7, -v9, v6, v7
    v_mul_f32 v11, v9, v5
    v_fma_f32 v11, v8, v6, v11
    v_add_f32 v4, v2, v12
    v_add_f32 v5, v3, v13
    v_sub_f32 v6, v2, v12
    v_sub_f32 v8, v3, v13
    v_add_f32 v9, v14, v7
    v_add_f32 v10, v15, v11
    v_sub_f32 v16, v14, v7
    v_sub_f32 v17, v15, v11
    v_add_f32 v2, v4, v9
    v_add_f32 v3, v5, v10
    v_sub_f32 v7, v4, v9
    v_sub_f32 v11, v5, v10
    v_sub_f32 v12, v6, v17
    v_add_f32 v13, v8, v16
    v_add_f32 v14, v6, v17
    v_sub_f32 v15, v8, v16
    ds_read_b64 v[4:5], v1 offset:18432
    ds_read_b64 v[8:9], v1 offset:22528
    ds_read_b64 v[16:17], v1 offset:26624
    ds_read_b64 v[28:29], v1 offset:30720
    s_waitcnt lgkmcnt(0)
    v_add_u32 v6, 256, v0
    v_cvt_f32_u32 v6, v6
    v_mul_f32 v6, 0x3a000000, v6
    v_mul_f32 v10, 0x3f800000, v6
    v_cos_f32 v27, v10
    v_sin_f32 v30, v10
    s_nop 0
    v_mul_f32 v31, v8, v27
    v_fma_f32 v31, -v9, v30, v31
    v_mul_f32 v32, v9, v27
    v_fma_f32 v32, v8, v30, v32
    v_mul_f32 v8, 0x40000000, v6
    v_cos_f32 v9, v8
    v_sin_f32 v10, v8
    s_nop 0
    v_mul_f32 v27, v16, v9
    v_fma_f32 v27, -v17, v10, v27
    v_mul_f32 v30, v17, v9
    v_fma_f32 v30, v16, v10, v30
    v_mul_f32 v8, 0x40400000, v6
    v_cos_f32 v9, v8
    v_sin_f32 v10, v8
    s_nop 0
    v_mul_f32 v16, v28, v9
    v_fma_f32 v16, -v29, v10, v16
    v_mul_f32 v17, v29, v9
    v_fma_f32 v17, v28, v10, v17
    v_add_f32 v6, v4, v27
    v_add_f32 v8, v5, v30
    v_sub_f32 v9, v4, v27
    v_sub_f32 v10, v5, v30
    v_add_f32 v28, v31, v16
    v_add_f32 v29, v32, v17
    v_sub_f32 v33, v31, v16
    v_sub_f32 v34, v32, v17
    v_add_f32 v4, v6, v28
    v_add_f32 v5, v8, v29
    v_sub_f32 v16, v6, v28
    v_sub_f32 v17, v8, v29
    v_sub_f32 v27, v9, v34
    v_add_f32 v30, v10, v33
    v_add_f32 v31, v9, v34
    v_sub_f32 v32, v10, v33
    v_mov_b32 v8, v2
    v_mov_b32 v9, v3
    s_add_u32 s40, s27, 0
    buffer_store_dwordx2 v[8:9], v1, s[28:31], s40 offen
    v_mov_b32 v28, v4
    v_mov_b32 v29, v5
    s_add_u32 s40, s27, 2048
    buffer_store_dwordx2 v[28:29], v1, s[28:31], s40 offen
    v_mov_b32 v34, v12
    v_mov_b32 v35, v13
    s_add_u32 s40, s27, 4096
    buffer_store_dwordx2 v[34:35], v1, s[28:31], s40 offen
    v_mov_b32 v36, v27
    v_mov_b32 v37, v30
    s_add_u32 s40, s27, 6144
    buffer_store_dwordx2 v[36:37], v1, s[28:31], s40 offen
    v_mov_b32 v38, v7
    v_mov_b32 v39, v11
    s_add_u32 s40, s27, 8192
    buffer_store_dwordx2 v[38:39], v1, s[28:31], s40 offen
    v_mov_b32 v40, v16
    v_mov_b32 v41, v17
    s_add_u32 s40, s27, 10240
    buffer_store_dwordx2 v[40:41], v1, s[28:31], s40 offen
    v_mov_b32 v42, v14
    v_mov_b32 v43, v15
    s_add_u32 s40, s27, 12288
    buffer_store_dwordx2 v[42:43], v1, s[28:31], s40 offen
    v_mov_b32 v44, v31
    v_mov_b32 v45, v32
    s_add_u32 s40, s27, 14336
    buffer_store_dwordx2 v[44:45], v1, s[28:31], s40 offen
L_end_col1_kernel:
    s_endpgm
.globl ri1_kernel
.p2align 8
.type ri1_kernel,@function
ri1_kernel:
    s_cmp_ge_u32 s2, 256
    s_cbranch_scc1 L_end_ri1_kernel
    s_load_dwordx16 s[4:19], s[0:1], 0
    s_load_dwordx4 s[20:23], s[0:1], 64
    s_load_dwordx2 s[24:25], s[0:1], 80
    s_waitcnt lgkmcnt(0)
    s_add_u32 s28, s4, 0x0
    s_addc_u32 s29, s5, 0
    s_mov_b32 s30, 0x280000
    s_mov_b32 s31, 0x00020000
    s_add_u32 s32, s24, 0x0
    s_addc_u32 s33, s25, 0
    s_mov_b32 s34, 0x504000
    s_mov_b32 s35, 0x00020000
    s_add_u32 s36, s24, 0xf00000
    s_addc_u32 s37, s25, 0
    s_mov_b32 s38, 0x280000
    s_mov_b32 s39, 0x00020000
    s_add_u32 s44, s24, 0x1200000
    s_addc_u32 s45, s25, 0
    s_mov_b32 s46, 0x280000
    s_mov_b32 s47, 0x00020000
    v_and_b32 v1, 63, v0
    v_lshrrev_b32 v2, 6, v0
    s_nop 1
    v_readfirstlane_b32 s26, v2
    s_nop 3
    v_and_b32 v2, 7, v0
    v_lshrrev_b32 v3, 3, v0
    v_mul_u32_u24 v4, 2576, v2
    s_lshl_b32 s27, s2, 3
    v_add_u32 v2, s27, v2
    v_add_u32 v5, 0, v3
    v_lshlrev_b32 v23, 11, v5
    v_add_u32 v23, v23, v2
    v_lshlrev_b32 v23, 3, v23
    buffer_load_dwordx2 v[6:7], v23, s[32:35], 0 offen
    v_add_u32 v18, 64, v3
    v_lshlrev_b32 v23, 11, v18
    v_add_u32 v23, v23, v2
    v_lshlrev_b32 v23, 3, v23
    buffer_load_dwordx2 v[8:9], v23, s[32:35], 0 offen
    v_add_u32 v19, 128, v3
    v_lshlrev_b32 v23, 11, v19
    v_add_u32 v23, v23, v2
    v_lshlrev_b32 v23, 3, v23
    buffer_load_dwordx2 v[10:11], v23, s[32:35], 0 offen
    v_add_u32 v20, 192, v3
    v_lshlrev_b32 v23, 11, v20
    v_add_u32 v23, v23, v2
    v_lshlrev_b32 v23, 3, v23
    buffer_load_dwordx2 v[12:13], v23, s[32:35], 0 offen
    v_add_u32 v21, 256, v3
    v_lshlrev_b32 v23, 11, v21
    v_add_u32 v23, v23, v2
    v_lshlrev_b32 v23, 3, v23
    buffer_load_dwordx2 v[14:15], v23, s[32:35], 0 offen
    v_add_u32 v22, 320, v3
    v_lshlrev_b32 v23, 11, v22
    v_add_u32 v23, v23, v2
    v_lshlrev_b32 v23, 3, v23
    buffer_load_dwordx2 v[16:17], v23, s[32:35], 0 offen
    s_waitcnt vmcnt(0)
    v_cmp_eq_u32 vcc, 0, v5
    s_nop 1
    v_cndmask_b32 v7, v7, 0, vcc
    v_lshlrev_b32 v23, 3, v5
    v_add_u32 v23, v23, v4
    ds_write_b64 v23, v[6:7]
    v_lshlrev_b32 v23, 3, v18
    v_add_u32 v23, v23, v4
    ds_write_b64 v23, v[8:9]
    v_lshlrev_b32 v23, 3, v19
    v_add_u32 v23, v23, v4
    ds_write_b64 v23, v[10:11]
    v_lshlrev_b32 v23, 3, v20
    v_add_u32 v23, v23, v4
    ds_write_b64 v23, v[12:13]
    v_lshlrev_b32 v23, 3, v21
    v_add_u32 v23, v23, v4
    ds_write_b64 v23, v[14:15]
    v_cmp_eq_u32 vcc, 320, v22
    s_and_saveexec_b64 s[40:41], vcc
    v_cmp_eq_u32 vcc, 320, v22
    s_nop 1
    v_cndmask_b32 v17, v17, 0, vcc
    v_lshlrev_b32 v23, 3, v22
    v_add_u32 v23, v23, v4
    ds_write_b64 v23, v[16:17]
    s_waitcnt lgkmcnt(0)
    s_mov_b64 exec, s[40:41]
    s_barrier
    s_mul_i32 s27, s26, 2576
    v_lshlrev_b32 v5, 3, v1
    v_add_u32 v5, s27, v5
    s_mov_b32 s42, -1
    s_mov_b32 s43, 0xff
    s_mov_b64 exec, s[42:43]
    v_lshlrev_b32 v6, 3, v1
    v_sub_u32 v6, 320, v6
    v_add_u32 v6, s27, v6
    ds_read_b64 v[8:9], v5 offset:0
    ds_read_b64 v[10:11], v5 offset:320
    ds_read_b64 v[12:13], v5 offset:640
    ds_read_b64 v[14:15], v5 offset:960
    ds_read_b64 v[16:17], v5 offset:1280
    ds_read_b64 v[18:19], v5 offset:1600
    ds_read_b64 v[20:21], v5 offset:1920
    ds_read_b64 v[22:23], v5 offset:2240
    s_waitcnt lgkmcnt(0)
    ds_read_b64 v[24:25], v6 offset:2240
    ds_read_b64 v[26:27], v6 offset:1920
    ds_read_b64 v[28:29], v6 offset:1600
    ds_read_b64 v[30:31], v6 offset:1280
    ds_read_b64 v[32:33], v6 offset:960
    ds_read_b64 v[34:35], v6 offset:640
    ds_read_b64 v[36:37], v6 offset:320
    ds_read_b64 v[38:39], v6 offset:0
    s_waitcnt lgkmcnt(0)
    v_add_f32 v7, v8, v24
    v_sub_f32 v40, v9, v25
    v_sub_f32 v41, v8, v24
    v_add_f32 v42, v9, v25
    v_add_u32 v43, 0, v1
    v_cvt_f32_u32 v43, v43
    v_mul_f32 v43, 0x3acccccd, v43
    v_cos_f32 v44, v43
    v_sin_f32 v45, v43
    s_nop 0
    v_fma_f32 v7, -v45, v41, v7
    v_fma_f32 v7, -v44, v42, v7
    v_fma_f32 v40, -v45, v42, v40
    v_fma_f32 v40, v44, v41, v40
    v_add_f32 v8, v10, v26
    v_sub_f32 v9, v11, v27
    v_sub_f32 v24, v10, v26
    v_add_f32 v25, v11, v27
    v_add_u32 v41, 40, v1
    v_cvt_f32_u32 v41, v41
    v_mul_f32 v41, 0x3acccccd, v41
    v_cos_f32 v42, v41
    v_sin_f32 v43, v41
    s_nop 0
    v_fma_f32 v8, -v43, v24, v8
    v_fma_f32 v8, -v42, v25, v8
    v_fma_f32 v9, -v43, v25, v9
    v_fma_f32 v9, v42, v24, v9
    v_add_f32 v10, v12, v28
    v_sub_f32 v11, v13, v29
    v_sub_f32 v24, v12, v28
    v_add_f32 v25, v13, v29
    v_add_u32 v26, 80, v1
    v_cvt_f32_u32 v26, v26
    v_mul_f32 v26, 0x3acccccd, v26
    v_cos_f32 v27, v26
    v_sin_f32 v41, v26
    s_nop 0
    v_fma_f32 v10, -v41, v24, v10
    v_fma_f32 v10, -v27, v25, v10
    v_fma_f32 v11, -v41, v25, v11
    v_fma_f32 v11, v27, v24, v11
    v_add_f32 v12, v14, v30
    v_sub_f32 v13, v15, v31
    v_sub_f32 v24, v14, v30
    v_add_f32 v25, v15, v31
    v_add_u32 v26, 120, v1
    v_cvt_f32_u32 v26, v26
    v_mul_f32 v26, 0x3acccccd, v26
    v_cos_f32 v27, v26
    v_sin_f32 v28, v26
    s_nop 0
    v_fma_f32 v12, -v28, v24, v12
    v_fma_f32 v12, -v27, v25, v12
    v_fma_f32 v13, -v28, v25, v13
    v_fma_f32 v13, v27, v24, v13
    v_add_f32 v14, v16, v32
    v_sub_f32 v15, v17, v33
    v_sub_f32 v24, v16, v32
    v_add_f32 v25, v17, v33
    v_add_u32 v26, 160, v1
    v_cvt_f32_u32 v26, v26
    v_mul_f32 v26, 0x3acccccd, v26
    v_cos_f32 v27, v26
    v_sin_f32 v28, v26
    s_nop 0
    v_fma_f32 v14, -v28, v24, v14
    v_fma_f32 v14, -v27, v25, v14
    v_fma_f32 v15, -v28, v25, v15
    v_fma_f32 v15, v27, v24, v15
    v_add_f32 v16, v18, v34
    v_sub_f32 v17, v19, v35
    v_sub_f32 v24, v18, v34
    v_add_f32 v25, v19, v35
    v_add_u32 v26, 200, v1
    v_cvt_f32_u32 v26, v26
    v_mul_f32 v26, 0x3acccccd, v26
    v_cos_f32 v27, v26
    v_sin_f32 v28, v26
    s_nop 0
    v_fma_f32 v16, -v28, v24, v16
    v_fma_f32 v16, -v27, v25, v16
    v_fma_f32 v17, -v28, v25, v17
    v_fma_f32 v17, v27, v24, v17
    v_add_f32 v18, v20, v36
    v_sub_f32 v19, v21, v37
    v_sub_f32 v24, v20, v36
    v_add_f32 v25, v21, v37
    v_add_u32 v26, 240, v1
    v_cvt_f32_u32 v26, v26
    v_mul_f32 v26, 0x3acccccd, v26
    v_cos_f32 v27, v26
    v_sin_f32 v28, v26
    s_nop 0
    v_fma_f32 v18, -v28, v24, v18
    v_fma_f32 v18, -v27, v25, v18
    v_fma_f32 v19, -v28, v25, v19
    v_fma_f32 v19, v27, v24, v19
    v_add_f32 v20, v22, v38
    v_sub_f32 v21, v23, v39
    v_sub_f32 v24, v22, v38
    v_add_f32 v25, v23, v39
    v_add_u32 v26, 280, v1
    v_cvt_f32_u32 v26, v26
    v_mul_f32 v26, 0x3acccccd, v26
    v_cos_f32 v27, v26
    v_sin_f32 v28, v26
    s_nop 0
    v_fma_f32 v20, -v28, v24, v20
    v_fma_f32 v20, -v27, v25, v20
    v_fma_f32 v21, -v28, v25, v21
    v_fma_f32 v21, v27, v24, v21
    v_add_f32 v22, v7, v14
    v_add_f32 v23, v40, v15
    v_sub_f32 v24, v7, v14
    v_sub_f32 v25, v40, v15
    v_add_f32 v26, v10, v18
    v_add_f32 v27, v11, v19
    v_sub_f32 v28, v10, v18
    v_sub_f32 v29, v11, v19
    v_add_f32 v7, v22, v26
    v_add_f32 v10, v23, v27
    v_sub_f32 v11, v22, v26
    v_sub_f32 v14, v23, v27
    v_sub_f32 v15, v24, v29
    v_add_f32 v18, v25, v28
    v_add_f32 v19, v24, v29
    v_sub_f32 v30, v25, v28
    v_add_f32 v22, v8, v16
    v_add_f32 v23, v9, v17
    v_sub_f32 v24, v8, v16
    v_sub_f32 v25, v9, v17
    v_add_f32 v26, v12, v20
    v_add_f32 v27, v13, v21
    v_sub_f32 v28, v12, v20
    v_sub_f32 v29, v13, v21
    v_add_f32 v8, v22, v26
    v_add_f32 v9, v23, v27
    v_sub_f32 v12, v22, v26
    v_sub_f32 v13, v23, v27
    v_sub_f32 v16, v24, v29
    v_add_f32 v17, v25, v28
    v_add_f32 v20, v24, v29
    v_sub_f32 v21, v25, v28
    v_sub_f32 v22, v16, v17
    v_add_f32 v23, v17, v16
    v_mul_f32 v22, 0x3f3504f3, v22
    v_mul_f32 v23, 0x3f3504f3, v23
    v_sub_f32 v16, v20, v21
    v_add_f32 v17, v21, v20
    v_mul_f32 v16, 0x3f3504f3, v16
    v_mul_f32 v17, 0x3f3504f3, v17
    v_add_f32 v20, v7, v8
    v_add_f32 v21, v10, v9
    v_sub_f32 v24, v7, v8
    v_sub_f32 v25, v10, v9
    v_add_f32 v26, v15, v22
    v_add_f32 v27, v18, v23
    v_sub_f32 v28, v15, v22
    v_sub_f32 v29, v18, v23
    v_sub_f32 v31, v11, v13
    v_add_f32 v32, v14, v12
    v_add_f32 v33, v11, v13
    v_sub_f32 v34, v14, v12
    v_sub_f32 v35, v19, v17
    v_add_f32 v36, v30, v16
    v_add_f32 v37, v19, v17
    v_sub_f32 v38, v30, v16
    v_lshlrev_b32 v7, 6, v1
    v_add_u32 v7, s27, v7
    v_mov_b32 v8, v20
    v_mov_b32 v9, v21
    ds_write_b64 v7, v[8:9] offset:0
    v_mov_b32 v8, v26
    v_mov_b32 v9, v27
    ds_write_b64 v7, v[8:9] offset:8
    v_mov_b32 v8, v31
    v_mov_b32 v9, v32
    ds_write_b64 v7, v[8:9] offset:16
    v_mov_b32 v8, v35
    v_mov_b32 v9, v36
    ds_write_b64 v7, v[8:9] offset:24
    v_mov_b32 v8, v24
    v_mov_b32 v9, v25
    ds_write_b64 v7, v[8:9] offset:32
    v_mov_b32 v8, v28
    v_mov_b32 v9, v29
    ds_write_b64 v7, v[8:9] offset:40
    v_mov_b32 v8, v33
    v_mov_b32 v9, v34
    ds_write_b64 v7, v[8:9] offset:48
    v_mov_b32 v8, v37
    v_mov_b32 v9, v38
    ds_write_b64 v7, v[8:9] offset:56
    s_waitcnt lgkmcnt(0)
    ds_read_b64 v[8:9], v5 offset:0
    ds_read_b64 v[10:11], v5 offset:320
    ds_read_b64 v[12:13], v5 offset:640
    ds_read_b64 v[14:15], v5 offset:960
    ds_read_b64 v[16:17], v5 offset:1280
    ds_read_b64 v[18:19], v5 offset:1600
    ds_read_b64 v[20:21], v5 offset:1920
    ds_read_b64 v[22:23], v5 offset:2240
    s_waitcnt lgkmcnt(0)
    v_and_b32 v24, 7, v1
    v_lshrrev_b32 v7, 3, v1
    v_lshlrev_b32 v7, 6, v7
    v_add_u32 v7, v7, v24
    v_lshlrev_b32 v7, 3, v7
    v_add_u32 v7, s27, v7
    v_cvt_f32_u32 v24, v24
    v_mul_f32 v24, 0x3c800000, v24
    v_mul_f32 v25, 0x3f800000, v24
    v_cos_f32 v26, v25
    v_sin_f32 v27, v25
    s_nop 0
    v_mul_f32 v28, v10, v26
    v_fma_f32 v28, -v11, v27, v28
    v_mul_f32 v29, v11, v26
    v_fma_f32 v29, v10, v27, v29
    v_mul_f32 v10, 0x40000000, v24
    v_cos_f32 v11, v10
    v_sin_f32 v25, v10
    s_nop 0
    v_mul_f32 v26, v12, v11
    v_fma_f32 v26, -v13, v25, v26
    v_mul_f32 v27, v13, v11
    v_fma_f32 v27, v12, v25, v27
    v_mul_f32 v10, 0x40400000, v24
    v_cos_f32 v11, v10
    v_sin_f32 v12, v10
    s_nop 0
    v_mul_f32 v13, v14, v11
    v_fma_f32 v13, -v15, v12, v13
    v_mul_f32 v25, v15, v11
    v_fma_f32 v25, v14, v12, v25
    v_mul_f32 v10, 0x40800000, v24
    v_cos_f32 v11, v10
    v_sin_f32 v12, v10
    s_nop 0
    v_mul_f32 v14, v16, v11
    v_fma_f32 v14, -v17, v12, v14
    v_mul_f32 v15, v17, v11
    v_fma_f32 v15, v16, v12, v15
    v_mul_f32 v10, 0x40a00000, v24
    v_cos_f32 v11, v10
    v_sin_f32 v12, v10
    s_nop 0
    v_mul_f32 v16, v18, v11
    v_fma_f32 v16, -v19, v12, v16
    v_mul_f32 v17, v19, v11
    v_fma_f32 v17, v18, v12, v17
    v_mul_f32 v10, 0x40c00000, v24
    v_cos_f32 v11, v10
    v_sin_f32 v12, v10
    s_nop 0
    v_mul_f32 v18, v20, v11
    v_fma_f32 v18, -v21, v12, v18
    v_mul_f32 v19, v21, v11
    v_fma_f32 v19, v20, v12, v19
    v_mul_f32 v10, 0x40e00000, v24
    v_cos_f32 v11, v10
    v_sin_f32 v12, v10
    s_nop 0
    v_mul_f32 v20, v22, v11
    v_fma_f32 v20, -v23, v12, v20
    v_mul_f32 v21, v23, v11
    v_fma_f32 v21, v22, v12, v21
    v_add_f32 v10, v8, v14
    v_add_f32 v11, v9, v15
    v_sub_f32 v12, v8, v14
    v_sub_f32 v22, v9, v15
    v_add_f32 v23, v26, v18
    v_add_f32 v30, v27, v19
    v_sub_f32 v31, v26, v18
    v_sub_f32 v32, v27, v19
    v_add_f32 v8, v10, v23
    v_add_f32 v9, v11, v30
    v_sub_f32 v14, v10, v23
    v_sub_f32 v15, v11, v30
    v_sub_f32 v18, v12, v32
    v_add_f32 v19, v22, v31
    v_add_f32 v26, v12, v32
    v_sub_f32 v27, v22, v31
    v_add_f32 v10, v28, v16
    v_add_f32 v11, v29, v17
    v_sub_f32 v12, v28, v16
    v_sub_f32 v22, v29, v17
    v_add_f32 v23, v13, v20
    v_add_f32 v30, v25, v21
    v_sub_f32 v31, v13, v20
    v_sub_f32 v32, v25, v21
    v_add_f32 v13, v10, v23
    v_add_f32 v16, v11, v30
    v_sub_f32 v17, v10, v23
    v_sub_f32 v20, v11, v30
    v_sub_f32 v21, v12, v32
    v_add_f32 v25, v22, v31
    v_add_f32 v28, v12, v32
    v_sub_f32 v29, v22, v31
    v_sub_f32 v10, v21, v25
    v_add_f32 v11, v25, v21
    v_mul_f32 v10, 0x3f3504f3, v10
    v_mul_f32 v11, 0x3f3504f3, v11
    v_sub_f32 v12, v28, v29
    v_add_f32 v21, v29, v28
    v_mul_f32 v12, 0x3f3504f3, v12
    v_mul_f32 v21, 0x3f3504f3, v21
    v_add_f32 v22, v8, v13
    v_add_f32 v23, v9, v16
    v_sub_f32 v25, v8, v13
    v_sub_f32 v28, v9, v16
    v_add_f32 v29, v18, v10
    v_add_f32 v30, v19, v11
    v_sub_f32 v31, v18, v10
    v_sub_f32 v32, v19, v11
    v_sub_f32 v33, v14, v20
    v_add_f32 v34, v15, v17
    v_add_f32 v35, v14, v20
    v_sub_f32 v36, v15, v17
    v_sub_f32 v37, v26, v21
    v_add_f32 v38, v27, v12
    v_add_f32 v39, v26, v21
    v_sub_f32 v40, v27, v12
    v_mov_b32 v8, v22
    v_mov_b32 v9, v23
    ds_write_b64 v7, v[8:9] offset:0
    v_mov_b32 v8, v29
    v_mov_b32 v9, v30
    ds_write_b64 v7, v[8:9] offset:64
    v_mov_b32 v8, v33
    v_mov_b32 v9, v34
    ds_write_b64 v7, v[8:9] offset:128
    v_mov_b32 v8, v37
    v_mov_b32 v9, v38
    ds_write_b64 v7, v[8:9] offset:192
    v_mov_b32 v8, v25
    v_mov_b32 v9, v28
    ds_write_b64 v7, v[8:9] offset:256
    v_mov_b32 v8, v31
    v_mov_b32 v9, v32
    ds_write_b64 v7, v[8:9] offset:320
    v_mov_b32 v8, v35
    v_mov_b32 v9, v36
    ds_write_b64 v7, v[8:9] offset:384
    v_mov_b32 v8, v39
    v_mov_b32 v9, v40
    ds_write_b64 v7, v[8:9] offset:448
    s_mov_b64 exec, s[40:41]
    s_waitcnt lgkmcnt(0)
    ds_read_b64 v[8:9], v5 offset:0
    ds_read_b64 v[10:11], v5 offset:512
    ds_read_b64 v[12:13], v5 offset:1024
    ds_read_b64 v[14:15], v5 offset:1536
    ds_read_b64 v[16:17], v5 offset:2048
    s_waitcnt lgkmcnt(0)
    v_mov_b32 v24, v1
    v_cvt_f32_u32 v24, v24
    v_mul_f32 v24, 0x3b4ccccd, v24
    v_mul_f32 v18, 0x3f800000, v24
    v_cos_f32 v19, v18
    v_sin_f32 v20, v18
    s_nop 0
    v_mul_f32 v21, v10, v19
    v_fma_f32 v21, -v11, v20, v21
    v_mul_f32 v22, v11, v19
    v_fma_f32 v22, v10, v20, v22
    v_mul_f32 v10, 0x40000000, v24
    v_cos_f32 v11, v10
    v_sin_f32 v18, v10
    s_nop 0
    v_mul_f32 v19, v12, v11
    v_fma_f32 v19, -v13, v18, v19
    v_mul_f32 v20, v13, v11
    v_fma_f32 v20, v12, v18, v20
    v_mul_f32 v10, 0x40400000, v24
    v_cos_f32 v11, v10
    v_sin_f32 v12, v10
    s_nop 0
    v_mul_f32 v13, v14, v11
    v_fma_f32 v13, -v15, v12, v13
    v_mul_f32 v18, v15, v11
    v_fma_f32 v18, v14, v12, v18
    v_mul_f32 v10, 0x40800000, v24
    v_cos_f32 v11, v10
    v_sin_f32 v12, v10
    s_nop 0
    v_mul_f32 v14, v16, v11
    v_fma_f32 v14, -v17, v12, v14
    v_mul_f32 v15, v17, v11
    v_fma_f32 v15, v16, v12, v15
    v_add_f32 v10, v21, v14
    v_add_f32 v11, v22, v15
    v_add_f32 v12, v19, v13
    v_add_f32 v16, v20, v18
    v_sub_f32 v17, v21, v14
    v_sub_f32 v23, v22, v15
    v_sub_f32 v25, v19, v13
    v_sub_f32 v26, v20, v18
    v_add_f32 v27, v8, v10
    v_add_f32 v28, v9, v11
    v_add_f32 v29, v27, v12
    v_add_f32 v30, v28, v16
    v_mov_b32 v27, v8
    v_fmac_f32 v27, 0x3e9e377a, v10
    v_fmac_f32 v27, 0xbf4f1bbd, v12
    v_mov_b32 v31, v8
    v_fmac_f32 v31, 0xbf4f1bbd, v10
    v_fmac_f32 v31, 0x3e9e377a, v12
    v_mul_f32 v33, 0x3f737871, v17
    v_fmac_f32 v33, 0x3f167918, v25
    v_mul_f32 v35, 0x3f167918, v17
    v_fmac_f32 v35, 0xbf737871, v25
    v_mov_b32 v28, v9
    v_fmac_f32 v28, 0x3e9e377a, v11
    v_fmac_f32 v28, 0xbf4f1bbd, v16
    v_mov_b32 v32, v9
    v_fmac_f32 v32, 0xbf4f1bbd, v11
    v_fmac_f32 v32, 0x3e9e377a, v16
    v_mul_f32 v34, 0x3f737871, v23
    v_fmac_f32 v34, 0x3f167918, v26
    v_mul_f32 v36, 0x3f167918, v23
    v_fmac_f32 v36, 0xbf737871, v26
    v_sub_f32 v8, v27, v34
    v_add_f32 v9, v28, v33
    v_add_f32 v10, v27, v34
    v_sub_f32 v11, v28, v33
    v_sub_f32 v12, v31, v36
    v_add_f32 v13, v32, v35
    v_add_f32 v14, v31, v36
    v_sub_f32 v15, v32, v35
    s_lshl_b32 s27, s2, 3
    s_add_u32 s27, s27, s26
    s_mul_i32 s27, s27, 1280
    v_lshlrev_b32 v16, 2, v1
    buffer_load_dword v17, v16, s[28:31], s27 offen offset:0
    buffer_load_dword v18, v16, s[28:31], s27 offen offset:256
    buffer_load_dword v19, v16, s[28:31], s27 offen offset:512
    buffer_load_dword v20, v16, s[28:31], s27 offen offset:768
    buffer_load_dword v21, v16, s[28:31], s27 offen offset:1024
    s_waitcnt vmcnt(0)
    v_cvt_pk_bf16_f32 v29, v29, v29
    v_lshlrev_b32 v29, 16, v29
    v_cvt_pk_bf16_f32 v30, v30, v30
    v_lshlrev_b32 v30, 16, v30
    v_lshlrev_b32 v22, 16, v17
    v_add_f32 v29, v29, v22
    v_and_b32 v22, 0xffff0000, v17
    v_add_f32 v30, v30, v22
    v_cvt_pk_bf16_f32 v17, v29, v30
    buffer_store_dword v17, v16, s[36:39], s27 offen offset:0
    v_lshlrev_b32 v29, 16, v17
    v_and_b32 v30, 0xffff0000, v17
    v_cvt_pk_bf16_f32 v8, v8, v8
    v_lshlrev_b32 v8, 16, v8
    v_cvt_pk_bf16_f32 v9, v9, v9
    v_lshlrev_b32 v9, 16, v9
    v_lshlrev_b32 v22, 16, v18
    v_add_f32 v8, v8, v22
    v_and_b32 v22, 0xffff0000, v18
    v_add_f32 v9, v9, v22
    v_cvt_pk_bf16_f32 v18, v8, v9
    buffer_store_dword v18, v16, s[36:39], s27 offen offset:256
    v_lshlrev_b32 v8, 16, v18
    v_and_b32 v9, 0xffff0000, v18
    v_cvt_pk_bf16_f32 v12, v12, v12
    v_lshlrev_b32 v12, 16, v12
    v_cvt_pk_bf16_f32 v13, v13, v13
    v_lshlrev_b32 v13, 16, v13
    v_lshlrev_b32 v22, 16, v19
    v_add_f32 v12, v12, v22
    v_and_b32 v22, 0xffff0000, v19
    v_add_f32 v13, v13, v22
    v_cvt_pk_bf16_f32 v19, v12, v13
    buffer_store_dword v19, v16, s[36:39], s27 offen offset:512
    v_lshlrev_b32 v12, 16, v19
    v_and_b32 v13, 0xffff0000, v19
    v_cvt_pk_bf16_f32 v14, v14, v14
    v_lshlrev_b32 v14, 16, v14
    v_cvt_pk_bf16_f32 v15, v15, v15
    v_lshlrev_b32 v15, 16, v15
    v_lshlrev_b32 v22, 16, v20
    v_add_f32 v14, v14, v22
    v_and_b32 v22, 0xffff0000, v20
    v_add_f32 v15, v15, v22
    v_cvt_pk_bf16_f32 v20, v14, v15
    buffer_store_dword v20, v16, s[36:39], s27 offen offset:768
    v_lshlrev_b32 v14, 16, v20
    v_and_b32 v15, 0xffff0000, v20
    v_cvt_pk_bf16_f32 v10, v10, v10
    v_lshlrev_b32 v10, 16, v10
    v_cvt_pk_bf16_f32 v11, v11, v11
    v_lshlrev_b32 v11, 16, v11
    v_lshlrev_b32 v22, 16, v21
    v_add_f32 v10, v10, v22
    v_and_b32 v22, 0xffff0000, v21
    v_add_f32 v11, v11, v22
    v_cvt_pk_bf16_f32 v21, v10, v11
    buffer_store_dword v21, v16, s[36:39], s27 offen offset:1024
    v_lshlrev_b32 v10, 16, v21
    v_and_b32 v11, 0xffff0000, v21
    v_add_f32 v22, v29, v30
    v_add_f32 v22, v22, v8
    v_add_f32 v22, v22, v9
    v_add_f32 v22, v22, v12
    v_add_f32 v22, v22, v13
    v_add_f32 v22, v22, v14
    v_add_f32 v22, v22, v15
    v_add_f32 v22, v22, v10
    v_add_f32 v22, v22, v11
    ds_swizzle_b32 v26, v22 offset:0x41f
    s_waitcnt lgkmcnt(0)
    v_add_f32 v22, v22, v26
    ds_swizzle_b32 v26, v22 offset:0x81f
    s_waitcnt lgkmcnt(0)
    v_add_f32 v22, v22, v26
    ds_swizzle_b32 v26, v22 offset:0x101f
    s_waitcnt lgkmcnt(0)
    v_add_f32 v22, v22, v26
    ds_swizzle_b32 v26, v22 offset:0x201f
    s_waitcnt lgkmcnt(0)
    v_add_f32 v22, v22, v26
    ds_swizzle_b32 v26, v22 offset:0x401f
    s_waitcnt lgkmcnt(0)
    v_add_f32 v22, v22, v26
    s_nop 1
    v_readlane_b32 s60, v22, 32
    s_nop 3
    v_add_f32 v22, s60, v22
    s_nop 1
    v_readlane_b32 s60, v22, 0
    s_nop 3
    v_mov_b32 v25, s60
    v_mul_f32 v25, 0x3acccccd, v25
    v_mov_b32 v22, 0
    v_sub_f32 v23, v29, v25
    v_fmac_f32 v22, v23, v23
    v_sub_f32 v23, v30, v25
    v_fmac_f32 v22, v23, v23
    v_sub_f32 v23, v8, v25
    v_fmac_f32 v22, v23, v23
    v_sub_f32 v23, v9, v25
    v_fmac_f32 v22, v23, v23
    v_sub_f32 v23, v12, v25
    v_fmac_f32 v22, v23, v23
    v_sub_f32 v23, v13, v25
    v_fmac_f32 v22, v23, v23
    v_sub_f32 v23, v14, v25
    v_fmac_f32 v22, v23, v23
    v_sub_f32 v23, v15, v25
    v_fmac_f32 v22, v23, v23
    v_sub_f32 v23, v10, v25
    v_fmac_f32 v22, v23, v23
    v_sub_f32 v23, v11, v25
    v_fmac_f32 v22, v23, v23
    ds_swizzle_b32 v26, v22 offset:0x41f
    s_waitcnt lgkmcnt(0)
    v_add_f32 v22, v22, v26
    ds_swizzle_b32 v26, v22 offset:0x81f
    s_waitcnt lgkmcnt(0)
    v_add_f32 v22, v22, v26
    ds_swizzle_b32 v26, v22 offset:0x101f
    s_waitcnt lgkmcnt(0)
    v_add_f32 v22, v22, v26
    ds_swizzle_b32 v26, v22 offset:0x201f
    s_waitcnt lgkmcnt(0)
    v_add_f32 v22, v22, v26
    ds_swizzle_b32 v26, v22 offset:0x401f
    s_waitcnt lgkmcnt(0)
    v_add_f32 v22, v22, v26
    s_nop 1
    v_readlane_b32 s60, v22, 32
    s_nop 3
    v_add_f32 v22, s60, v22
    s_nop 1
    v_readlane_b32 s60, v22, 0
    s_nop 3
    v_mov_b32 v22, s60
    v_mul_f32 v22, 0x3acccccd, v22
    v_cvt_pk_bf16_f32 v25, v25, v25
    v_lshlrev_b32 v25, 16, v25
    v_cvt_pk_bf16_f32 v22, v22, v22
    v_lshlrev_b32 v22, 16, v22
    v_add_f32 v22, 0x3727c5ac, v22
    v_cvt_pk_bf16_f32 v22, v22, v22
    v_lshlrev_b32 v22, 16, v22
    v_sqrt_f32 v22, v22
    s_nop 0
    v_cvt_pk_bf16_f32 v22, v22, v22
    v_lshlrev_b32 v22, 16, v22
    v_rcp_f32 v22, v22
    s_nop 0
    v_sub_f32 v29, v29, v25
    v_cvt_pk_bf16_f32 v29, v29, v29
    v_lshlrev_b32 v29, 16, v29
    v_mul_f32 v29, v29, v22
    v_cvt_pk_bf16_f32 v29, v29, v29
    v_lshlrev_b32 v29, 16, v29
    v_sub_f32 v30, v30, v25
    v_cvt_pk_bf16_f32 v30, v30, v30
    v_lshlrev_b32 v30, 16, v30
    v_mul_f32 v30, v30, v22
    v_cvt_pk_bf16_f32 v30, v30, v30
    v_lshlrev_b32 v30, 16, v30
    v_sub_f32 v8, v8, v25
    v_cvt_pk_bf16_f32 v8, v8, v8
    v_lshlrev_b32 v8, 16, v8
    v_mul_f32 v8, v8, v22
    v_cvt_pk_bf16_f32 v8, v8, v8
    v_lshlrev_b32 v8, 16, v8
    v_sub_f32 v9, v9, v25
    v_cvt_pk_bf16_f32 v9, v9, v9
    v_lshlrev_b32 v9, 16, v9
    v_mul_f32 v9, v9, v22
    v_cvt_pk_bf16_f32 v9, v9, v9
    v_lshlrev_b32 v9, 16, v9
    v_sub_f32 v12, v12, v25
    v_cvt_pk_bf16_f32 v12, v12, v12
    v_lshlrev_b32 v12, 16, v12
    v_mul_f32 v12, v12, v22
    v_cvt_pk_bf16_f32 v12, v12, v12
    v_lshlrev_b32 v12, 16, v12
    v_sub_f32 v13, v13, v25
    v_cvt_pk_bf16_f32 v13, v13, v13
    v_lshlrev_b32 v13, 16, v13
    v_mul_f32 v13, v13, v22
    v_cvt_pk_bf16_f32 v13, v13, v13
    v_lshlrev_b32 v13, 16, v13
    v_sub_f32 v14, v14, v25
    v_cvt_pk_bf16_f32 v14, v14, v14
    v_lshlrev_b32 v14, 16, v14
    v_mul_f32 v14, v14, v22
    v_cvt_pk_bf16_f32 v14, v14, v14
    v_lshlrev_b32 v14, 16, v14
    v_sub_f32 v15, v15, v25
    v_cvt_pk_bf16_f32 v15, v15, v15
    v_lshlrev_b32 v15, 16, v15
    v_mul_f32 v15, v15, v22
    v_cvt_pk_bf16_f32 v15, v15, v15
    v_lshlrev_b32 v15, 16, v15
    v_sub_f32 v10, v10, v25
    v_cvt_pk_bf16_f32 v10, v10, v10
    v_lshlrev_b32 v10, 16, v10
    v_mul_f32 v10, v10, v22
    v_cvt_pk_bf16_f32 v10, v10, v10
    v_lshlrev_b32 v10, 16, v10
    v_sub_f32 v11, v11, v25
    v_cvt_pk_bf16_f32 v11, v11, v11
    v_lshlrev_b32 v11, 16, v11
    v_mul_f32 v11, v11, v22
    v_cvt_pk_bf16_f32 v11, v11, v11
    v_lshlrev_b32 v11, 16, v11
    s_nop 2
    v_cvt_pk_bf16_f32 v22, v29, v30
    buffer_store_dword v22, v16, s[44:47], s27 offen offset:0
    v_cvt_pk_bf16_f32 v23, v8, v9
    buffer_store_dword v23, v16, s[44:47], s27 offen offset:256
    v_cvt_pk_bf16_f32 v25, v12, v13
    buffer_store_dword v25, v16, s[44:47], s27 offen offset:512
    v_cvt_pk_bf16_f32 v26, v14, v15
    buffer_store_dword v26, v16, s[44:47], s27 offen offset:768
    v_cvt_pk_bf16_f32 v27, v10, v11
    buffer_store_dword v27, v16, s[44:47], s27 offen offset:1024
L_end_ri1_kernel:
    s_endpgm
.globl g1a_kernel
.p2align 8
.type g1a_kernel,@function
g1a_kernel:
    s_cmp_ge_u32 s2, 256
    s_cbranch_scc1 L_end_g1a_kernel
    s_load_dwordx16 s[4:19], s[0:1], 0
    s_load_dwordx4 s[20:23], s[0:1], 64
    s_load_dwordx2 s[24:25], s[0:1], 80
    s_waitcnt lgkmcnt(0)
    s_add_u32 s28, s24, 0x1200000
    s_addc_u32 s29, s25, 0
    s_mov_b32 s30, 0x280000
    s_mov_b32 s31, 0x00020000
    s_add_u32 s32, s24, 0x900000
    s_addc_u32 s33, s25, 0
    s_mov_b32 s34, 0x21c000
    s_mov_b32 s35, 0x00020000
    s_add_u32 s36, s24, 0x1500000
    s_addc_u32 s37, s25, 0
    s_mov_b32 s38, 0x6c0000
    s_mov_b32 s39, 0x00020000
    s_add_u32 s44, s14, 0x0
    s_addc_u32 s45, s15, 0
    s_mov_b32 s46, 0xd80
    s_mov_b32 s47, 0x00020000
    v_and_b32 v1, 63, v0
    v_lshrrev_b32 v2, 6, v0
    s_nop 1
    v_readfirstlane_b32 s26, v2
    s_nop 3
    s_and_b32 s27, s2, 31
    s_lshr_b32 s40, s2, 5
    s_mul_i32 s40, s40, 27
    s_lshr_b32 s40, s40, 1
    s_lshl_b32 s40, s40, 4
    v_and_b32 v2, 15, v1
    v_lshrrev_b32 v3, 4, v1
    v_lshrrev_b32 v6, 3, v0
    v_and_b32 v7, 7, v0
    v_lshlrev_b32 v7, 4, v7
    v_mul_u32_u24 v4, 1280, v6
    v_add_u32 v4, v4, v7
    v_mul_u32_u24 v5, 144, v6
    v_add_u32 v5, v5, v7
    v_add_u32 v8, 41472, v5
    s_mul_i32 s52, s27, 81920
    s_add_u32 s53, s52, 40960
    s_mul_i32 s54, s40, 1280
    s_add_u32 s55, s54, 40960
    s_add_u32 s56, s54, 81920
    s_add_u32 s57, s54, 122880
    s_add_u32 s58, s54, 163840
    s_add_u32 s59, s54, 204800
    s_add_u32 s60, s54, 245760
    v_lshlrev_b32 v7, 4, v3
    v_mul_u32_u24 v10, 144, v2
    v_add_u32 v10, v10, v7
    s_mul_i32 s41, s26, 2304
    v_add_u32 v9, s41, v10
    v_add_u32 v10, 9216, v10
    v_add_u32 v11, 41472, v9
    v_add_u32 v12, 41472, v10
    v_mov_b32 v16, 0
    v_mov_b32 v17, 0
    v_mov_b32 v18, 0
    v_mov_b32 v19, 0
    v_mov_b32 v20, 0
    v_mov_b32 v21, 0
    v_mov_b32 v22, 0
    v_mov_b32 v23, 0
    v_mov_b32 v24, 0
    v_mov_b32 v25, 0
    v_mov_b32 v26, 0
    v_mov_b32 v27, 0
    v_mov_b32 v28, 0
    v_mov_b32 v29, 0
    v_mov_b32 v30, 0
    v_mov_b32 v31, 0
    v_mov_b32 v32, 0
    v_mov_b32 v33, 0
    v_mov_b32 v34, 0
    v_mov_b32 v35, 0
    v_mov_b32 v36, 0
    v_mov_b32 v37, 0
    v_mov_b32 v38, 0
    v_mov_b32 v39, 0
    v_mov_b32 v40, 0
    v_mov_b32 v41, 0
    v_mov_b32 v42, 0
    v_mov_b32 v43, 0
    v_mov_b32 v44, 0
    v_mov_b32 v45, 0
    v_mov_b32 v46, 0
    v_mov_b32 v47, 0
    v_mov_b32 v48, 0
    v_mov_b32 v49, 0
    v_mov_b32 v50, 0
    v_mov_b32 v51, 0
    v_mov_b32 v52, 0
    v_mov_b32 v53, 0
    v_mov_b32 v54, 0
    v_mov_b32 v55, 0
    v_mov_b32 v56, 0
    v_mov_b32 v57, 0
    v_mov_b32 v58, 0
    v_mov_b32 v59, 0
    v_mov_b32 v60, 0
    v_mov_b32 v61, 0
    v_mov_b32 v62, 0
    v_mov_b32 v63, 0
    v_mov_b32 v64, 0
    v_mov_b32 v65, 0
    v_mov_b32 v66, 0
    v_mov_b32 v67, 0
    v_mov_b32 v68, 0
    v_mov_b32 v69, 0
    v_mov_b32 v70, 0
    v_mov_b32 v71, 0
    buffer_load_dwordx4 v[72:75], v4, s[28:31], s52 offen offset:0
    buffer_load_dwordx4 v[76:79], v4, s[28:31], s53 offen offset:0
    buffer_load_dwordx4 v[80:83], v4, s[32:35], s54 offen offset:0
    buffer_load_dwordx4 v[84:87], v4, s[32:35], s55 offen offset:0
    buffer_load_dwordx4 v[88:91], v4, s[32:35], s56 offen offset:0
    buffer_load_dwordx4 v[92:95], v4, s[32:35], s57 offen offset:0
    buffer_load_dwordx4 v[96:99], v4, s[32:35], s58 offen offset:0
    buffer_load_dwordx4 v[100:103], v4, s[32:35], s59 offen offset:0
    buffer_load_dwordx4 v[104:107], v4, s[32:35], s60 offen offset:0
    buffer_load_dwordx4 v[108:111], v4, s[28:31], s52 offen offset:128
    buffer_load_dwordx4 v[112:115], v4, s[28:31], s53 offen offset:128
    buffer_load_dwordx4 v[116:119], v4, s[32:35], s54 offen offset:128
    buffer_load_dwordx4 v[120:123], v4, s[32:35], s55 offen offset:128
    buffer_load_dwordx4 v[124:127], v4, s[32:35], s56 offen offset:128
    buffer_load_dwordx4 v[128:131], v4, s[32:35], s57 offen offset:128
    buffer_load_dwordx4 v[132:135], v4, s[32:35], s58 offen offset:128
    buffer_load_dwordx4 v[136:139], v4, s[32:35], s59 offen offset:128
    buffer_load_dwordx4 v[140:143], v4, s[32:35], s60 offen offset:128
    s_waitcnt vmcnt(9)
    ds_write_b128 v5, v[72:75] offset:0
    ds_write_b128 v5, v[76:79] offset:4608
    ds_write_b128 v5, v[80:83] offset:9216
    ds_write_b128 v5, v[84:87] offset:13824
    ds_write_b128 v5, v[88:91] offset:18432
    ds_write_b128 v5, v[92:95] offset:23040
    ds_write_b128 v5, v[96:99] offset:27648
    ds_write_b128 v5, v[100:103] offset:32256
    ds_write_b128 v5, v[104:107] offset:36864
    s_waitcnt lgkmcnt(0)
    s_barrier
    s_mov_b32 s62, 0
L_loop_g1a_kernel:
    buffer_load_dwordx4 v[72:75], v4, s[28:31], s52 offen offset:256
    buffer_load_dwordx4 v[76:79], v4, s[28:31], s53 offen offset:256
    buffer_load_dwordx4 v[80:83], v4, s[32:35], s54 offen offset:256
    buffer_load_dwordx4 v[84:87], v4, s[32:35], s55 offen offset:256
    buffer_load_dwordx4 v[88:91], v4, s[32:35], s56 offen offset:256
    buffer_load_dwordx4 v[92:95], v4, s[32:35], s57 offen offset:256
    buffer_load_dwordx4 v[96:99], v4, s[32:35], s58 offen offset:256
    buffer_load_dwordx4 v[100:103], v4, s[32:35], s59 offen offset:256
    buffer_load_dwordx4 v[104:107], v4, s[32:35], s60 offen offset:256
    ds_read_b128 v[144:147], v9 offset:0
    ds_read_b128 v[148:151], v10 offset:0
    ds_read_b128 v[152:155], v10 offset:2304
    ds_read_b128 v[156:159], v10 offset:4608
    ds_read_b128 v[160:163], v10 offset:6912
    ds_read_b128 v[164:167], v10 offset:9216
    ds_read_b128 v[168:171], v10 offset:11520
    ds_read_b128 v[172:175], v10 offset:13824
    ds_read_b128 v[176:179], v10 offset:16128
    ds_read_b128 v[180:183], v10 offset:18432
    ds_read_b128 v[184:187], v10 offset:20736
    ds_read_b128 v[188:191], v10 offset:23040
    ds_read_b128 v[192:195], v10 offset:25344
    ds_read_b128 v[196:199], v10 offset:27648
    ds_read_b128 v[200:203], v10 offset:29952
    s_waitcnt lgkmcnt(13)
    v_mfma_f32_16x16x32_bf16 v[16:19], v[148:151], v[144:147], v[16:19]
    s_waitcnt lgkmcnt(12)
    v_mfma_f32_16x16x32_bf16 v[20:23], v[152:155], v[144:147], v[20:23]
    s_waitcnt lgkmcnt(11)
    v_mfma_f32_16x16x32_bf16 v[24:27], v[156:159], v[144:147], v[24:27]
    s_waitcnt lgkmcnt(10)
    v_mfma_f32_16x16x32_bf16 v[28:31], v[160:163], v[144:147], v[28:31]
    s_waitcnt lgkmcnt(9)
    v_mfma_f32_16x16x32_bf16 v[32:35], v[164:167], v[144:147], v[32:35]
    s_waitcnt lgkmcnt(8)
    v_mfma_f32_16x16x32_bf16 v[36:39], v[168:171], v[144:147], v[36:39]
    s_waitcnt lgkmcnt(7)
    v_mfma_f32_16x16x32_bf16 v[40:43], v[172:175], v[144:147], v[40:43]
    s_waitcnt lgkmcnt(6)
    v_mfma_f32_16x16x32_bf16 v[44:47], v[176:179], v[144:147], v[44:47]
    s_waitcnt lgkmcnt(5)
    v_mfma_f32_16x16x32_bf16 v[48:51], v[180:183], v[144:147], v[48:51]
    s_waitcnt lgkmcnt(4)
    v_mfma_f32_16x16x32_bf16 v[52:55], v[184:187], v[144:147], v[52:55]
    s_waitcnt lgkmcnt(3)
    v_mfma_f32_16x16x32_bf16 v[56:59], v[188:191], v[144:147], v[56:59]
    s_waitcnt lgkmcnt(2)
    v_mfma_f32_16x16x32_bf16 v[60:63], v[192:195], v[144:147], v[60:63]
    s_waitcnt lgkmcnt(1)
    v_mfma_f32_16x16x32_bf16 v[64:67], v[196:199], v[144:147], v[64:67]
    s_waitcnt lgkmcnt(0)
    v_mfma_f32_16x16x32_bf16 v[68:71], v[200:203], v[144:147], v[68:71]
    ds_read_b128 v[144:147], v9 offset:64
    ds_read_b128 v[148:151], v10 offset:64
    ds_read_b128 v[152:155], v10 offset:2368
    ds_read_b128 v[156:159], v10 offset:4672
    ds_read_b128 v[160:163], v10 offset:6976
    ds_read_b128 v[164:167], v10 offset:9280
    ds_read_b128 v[168:171], v10 offset:11584
    ds_read_b128 v[172:175], v10 offset:13888
    ds_read_b128 v[176:179], v10 offset:16192
    ds_read_b128 v[180:183], v10 offset:18496
    ds_read_b128 v[184:187], v10 offset:20800
    ds_read_b128 v[188:191], v10 offset:23104
    ds_read_b128 v[192:195], v10 offset:25408
    ds_read_b128 v[196:199], v10 offset:27712
    ds_read_b128 v[200:203], v10 offset:30016
    s_waitcnt lgkmcnt(13)
    v_mfma_f32_16x16x32_bf16 v[16:19], v[148:151], v[144:147], v[16:19]
    s_waitcnt lgkmcnt(12)
    v_mfma_f32_16x16x32_bf16 v[20:23], v[152:155], v[144:147], v[20:23]
    s_waitcnt lgkmcnt(11)
    v_mfma_f32_16x16x32_bf16 v[24:27], v[156:159], v[144:147], v[24:27]
    s_waitcnt lgkmcnt(10)
    v_mfma_f32_16x16x32_bf16 v[28:31], v[160:163], v[144:147], v[28:31]
    s_waitcnt lgkmcnt(9)
    v_mfma_f32_16x16x32_bf16 v[32:35], v[164:167], v[144:147], v[32:35]
    s_waitcnt lgkmcnt(8)
    v_mfma_f32_16x16x32_bf16 v[36:39], v[168:171], v[144:147], v[36:39]
    s_waitcnt lgkmcnt(7)
    v_mfma_f32_16x16x32_bf16 v[40:43], v[172:175], v[144:147], v[40:43]
    s_waitcnt lgkmcnt(6)
    v_mfma_f32_16x16x32_bf16 v[44:47], v[176:179], v[144:147], v[44:47]
    s_waitcnt lgkmcnt(5)
    v_mfma_f32_16x16x32_bf16 v[48:51], v[180:183], v[144:147], v[48:51]
    s_waitcnt lgkmcnt(4)
    v_mfma_f32_16x16x32_bf16 v[52:55], v[184:187], v[144:147], v[52:55]
    s_waitcnt lgkmcnt(3)
    v_mfma_f32_16x16x32_bf16 v[56:59], v[188:191], v[144:147], v[56:59]
    s_waitcnt lgkmcnt(2)
    v_mfma_f32_16x16x32_bf16 v[60:63], v[192:195], v[144:147], v[60:63]
    s_waitcnt lgkmcnt(1)
    v_mfma_f32_16x16x32_bf16 v[64:67], v[196:199], v[144:147], v[64:67]
    s_waitcnt lgkmcnt(0)
    v_mfma_f32_16x16x32_bf16 v[68:71], v[200:203], v[144:147], v[68:71]
    s_waitcnt vmcnt(9)
    ds_write_b128 v8, v[108:111] offset:0
    ds_write_b128 v8, v[112:115] offset:4608
    ds_write_b128 v8, v[116:119] offset:9216
    ds_write_b128 v8, v[120:123] offset:13824
    ds_write_b128 v8, v[124:127] offset:18432
    ds_write_b128 v8, v[128:131] offset:23040
    ds_write_b128 v8, v[132:135] offset:27648
    ds_write_b128 v8, v[136:139] offset:32256
    ds_write_b128 v8, v[140:143] offset:36864
    s_waitcnt lgkmcnt(0)
    s_barrier
    buffer_load_dwordx4 v[108:111], v4, s[28:31], s52 offen offset:384
    buffer_load_dwordx4 v[112:115], v4, s[28:31], s53 offen offset:384
    buffer_load_dwordx4 v[116:119], v4, s[32:35], s54 offen offset:384
    buffer_load_dwordx4 v[120:123], v4, s[32:35], s55 offen offset:384
    buffer_load_dwordx4 v[124:127], v4, s[32:35], s56 offen offset:384
    buffer_load_dwordx4 v[128:131], v4, s[32:35], s57 offen offset:384
    buffer_load_dwordx4 v[132:135], v4, s[32:35], s58 offen offset:384
    buffer_load_dwordx4 v[136:139], v4, s[32:35], s59 offen offset:384
    buffer_load_dwordx4 v[140:143], v4, s[32:35], s60 offen offset:384
    ds_read_b128 v[144:147], v11 offset:0
    ds_read_b128 v[148:151], v12 offset:0
    ds_read_b128 v[152:155], v12 offset:2304
    ds_read_b128 v[156:159], v12 offset:4608
    ds_read_b128 v[160:163], v12 offset:6912
    ds_read_b128 v[164:167], v12 offset:9216
    ds_read_b128 v[168:171], v12 offset:11520
    ds_read_b128 v[172:175], v12 offset:13824
    ds_read_b128 v[176:179], v12 offset:16128
    ds_read_b128 v[180:183], v12 offset:18432
    ds_read_b128 v[184:187], v12 offset:20736
    ds_read_b128 v[188:191], v12 offset:23040
    ds_read_b128 v[192:195], v12 offset:25344
    ds_read_b128 v[196:199], v12 offset:27648
    ds_read_b128 v[200:203], v12 offset:29952
    s_waitcnt lgkmcnt(13)
    v_mfma_f32_16x16x32_bf16 v[16:19], v[148:151], v[144:147], v[16:19]
    s_waitcnt lgkmcnt(12)
    v_mfma_f32_16x16x32_bf16 v[20:23], v[152:155], v[144:147], v[20:23]
    s_waitcnt lgkmcnt(11)
    v_mfma_f32_16x16x32_bf16 v[24:27], v[156:159], v[144:147], v[24:27]
    s_waitcnt lgkmcnt(10)
    v_mfma_f32_16x16x32_bf16 v[28:31], v[160:163], v[144:147], v[28:31]
    s_waitcnt lgkmcnt(9)
    v_mfma_f32_16x16x32_bf16 v[32:35], v[164:167], v[144:147], v[32:35]
    s_waitcnt lgkmcnt(8)
    v_mfma_f32_16x16x32_bf16 v[36:39], v[168:171], v[144:147], v[36:39]
    s_waitcnt lgkmcnt(7)
    v_mfma_f32_16x16x32_bf16 v[40:43], v[172:175], v[144:147], v[40:43]
    s_waitcnt lgkmcnt(6)
    v_mfma_f32_16x16x32_bf16 v[44:47], v[176:179], v[144:147], v[44:47]
    s_waitcnt lgkmcnt(5)
    v_mfma_f32_16x16x32_bf16 v[48:51], v[180:183], v[144:147], v[48:51]
    s_waitcnt lgkmcnt(4)
    v_mfma_f32_16x16x32_bf16 v[52:55], v[184:187], v[144:147], v[52:55]
    s_waitcnt lgkmcnt(3)
    v_mfma_f32_16x16x32_bf16 v[56:59], v[188:191], v[144:147], v[56:59]
    s_waitcnt lgkmcnt(2)
    v_mfma_f32_16x16x32_bf16 v[60:63], v[192:195], v[144:147], v[60:63]
    s_waitcnt lgkmcnt(1)
    v_mfma_f32_16x16x32_bf16 v[64:67], v[196:199], v[144:147], v[64:67]
    s_waitcnt lgkmcnt(0)
    v_mfma_f32_16x16x32_bf16 v[68:71], v[200:203], v[144:147], v[68:71]
    ds_read_b128 v[144:147], v11 offset:64
    ds_read_b128 v[148:151], v12 offset:64
    ds_read_b128 v[152:155], v12 offset:2368
    ds_read_b128 v[156:159], v12 offset:4672
    ds_read_b128 v[160:163], v12 offset:6976
    ds_read_b128 v[164:167], v12 offset:9280
    ds_read_b128 v[168:171], v12 offset:11584
    ds_read_b128 v[172:175], v12 offset:13888
    ds_read_b128 v[176:179], v12 offset:16192
    ds_read_b128 v[180:183], v12 offset:18496
    ds_read_b128 v[184:187], v12 offset:20800
    ds_read_b128 v[188:191], v12 offset:23104
    ds_read_b128 v[192:195], v12 offset:25408
    ds_read_b128 v[196:199], v12 offset:27712
    ds_read_b128 v[200:203], v12 offset:30016
    s_waitcnt lgkmcnt(13)
    v_mfma_f32_16x16x32_bf16 v[16:19], v[148:151], v[144:147], v[16:19]
    s_waitcnt lgkmcnt(12)
    v_mfma_f32_16x16x32_bf16 v[20:23], v[152:155], v[144:147], v[20:23]
    s_waitcnt lgkmcnt(11)
    v_mfma_f32_16x16x32_bf16 v[24:27], v[156:159], v[144:147], v[24:27]
    s_waitcnt lgkmcnt(10)
    v_mfma_f32_16x16x32_bf16 v[28:31], v[160:163], v[144:147], v[28:31]
    s_waitcnt lgkmcnt(9)
    v_mfma_f32_16x16x32_bf16 v[32:35], v[164:167], v[144:147], v[32:35]
    s_waitcnt lgkmcnt(8)
    v_mfma_f32_16x16x32_bf16 v[36:39], v[168:171], v[144:147], v[36:39]
    s_waitcnt lgkmcnt(7)
    v_mfma_f32_16x16x32_bf16 v[40:43], v[172:175], v[144:147], v[40:43]
    s_waitcnt lgkmcnt(6)
    v_mfma_f32_16x16x32_bf16 v[44:47], v[176:179], v[144:147], v[44:47]
    s_waitcnt lgkmcnt(5)
    v_mfma_f32_16x16x32_bf16 v[48:51], v[180:183], v[144:147], v[48:51]
    s_waitcnt lgkmcnt(4)
    v_mfma_f32_16x16x32_bf16 v[52:55], v[184:187], v[144:147], v[52:55]
    s_waitcnt lgkmcnt(3)
    v_mfma_f32_16x16x32_bf16 v[56:59], v[188:191], v[144:147], v[56:59]
    s_waitcnt lgkmcnt(2)
    v_mfma_f32_16x16x32_bf16 v[60:63], v[192:195], v[144:147], v[60:63]
    s_waitcnt lgkmcnt(1)
    v_mfma_f32_16x16x32_bf16 v[64:67], v[196:199], v[144:147], v[64:67]
    s_waitcnt lgkmcnt(0)
    v_mfma_f32_16x16x32_bf16 v[68:71], v[200:203], v[144:147], v[68:71]
    s_waitcnt vmcnt(9)
    ds_write_b128 v5, v[72:75] offset:0
    ds_write_b128 v5, v[76:79] offset:4608
    ds_write_b128 v5, v[80:83] offset:9216
    ds_write_b128 v5, v[84:87] offset:13824
    ds_write_b128 v5, v[88:91] offset:18432
    ds_write_b128 v5, v[92:95] offset:23040
    ds_write_b128 v5, v[96:99] offset:27648
    ds_write_b128 v5, v[100:103] offset:32256
    ds_write_b128 v5, v[104:107] offset:36864
    s_waitcnt lgkmcnt(0)
    s_barrier
    s_add_u32 s52, s52, 256
    s_add_u32 s53, s53, 256
    s_add_u32 s54, s54, 256
    s_add_u32 s55, s55, 256
    s_add_u32 s56, s56, 256
    s_add_u32 s57, s57, 256
    s_add_u32 s58, s58, 256
    s_add_u32 s59, s59, 256
    s_add_u32 s60, s60, 256
    s_add_u32 s62, s62, 1
    s_cmp_lt_u32 s62, 5
    s_cbranch_scc1 L_loop_g1a_kernel
    s_waitcnt vmcnt(0)
    v_lshlrev_b32 v13, 2, v3
    v_add_u32 v13, s40, v13
    v_lshlrev_b32 v13, 1, v13
    s_lshl_b32 s42, s27, 6
    s_lshl_b32 s41, s26, 4
    s_add_u32 s42, s42, s41
    v_add_u32 v14, s42, v2
    s_mov_b32 s42, 3456
    v_mul_lo_u32 v14, s42, v14
    v_add_u32 v14, v14, v13
    buffer_load_dwordx2 v[72:73], v13, s[44:47], 0 offen offset:0
    buffer_load_dwordx2 v[74:75], v13, s[44:47], 0 offen offset:32
    buffer_load_dwordx2 v[76:77], v13, s[44:47], 0 offen offset:64
    buffer_load_dwordx2 v[78:79], v13, s[44:47], 0 offen offset:96
    buffer_load_dwordx2 v[80:81], v13, s[44:47], 0 offen offset:128
    buffer_load_dwordx2 v[82:83], v13, s[44:47], 0 offen offset:160
    buffer_load_dwordx2 v[84:85], v13, s[44:47], 0 offen offset:192
    buffer_load_dwordx2 v[86:87], v13, s[44:47], 0 offen offset:224
    buffer_load_dwordx2 v[88:89], v13, s[44:47], 0 offen offset:256
    buffer_load_dwordx2 v[90:91], v13, s[44:47], 0 offen offset:288
    buffer_load_dwordx2 v[92:93], v13, s[44:47], 0 offen offset:320
    buffer_load_dwordx2 v[94:95], v13, s[44:47], 0 offen offset:352
    buffer_load_dwordx2 v[96:97], v13, s[44:47], 0 offen offset:384
    buffer_load_dwordx2 v[98:99], v13, s[44:47], 0 offen offset:416
    s_waitcnt vmcnt(0)
    v_cvt_pk_bf16_f32 v16, v16, v16
    v_lshlrev_b32 v16, 16, v16
    v_lshlrev_b32 v15, 16, v72
    v_add_f32 v16, v16, v15
    v_cvt_pk_bf16_f32 v16, v16, v16
    v_lshlrev_b32 v16, 16, v16
    v_mul_f32 v100, v16, v16
    v_mul_f32 v100, 0x3d372713, v100
    v_fma_f32 v100, v100, v16, v16
    v_mul_f32 v100, 0x40135761, v100
    v_exp_f32 v100, v100
    s_nop 0
    v_add_f32 v100, 1.0, v100
    v_rcp_f32 v100, v100
    s_nop 0
    v_sub_f32 v100, 1.0, v100
    v_mul_f32 v16, v16, v100
    v_cvt_pk_bf16_f32 v17, v17, v17
    v_lshlrev_b32 v17, 16, v17
    v_and_b32 v15, 0xffff0000, v72
    v_add_f32 v17, v17, v15
    v_cvt_pk_bf16_f32 v17, v17, v17
    v_lshlrev_b32 v17, 16, v17
    v_mul_f32 v100, v17, v17
    v_mul_f32 v100, 0x3d372713, v100
    v_fma_f32 v100, v100, v17, v17
    v_mul_f32 v100, 0x40135761, v100
    v_exp_f32 v100, v100
    s_nop 0
    v_add_f32 v100, 1.0, v100
    v_rcp_f32 v100, v100
    s_nop 0
    v_sub_f32 v100, 1.0, v100
    v_mul_f32 v17, v17, v100
    v_cvt_pk_bf16_f32 v18, v18, v18
    v_lshlrev_b32 v18, 16, v18
    v_lshlrev_b32 v15, 16, v73
    v_add_f32 v18, v18, v15
    v_cvt_pk_bf16_f32 v18, v18, v18
    v_lshlrev_b32 v18, 16, v18
    v_mul_f32 v100, v18, v18
    v_mul_f32 v100, 0x3d372713, v100
    v_fma_f32 v100, v100, v18, v18
    v_mul_f32 v100, 0x40135761, v100
    v_exp_f32 v100, v100
    s_nop 0
    v_add_f32 v100, 1.0, v100
    v_rcp_f32 v100, v100
    s_nop 0
    v_sub_f32 v100, 1.0, v100
    v_mul_f32 v18, v18, v100
    v_cvt_pk_bf16_f32 v19, v19, v19
    v_lshlrev_b32 v19, 16, v19
    v_and_b32 v15, 0xffff0000, v73
    v_add_f32 v19, v19, v15
    v_cvt_pk_bf16_f32 v19, v19, v19
    v_lshlrev_b32 v19, 16, v19
    v_mul_f32 v100, v19, v19
    v_mul_f32 v100, 0x3d372713, v100
    v_fma_f32 v100, v100, v19, v19
    v_mul_f32 v100, 0x40135761, v100
    v_exp_f32 v100, v100
    s_nop 0
    v_add_f32 v100, 1.0, v100
    v_rcp_f32 v100, v100
    s_nop 0
    v_sub_f32 v100, 1.0, v100
    v_mul_f32 v19, v19, v100
    v_cvt_pk_bf16_f32 v72, v16, v17
    v_cvt_pk_bf16_f32 v73, v18, v19
    buffer_store_dwordx2 v[72:73], v14, s[36:39], 0 offen offset:0
    v_cvt_pk_bf16_f32 v20, v20, v20
    v_lshlrev_b32 v20, 16, v20
    v_lshlrev_b32 v15, 16, v74
    v_add_f32 v20, v20, v15
    v_cvt_pk_bf16_f32 v20, v20, v20
    v_lshlrev_b32 v20, 16, v20
    v_mul_f32 v100, v20, v20
    v_mul_f32 v100, 0x3d372713, v100
    v_fma_f32 v100, v100, v20, v20
    v_mul_f32 v100, 0x40135761, v100
    v_exp_f32 v100, v100
    s_nop 0
    v_add_f32 v100, 1.0, v100
    v_rcp_f32 v100, v100
    s_nop 0
    v_sub_f32 v100, 1.0, v100
    v_mul_f32 v20, v20, v100
    v_cvt_pk_bf16_f32 v21, v21, v21
    v_lshlrev_b32 v21, 16, v21
    v_and_b32 v15, 0xffff0000, v74
    v_add_f32 v21, v21, v15
    v_cvt_pk_bf16_f32 v21, v21, v21
    v_lshlrev_b32 v21, 16, v21
    v_mul_f32 v100, v21, v21
    v_mul_f32 v100, 0x3d372713, v100
    v_fma_f32 v100, v100, v21, v21
    v_mul_f32 v100, 0x40135761, v100
    v_exp_f32 v100, v100
    s_nop 0
    v_add_f32 v100, 1.0, v100
    v_rcp_f32 v100, v100
    s_nop 0
    v_sub_f32 v100, 1.0, v100
    v_mul_f32 v21, v21, v100
    v_cvt_pk_bf16_f32 v22, v22, v22
    v_lshlrev_b32 v22, 16, v22
    v_lshlrev_b32 v15, 16, v75
    v_add_f32 v22, v22, v15
    v_cvt_pk_bf16_f32 v22, v22, v22
    v_lshlrev_b32 v22, 16, v22
    v_mul_f32 v100, v22, v22
    v_mul_f32 v100, 0x3d372713, v100
    v_fma_f32 v100, v100, v22, v22
    v_mul_f32 v100, 0x40135761, v100
    v_exp_f32 v100, v100
    s_nop 0
    v_add_f32 v100, 1.0, v100
    v_rcp_f32 v100, v100
    s_nop 0
    v_sub_f32 v100, 1.0, v100
    v_mul_f32 v22, v22, v100
    v_cvt_pk_bf16_f32 v23, v23, v23
    v_lshlrev_b32 v23, 16, v23
    v_and_b32 v15, 0xffff0000, v75
    v_add_f32 v23, v23, v15
    v_cvt_pk_bf16_f32 v23, v23, v23
    v_lshlrev_b32 v23, 16, v23
    v_mul_f32 v100, v23, v23
    v_mul_f32 v100, 0x3d372713, v100
    v_fma_f32 v100, v100, v23, v23
    v_mul_f32 v100, 0x40135761, v100
    v_exp_f32 v100, v100
    s_nop 0
    v_add_f32 v100, 1.0, v100
    v_rcp_f32 v100, v100
    s_nop 0
    v_sub_f32 v100, 1.0, v100
    v_mul_f32 v23, v23, v100
    v_cvt_pk_bf16_f32 v74, v20, v21
    v_cvt_pk_bf16_f32 v75, v22, v23
    buffer_store_dwordx2 v[74:75], v14, s[36:39], 0 offen offset:32
    v_cvt_pk_bf16_f32 v24, v24, v24
    v_lshlrev_b32 v24, 16, v24
    v_lshlrev_b32 v15, 16, v76
    v_add_f32 v24, v24, v15
    v_cvt_pk_bf16_f32 v24, v24, v24
    v_lshlrev_b32 v24, 16, v24
    v_mul_f32 v100, v24, v24
    v_mul_f32 v100, 0x3d372713, v100
    v_fma_f32 v100, v100, v24, v24
    v_mul_f32 v100, 0x40135761, v100
    v_exp_f32 v100, v100
    s_nop 0
    v_add_f32 v100, 1.0, v100
    v_rcp_f32 v100, v100
    s_nop 0
    v_sub_f32 v100, 1.0, v100
    v_mul_f32 v24, v24, v100
    v_cvt_pk_bf16_f32 v25, v25, v25
    v_lshlrev_b32 v25, 16, v25
    v_and_b32 v15, 0xffff0000, v76
    v_add_f32 v25, v25, v15
    v_cvt_pk_bf16_f32 v25, v25, v25
    v_lshlrev_b32 v25, 16, v25
    v_mul_f32 v100, v25, v25
    v_mul_f32 v100, 0x3d372713, v100
    v_fma_f32 v100, v100, v25, v25
    v_mul_f32 v100, 0x40135761, v100
    v_exp_f32 v100, v100
    s_nop 0
    v_add_f32 v100, 1.0, v100
    v_rcp_f32 v100, v100
    s_nop 0
    v_sub_f32 v100, 1.0, v100
    v_mul_f32 v25, v25, v100
    v_cvt_pk_bf16_f32 v26, v26, v26
    v_lshlrev_b32 v26, 16, v26
    v_lshlrev_b32 v15, 16, v77
    v_add_f32 v26, v26, v15
    v_cvt_pk_bf16_f32 v26, v26, v26
    v_lshlrev_b32 v26, 16, v26
    v_mul_f32 v100, v26, v26
    v_mul_f32 v100, 0x3d372713, v100
    v_fma_f32 v100, v100, v26, v26
    v_mul_f32 v100, 0x40135761, v100
    v_exp_f32 v100, v100
    s_nop 0
    v_add_f32 v100, 1.0, v100
    v_rcp_f32 v100, v100
    s_nop 0
    v_sub_f32 v100, 1.0, v100
    v_mul_f32 v26, v26, v100
    v_cvt_pk_bf16_f32 v27, v27, v27
    v_lshlrev_b32 v27, 16, v27
    v_and_b32 v15, 0xffff0000, v77
    v_add_f32 v27, v27, v15
    v_cvt_pk_bf16_f32 v27, v27, v27
    v_lshlrev_b32 v27, 16, v27
    v_mul_f32 v100, v27, v27
    v_mul_f32 v100, 0x3d372713, v100
    v_fma_f32 v100, v100, v27, v27
    v_mul_f32 v100, 0x40135761, v100
    v_exp_f32 v100, v100
    s_nop 0
    v_add_f32 v100, 1.0, v100
    v_rcp_f32 v100, v100
    s_nop 0
    v_sub_f32 v100, 1.0, v100
    v_mul_f32 v27, v27, v100
    v_cvt_pk_bf16_f32 v76, v24, v25
    v_cvt_pk_bf16_f32 v77, v26, v27
    buffer_store_dwordx2 v[76:77], v14, s[36:39], 0 offen offset:64
    v_cvt_pk_bf16_f32 v28, v28, v28
    v_lshlrev_b32 v28, 16, v28
    v_lshlrev_b32 v15, 16, v78
    v_add_f32 v28, v28, v15
    v_cvt_pk_bf16_f32 v28, v28, v28
    v_lshlrev_b32 v28, 16, v28
    v_mul_f32 v100, v28, v28
    v_mul_f32 v100, 0x3d372713, v100
    v_fma_f32 v100, v100, v28, v28
    v_mul_f32 v100, 0x40135761, v100
    v_exp_f32 v100, v100
    s_nop 0
    v_add_f32 v100, 1.0, v100
    v_rcp_f32 v100, v100
    s_nop 0
    v_sub_f32 v100, 1.0, v100
    v_mul_f32 v28, v28, v100
    v_cvt_pk_bf16_f32 v29, v29, v29
    v_lshlrev_b32 v29, 16, v29
    v_and_b32 v15, 0xffff0000, v78
    v_add_f32 v29, v29, v15
    v_cvt_pk_bf16_f32 v29, v29, v29
    v_lshlrev_b32 v29, 16, v29
    v_mul_f32 v100, v29, v29
    v_mul_f32 v100, 0x3d372713, v100
    v_fma_f32 v100, v100, v29, v29
    v_mul_f32 v100, 0x40135761, v100
    v_exp_f32 v100, v100
    s_nop 0
    v_add_f32 v100, 1.0, v100
    v_rcp_f32 v100, v100
    s_nop 0
    v_sub_f32 v100, 1.0, v100
    v_mul_f32 v29, v29, v100
    v_cvt_pk_bf16_f32 v30, v30, v30
    v_lshlrev_b32 v30, 16, v30
    v_lshlrev_b32 v15, 16, v79
    v_add_f32 v30, v30, v15
    v_cvt_pk_bf16_f32 v30, v30, v30
    v_lshlrev_b32 v30, 16, v30
    v_mul_f32 v100, v30, v30
    v_mul_f32 v100, 0x3d372713, v100
    v_fma_f32 v100, v100, v30, v30
    v_mul_f32 v100, 0x40135761, v100
    v_exp_f32 v100, v100
    s_nop 0
    v_add_f32 v100, 1.0, v100
    v_rcp_f32 v100, v100
    s_nop 0
    v_sub_f32 v100, 1.0, v100
    v_mul_f32 v30, v30, v100
    v_cvt_pk_bf16_f32 v31, v31, v31
    v_lshlrev_b32 v31, 16, v31
    v_and_b32 v15, 0xffff0000, v79
    v_add_f32 v31, v31, v15
    v_cvt_pk_bf16_f32 v31, v31, v31
    v_lshlrev_b32 v31, 16, v31
    v_mul_f32 v100, v31, v31
    v_mul_f32 v100, 0x3d372713, v100
    v_fma_f32 v100, v100, v31, v31
    v_mul_f32 v100, 0x40135761, v100
    v_exp_f32 v100, v100
    s_nop 0
    v_add_f32 v100, 1.0, v100
    v_rcp_f32 v100, v100
    s_nop 0
    v_sub_f32 v100, 1.0, v100
    v_mul_f32 v31, v31, v100
    v_cvt_pk_bf16_f32 v78, v28, v29
    v_cvt_pk_bf16_f32 v79, v30, v31
    buffer_store_dwordx2 v[78:79], v14, s[36:39], 0 offen offset:96
    v_cvt_pk_bf16_f32 v32, v32, v32
    v_lshlrev_b32 v32, 16, v32
    v_lshlrev_b32 v15, 16, v80
    v_add_f32 v32, v32, v15
    v_cvt_pk_bf16_f32 v32, v32, v32
    v_lshlrev_b32 v32, 16, v32
    v_mul_f32 v100, v32, v32
    v_mul_f32 v100, 0x3d372713, v100
    v_fma_f32 v100, v100, v32, v32
    v_mul_f32 v100, 0x40135761, v100
    v_exp_f32 v100, v100
    s_nop 0
    v_add_f32 v100, 1.0, v100
    v_rcp_f32 v100, v100
    s_nop 0
    v_sub_f32 v100, 1.0, v100
    v_mul_f32 v32, v32, v100
    v_cvt_pk_bf16_f32 v33, v33, v33
    v_lshlrev_b32 v33, 16, v33
    v_and_b32 v15, 0xffff0000, v80
    v_add_f32 v33, v33, v15
    v_cvt_pk_bf16_f32 v33, v33, v33
    v_lshlrev_b32 v33, 16, v33
    v_mul_f32 v100, v33, v33
    v_mul_f32 v100, 0x3d372713, v100
    v_fma_f32 v100, v100, v33, v33
    v_mul_f32 v100, 0x40135761, v100
    v_exp_f32 v100, v100
    s_nop 0
    v_add_f32 v100, 1.0, v100
    v_rcp_f32 v100, v100
    s_nop 0
    v_sub_f32 v100, 1.0, v100
    v_mul_f32 v33, v33, v100
    v_cvt_pk_bf16_f32 v34, v34, v34
    v_lshlrev_b32 v34, 16, v34
    v_lshlrev_b32 v15, 16, v81
    v_add_f32 v34, v34, v15
    v_cvt_pk_bf16_f32 v34, v34, v34
    v_lshlrev_b32 v34, 16, v34
    v_mul_f32 v100, v34, v34
    v_mul_f32 v100, 0x3d372713, v100
    v_fma_f32 v100, v100, v34, v34
    v_mul_f32 v100, 0x40135761, v100
    v_exp_f32 v100, v100
    s_nop 0
    v_add_f32 v100, 1.0, v100
    v_rcp_f32 v100, v100
    s_nop 0
    v_sub_f32 v100, 1.0, v100
    v_mul_f32 v34, v34, v100
    v_cvt_pk_bf16_f32 v35, v35, v35
    v_lshlrev_b32 v35, 16, v35
    v_and_b32 v15, 0xffff0000, v81
    v_add_f32 v35, v35, v15
    v_cvt_pk_bf16_f32 v35, v35, v35
    v_lshlrev_b32 v35, 16, v35
    v_mul_f32 v100, v35, v35
    v_mul_f32 v100, 0x3d372713, v100
    v_fma_f32 v100, v100, v35, v35
    v_mul_f32 v100, 0x40135761, v100
    v_exp_f32 v100, v100
    s_nop 0
    v_add_f32 v100, 1.0, v100
    v_rcp_f32 v100, v100
    s_nop 0
    v_sub_f32 v100, 1.0, v100
    v_mul_f32 v35, v35, v100
    v_cvt_pk_bf16_f32 v80, v32, v33
    v_cvt_pk_bf16_f32 v81, v34, v35
    buffer_store_dwordx2 v[80:81], v14, s[36:39], 0 offen offset:128
    v_cvt_pk_bf16_f32 v36, v36, v36
    v_lshlrev_b32 v36, 16, v36
    v_lshlrev_b32 v15, 16, v82
    v_add_f32 v36, v36, v15
    v_cvt_pk_bf16_f32 v36, v36, v36
    v_lshlrev_b32 v36, 16, v36
    v_mul_f32 v100, v36, v36
    v_mul_f32 v100, 0x3d372713, v100
    v_fma_f32 v100, v100, v36, v36
    v_mul_f32 v100, 0x40135761, v100
    v_exp_f32 v100, v100
    s_nop 0
    v_add_f32 v100, 1.0, v100
    v_rcp_f32 v100, v100
    s_nop 0
    v_sub_f32 v100, 1.0, v100
    v_mul_f32 v36, v36, v100
    v_cvt_pk_bf16_f32 v37, v37, v37
    v_lshlrev_b32 v37, 16, v37
    v_and_b32 v15, 0xffff0000, v82
    v_add_f32 v37, v37, v15
    v_cvt_pk_bf16_f32 v37, v37, v37
    v_lshlrev_b32 v37, 16, v37
    v_mul_f32 v100, v37, v37
    v_mul_f32 v100, 0x3d372713, v100
    v_fma_f32 v100, v100, v37, v37
    v_mul_f32 v100, 0x40135761, v100
    v_exp_f32 v100, v100
    s_nop 0
    v_add_f32 v100, 1.0, v100
    v_rcp_f32 v100, v100
    s_nop 0
    v_sub_f32 v100, 1.0, v100
    v_mul_f32 v37, v37, v100
    v_cvt_pk_bf16_f32 v38, v38, v38
    v_lshlrev_b32 v38, 16, v38
    v_lshlrev_b32 v15, 16, v83
    v_add_f32 v38, v38, v15
    v_cvt_pk_bf16_f32 v38, v38, v38
    v_lshlrev_b32 v38, 16, v38
    v_mul_f32 v100, v38, v38
    v_mul_f32 v100, 0x3d372713, v100
    v_fma_f32 v100, v100, v38, v38
    v_mul_f32 v100, 0x40135761, v100
    v_exp_f32 v100, v100
    s_nop 0
    v_add_f32 v100, 1.0, v100
    v_rcp_f32 v100, v100
    s_nop 0
    v_sub_f32 v100, 1.0, v100
    v_mul_f32 v38, v38, v100
    v_cvt_pk_bf16_f32 v39, v39, v39
    v_lshlrev_b32 v39, 16, v39
    v_and_b32 v15, 0xffff0000, v83
    v_add_f32 v39, v39, v15
    v_cvt_pk_bf16_f32 v39, v39, v39
    v_lshlrev_b32 v39, 16, v39
    v_mul_f32 v100, v39, v39
    v_mul_f32 v100, 0x3d372713, v100
    v_fma_f32 v100, v100, v39, v39
    v_mul_f32 v100, 0x40135761, v100
    v_exp_f32 v100, v100
    s_nop 0
    v_add_f32 v100, 1.0, v100
    v_rcp_f32 v100, v100
    s_nop 0
    v_sub_f32 v100, 1.0, v100
    v_mul_f32 v39, v39, v100
    v_cvt_pk_bf16_f32 v82, v36, v37
    v_cvt_pk_bf16_f32 v83, v38, v39
    buffer_store_dwordx2 v[82:83], v14, s[36:39], 0 offen offset:160
    v_cvt_pk_bf16_f32 v40, v40, v40
    v_lshlrev_b32 v40, 16, v40
    v_lshlrev_b32 v15, 16, v84
    v_add_f32 v40, v40, v15
    v_cvt_pk_bf16_f32 v40, v40, v40
    v_lshlrev_b32 v40, 16, v40
    v_mul_f32 v100, v40, v40
    v_mul_f32 v100, 0x3d372713, v100
    v_fma_f32 v100, v100, v40, v40
    v_mul_f32 v100, 0x40135761, v100
    v_exp_f32 v100, v100
    s_nop 0
    v_add_f32 v100, 1.0, v100
    v_rcp_f32 v100, v100
    s_nop 0
    v_sub_f32 v100, 1.0, v100
    v_mul_f32 v40, v40, v100
    v_cvt_pk_bf16_f32 v41, v41, v41
    v_lshlrev_b32 v41, 16, v41
    v_and_b32 v15, 0xffff0000, v84
    v_add_f32 v41, v41, v15
    v_cvt_pk_bf16_f32 v41, v41, v41
    v_lshlrev_b32 v41, 16, v41
    v_mul_f32 v100, v41, v41
    v_mul_f32 v100, 0x3d372713, v100
    v_fma_f32 v100, v100, v41, v41
    v_mul_f32 v100, 0x40135761, v100
    v_exp_f32 v100, v100
    s_nop 0
    v_add_f32 v100, 1.0, v100
    v_rcp_f32 v100, v100
    s_nop 0
    v_sub_f32 v100, 1.0, v100
    v_mul_f32 v41, v41, v100
    v_cvt_pk_bf16_f32 v42, v42, v42
    v_lshlrev_b32 v42, 16, v42
    v_lshlrev_b32 v15, 16, v85
    v_add_f32 v42, v42, v15
    v_cvt_pk_bf16_f32 v42, v42, v42
    v_lshlrev_b32 v42, 16, v42
    v_mul_f32 v100, v42, v42
    v_mul_f32 v100, 0x3d372713, v100
    v_fma_f32 v100, v100, v42, v42
    v_mul_f32 v100, 0x40135761, v100
    v_exp_f32 v100, v100
    s_nop 0
    v_add_f32 v100, 1.0, v100
    v_rcp_f32 v100, v100
    s_nop 0
    v_sub_f32 v100, 1.0, v100
    v_mul_f32 v42, v42, v100
    v_cvt_pk_bf16_f32 v43, v43, v43
    v_lshlrev_b32 v43, 16, v43
    v_and_b32 v15, 0xffff0000, v85
    v_add_f32 v43, v43, v15
    v_cvt_pk_bf16_f32 v43, v43, v43
    v_lshlrev_b32 v43, 16, v43
    v_mul_f32 v100, v43, v43
    v_mul_f32 v100, 0x3d372713, v100
    v_fma_f32 v100, v100, v43, v43
    v_mul_f32 v100, 0x40135761, v100
    v_exp_f32 v100, v100
    s_nop 0
    v_add_f32 v100, 1.0, v100
    v_rcp_f32 v100, v100
    s_nop 0
    v_sub_f32 v100, 1.0, v100
    v_mul_f32 v43, v43, v100
    v_cvt_pk_bf16_f32 v84, v40, v41
    v_cvt_pk_bf16_f32 v85, v42, v43
    buffer_store_dwordx2 v[84:85], v14, s[36:39], 0 offen offset:192
    v_cvt_pk_bf16_f32 v44, v44, v44
    v_lshlrev_b32 v44, 16, v44
    v_lshlrev_b32 v15, 16, v86
    v_add_f32 v44, v44, v15
    v_cvt_pk_bf16_f32 v44, v44, v44
    v_lshlrev_b32 v44, 16, v44
    v_mul_f32 v100, v44, v44
    v_mul_f32 v100, 0x3d372713, v100
    v_fma_f32 v100, v100, v44, v44
    v_mul_f32 v100, 0x40135761, v100
    v_exp_f32 v100, v100
    s_nop 0
    v_add_f32 v100, 1.0, v100
    v_rcp_f32 v100, v100
    s_nop 0
    v_sub_f32 v100, 1.0, v100
    v_mul_f32 v44, v44, v100
    v_cvt_pk_bf16_f32 v45, v45, v45
    v_lshlrev_b32 v45, 16, v45
    v_and_b32 v15, 0xffff0000, v86
    v_add_f32 v45, v45, v15
    v_cvt_pk_bf16_f32 v45, v45, v45
    v_lshlrev_b32 v45, 16, v45
    v_mul_f32 v100, v45, v45
    v_mul_f32 v100, 0x3d372713, v100
    v_fma_f32 v100, v100, v45, v45
    v_mul_f32 v100, 0x40135761, v100
    v_exp_f32 v100, v100
    s_nop 0
    v_add_f32 v100, 1.0, v100
    v_rcp_f32 v100, v100
    s_nop 0
    v_sub_f32 v100, 1.0, v100
    v_mul_f32 v45, v45, v100
    v_cvt_pk_bf16_f32 v46, v46, v46
    v_lshlrev_b32 v46, 16, v46
    v_lshlrev_b32 v15, 16, v87
    v_add_f32 v46, v46, v15
    v_cvt_pk_bf16_f32 v46, v46, v46
    v_lshlrev_b32 v46, 16, v46
    v_mul_f32 v100, v46, v46
    v_mul_f32 v100, 0x3d372713, v100
    v_fma_f32 v100, v100, v46, v46
    v_mul_f32 v100, 0x40135761, v100
    v_exp_f32 v100, v100
    s_nop 0
    v_add_f32 v100, 1.0, v100
    v_rcp_f32 v100, v100
    s_nop 0
    v_sub_f32 v100, 1.0, v100
    v_mul_f32 v46, v46, v100
    v_cvt_pk_bf16_f32 v47, v47, v47
    v_lshlrev_b32 v47, 16, v47
    v_and_b32 v15, 0xffff0000, v87
    v_add_f32 v47, v47, v15
    v_cvt_pk_bf16_f32 v47, v47, v47
    v_lshlrev_b32 v47, 16, v47
    v_mul_f32 v100, v47, v47
    v_mul_f32 v100, 0x3d372713, v100
    v_fma_f32 v100, v100, v47, v47
    v_mul_f32 v100, 0x40135761, v100
    v_exp_f32 v100, v100
    s_nop 0
    v_add_f32 v100, 1.0, v100
    v_rcp_f32 v100, v100
    s_nop 0
    v_sub_f32 v100, 1.0, v100
    v_mul_f32 v47, v47, v100
    v_cvt_pk_bf16_f32 v86, v44, v45
    v_cvt_pk_bf16_f32 v87, v46, v47
    buffer_store_dwordx2 v[86:87], v14, s[36:39], 0 offen offset:224
    v_cvt_pk_bf16_f32 v48, v48, v48
    v_lshlrev_b32 v48, 16, v48
    v_lshlrev_b32 v15, 16, v88
    v_add_f32 v48, v48, v15
    v_cvt_pk_bf16_f32 v48, v48, v48
    v_lshlrev_b32 v48, 16, v48
    v_mul_f32 v100, v48, v48
    v_mul_f32 v100, 0x3d372713, v100
    v_fma_f32 v100, v100, v48, v48
    v_mul_f32 v100, 0x40135761, v100
    v_exp_f32 v100, v100
    s_nop 0
    v_add_f32 v100, 1.0, v100
    v_rcp_f32 v100, v100
    s_nop 0
    v_sub_f32 v100, 1.0, v100
    v_mul_f32 v48, v48, v100
    v_cvt_pk_bf16_f32 v49, v49, v49
    v_lshlrev_b32 v49, 16, v49
    v_and_b32 v15, 0xffff0000, v88
    v_add_f32 v49, v49, v15
    v_cvt_pk_bf16_f32 v49, v49, v49
    v_lshlrev_b32 v49, 16, v49
    v_mul_f32 v100, v49, v49
    v_mul_f32 v100, 0x3d372713, v100
    v_fma_f32 v100, v100, v49, v49
    v_mul_f32 v100, 0x40135761, v100
    v_exp_f32 v100, v100
    s_nop 0
    v_add_f32 v100, 1.0, v100
    v_rcp_f32 v100, v100
    s_nop 0
    v_sub_f32 v100, 1.0, v100
    v_mul_f32 v49, v49, v100
    v_cvt_pk_bf16_f32 v50, v50, v50
    v_lshlrev_b32 v50, 16, v50
    v_lshlrev_b32 v15, 16, v89
    v_add_f32 v50, v50, v15
    v_cvt_pk_bf16_f32 v50, v50, v50
    v_lshlrev_b32 v50, 16, v50
    v_mul_f32 v100, v50, v50
    v_mul_f32 v100, 0x3d372713, v100
    v_fma_f32 v100, v100, v50, v50
    v_mul_f32 v100, 0x40135761, v100
    v_exp_f32 v100, v100
    s_nop 0
    v_add_f32 v100, 1.0, v100
    v_rcp_f32 v100, v100
    s_nop 0
    v_sub_f32 v100, 1.0, v100
    v_mul_f32 v50, v50, v100
    v_cvt_pk_bf16_f32 v51, v51, v51
    v_lshlrev_b32 v51, 16, v51
    v_and_b32 v15, 0xffff0000, v89
    v_add_f32 v51, v51, v15
    v_cvt_pk_bf16_f32 v51, v51, v51
    v_lshlrev_b32 v51, 16, v51
    v_mul_f32 v100, v51, v51
    v_mul_f32 v100, 0x3d372713, v100
    v_fma_f32 v100, v100, v51, v51
    v_mul_f32 v100, 0x40135761, v100
    v_exp_f32 v100, v100
    s_nop 0
    v_add_f32 v100, 1.0, v100
    v_rcp_f32 v100, v100
    s_nop 0
    v_sub_f32 v100, 1.0, v100
    v_mul_f32 v51, v51, v100
    v_cvt_pk_bf16_f32 v88, v48, v49
    v_cvt_pk_bf16_f32 v89, v50, v51
    buffer_store_dwordx2 v[88:89], v14, s[36:39], 0 offen offset:256
    v_cvt_pk_bf16_f32 v52, v52, v52
    v_lshlrev_b32 v52, 16, v52
    v_lshlrev_b32 v15, 16, v90
    v_add_f32 v52, v52, v15
    v_cvt_pk_bf16_f32 v52, v52, v52
    v_lshlrev_b32 v52, 16, v52
    v_mul_f32 v100, v52, v52
    v_mul_f32 v100, 0x3d372713, v100
    v_fma_f32 v100, v100, v52, v52
    v_mul_f32 v100, 0x40135761, v100
    v_exp_f32 v100, v100
    s_nop 0
    v_add_f32 v100, 1.0, v100
    v_rcp_f32 v100, v100
    s_nop 0
    v_sub_f32 v100, 1.0, v100
    v_mul_f32 v52, v52, v100
    v_cvt_pk_bf16_f32 v53, v53, v53
    v_lshlrev_b32 v53, 16, v53
    v_and_b32 v15, 0xffff0000, v90
    v_add_f32 v53, v53, v15
    v_cvt_pk_bf16_f32 v53, v53, v53
    v_lshlrev_b32 v53, 16, v53
    v_mul_f32 v100, v53, v53
    v_mul_f32 v100, 0x3d372713, v100
    v_fma_f32 v100, v100, v53, v53
    v_mul_f32 v100, 0x40135761, v100
    v_exp_f32 v100, v100
    s_nop 0
    v_add_f32 v100, 1.0, v100
    v_rcp_f32 v100, v100
    s_nop 0
    v_sub_f32 v100, 1.0, v100
    v_mul_f32 v53, v53, v100
    v_cvt_pk_bf16_f32 v54, v54, v54
    v_lshlrev_b32 v54, 16, v54
    v_lshlrev_b32 v15, 16, v91
    v_add_f32 v54, v54, v15
    v_cvt_pk_bf16_f32 v54, v54, v54
    v_lshlrev_b32 v54, 16, v54
    v_mul_f32 v100, v54, v54
    v_mul_f32 v100, 0x3d372713, v100
    v_fma_f32 v100, v100, v54, v54
    v_mul_f32 v100, 0x40135761, v100
    v_exp_f32 v100, v100
    s_nop 0
    v_add_f32 v100, 1.0, v100
    v_rcp_f32 v100, v100
    s_nop 0
    v_sub_f32 v100, 1.0, v100
    v_mul_f32 v54, v54, v100
    v_cvt_pk_bf16_f32 v55, v55, v55
    v_lshlrev_b32 v55, 16, v55
    v_and_b32 v15, 0xffff0000, v91
    v_add_f32 v55, v55, v15
    v_cvt_pk_bf16_f32 v55, v55, v55
    v_lshlrev_b32 v55, 16, v55
    v_mul_f32 v100, v55, v55
    v_mul_f32 v100, 0x3d372713, v100
    v_fma_f32 v100, v100, v55, v55
    v_mul_f32 v100, 0x40135761, v100
    v_exp_f32 v100, v100
    s_nop 0
    v_add_f32 v100, 1.0, v100
    v_rcp_f32 v100, v100
    s_nop 0
    v_sub_f32 v100, 1.0, v100
    v_mul_f32 v55, v55, v100
    v_cvt_pk_bf16_f32 v90, v52, v53
    v_cvt_pk_bf16_f32 v91, v54, v55
    buffer_store_dwordx2 v[90:91], v14, s[36:39], 0 offen offset:288
    v_cvt_pk_bf16_f32 v56, v56, v56
    v_lshlrev_b32 v56, 16, v56
    v_lshlrev_b32 v15, 16, v92
    v_add_f32 v56, v56, v15
    v_cvt_pk_bf16_f32 v56, v56, v56
    v_lshlrev_b32 v56, 16, v56
    v_mul_f32 v100, v56, v56
    v_mul_f32 v100, 0x3d372713, v100
    v_fma_f32 v100, v100, v56, v56
    v_mul_f32 v100, 0x40135761, v100
    v_exp_f32 v100, v100
    s_nop 0
    v_add_f32 v100, 1.0, v100
    v_rcp_f32 v100, v100
    s_nop 0
    v_sub_f32 v100, 1.0, v100
    v_mul_f32 v56, v56, v100
    v_cvt_pk_bf16_f32 v57, v57, v57
    v_lshlrev_b32 v57, 16, v57
    v_and_b32 v15, 0xffff0000, v92
    v_add_f32 v57, v57, v15
    v_cvt_pk_bf16_f32 v57, v57, v57
    v_lshlrev_b32 v57, 16, v57
    v_mul_f32 v100, v57, v57
    v_mul_f32 v100, 0x3d372713, v100
    v_fma_f32 v100, v100, v57, v57
    v_mul_f32 v100, 0x40135761, v100
    v_exp_f32 v100, v100
    s_nop 0
    v_add_f32 v100, 1.0, v100
    v_rcp_f32 v100, v100
    s_nop 0
    v_sub_f32 v100, 1.0, v100
    v_mul_f32 v57, v57, v100
    v_cvt_pk_bf16_f32 v58, v58, v58
    v_lshlrev_b32 v58, 16, v58
    v_lshlrev_b32 v15, 16, v93
    v_add_f32 v58, v58, v15
    v_cvt_pk_bf16_f32 v58, v58, v58
    v_lshlrev_b32 v58, 16, v58
    v_mul_f32 v100, v58, v58
    v_mul_f32 v100, 0x3d372713, v100
    v_fma_f32 v100, v100, v58, v58
    v_mul_f32 v100, 0x40135761, v100
    v_exp_f32 v100, v100
    s_nop 0
    v_add_f32 v100, 1.0, v100
    v_rcp_f32 v100, v100
    s_nop 0
    v_sub_f32 v100, 1.0, v100
    v_mul_f32 v58, v58, v100
    v_cvt_pk_bf16_f32 v59, v59, v59
    v_lshlrev_b32 v59, 16, v59
    v_and_b32 v15, 0xffff0000, v93
    v_add_f32 v59, v59, v15
    v_cvt_pk_bf16_f32 v59, v59, v59
    v_lshlrev_b32 v59, 16, v59
    v_mul_f32 v100, v59, v59
    v_mul_f32 v100, 0x3d372713, v100
    v_fma_f32 v100, v100, v59, v59
    v_mul_f32 v100, 0x40135761, v100
    v_exp_f32 v100, v100
    s_nop 0
    v_add_f32 v100, 1.0, v100
    v_rcp_f32 v100, v100
    s_nop 0
    v_sub_f32 v100, 1.0, v100
    v_mul_f32 v59, v59, v100
    v_cvt_pk_bf16_f32 v92, v56, v57
    v_cvt_pk_bf16_f32 v93, v58, v59
    buffer_store_dwordx2 v[92:93], v14, s[36:39], 0 offen offset:320
    v_cvt_pk_bf16_f32 v60, v60, v60
    v_lshlrev_b32 v60, 16, v60
    v_lshlrev_b32 v15, 16, v94
    v_add_f32 v60, v60, v15
    v_cvt_pk_bf16_f32 v60, v60, v60
    v_lshlrev_b32 v60, 16, v60
    v_mul_f32 v100, v60, v60
    v_mul_f32 v100, 0x3d372713, v100
    v_fma_f32 v100, v100, v60, v60
    v_mul_f32 v100, 0x40135761, v100
    v_exp_f32 v100, v100
    s_nop 0
    v_add_f32 v100, 1.0, v100
    v_rcp_f32 v100, v100
    s_nop 0
    v_sub_f32 v100, 1.0, v100
    v_mul_f32 v60, v60, v100
    v_cvt_pk_bf16_f32 v61, v61, v61
    v_lshlrev_b32 v61, 16, v61
    v_and_b32 v15, 0xffff0000, v94
    v_add_f32 v61, v61, v15
    v_cvt_pk_bf16_f32 v61, v61, v61
    v_lshlrev_b32 v61, 16, v61
    v_mul_f32 v100, v61, v61
    v_mul_f32 v100, 0x3d372713, v100
    v_fma_f32 v100, v100, v61, v61
    v_mul_f32 v100, 0x40135761, v100
    v_exp_f32 v100, v100
    s_nop 0
    v_add_f32 v100, 1.0, v100
    v_rcp_f32 v100, v100
    s_nop 0
    v_sub_f32 v100, 1.0, v100
    v_mul_f32 v61, v61, v100
    v_cvt_pk_bf16_f32 v62, v62, v62
    v_lshlrev_b32 v62, 16, v62
    v_lshlrev_b32 v15, 16, v95
    v_add_f32 v62, v62, v15
    v_cvt_pk_bf16_f32 v62, v62, v62
    v_lshlrev_b32 v62, 16, v62
    v_mul_f32 v100, v62, v62
    v_mul_f32 v100, 0x3d372713, v100
    v_fma_f32 v100, v100, v62, v62
    v_mul_f32 v100, 0x40135761, v100
    v_exp_f32 v100, v100
    s_nop 0
    v_add_f32 v100, 1.0, v100
    v_rcp_f32 v100, v100
    s_nop 0
    v_sub_f32 v100, 1.0, v100
    v_mul_f32 v62, v62, v100
    v_cvt_pk_bf16_f32 v63, v63, v63
    v_lshlrev_b32 v63, 16, v63
    v_and_b32 v15, 0xffff0000, v95
    v_add_f32 v63, v63, v15
    v_cvt_pk_bf16_f32 v63, v63, v63
    v_lshlrev_b32 v63, 16, v63
    v_mul_f32 v100, v63, v63
    v_mul_f32 v100, 0x3d372713, v100
    v_fma_f32 v100, v100, v63, v63
    v_mul_f32 v100, 0x40135761, v100
    v_exp_f32 v100, v100
    s_nop 0
    v_add_f32 v100, 1.0, v100
    v_rcp_f32 v100, v100
    s_nop 0
    v_sub_f32 v100, 1.0, v100
    v_mul_f32 v63, v63, v100
    v_cvt_pk_bf16_f32 v94, v60, v61
    v_cvt_pk_bf16_f32 v95, v62, v63
    buffer_store_dwordx2 v[94:95], v14, s[36:39], 0 offen offset:352
    v_cvt_pk_bf16_f32 v64, v64, v64
    v_lshlrev_b32 v64, 16, v64
    v_lshlrev_b32 v15, 16, v96
    v_add_f32 v64, v64, v15
    v_cvt_pk_bf16_f32 v64, v64, v64
    v_lshlrev_b32 v64, 16, v64
    v_mul_f32 v100, v64, v64
    v_mul_f32 v100, 0x3d372713, v100
    v_fma_f32 v100, v100, v64, v64
    v_mul_f32 v100, 0x40135761, v100
    v_exp_f32 v100, v100
    s_nop 0
    v_add_f32 v100, 1.0, v100
    v_rcp_f32 v100, v100
    s_nop 0
    v_sub_f32 v100, 1.0, v100
    v_mul_f32 v64, v64, v100
    v_cvt_pk_bf16_f32 v65, v65, v65
    v_lshlrev_b32 v65, 16, v65
    v_and_b32 v15, 0xffff0000, v96
    v_add_f32 v65, v65, v15
    v_cvt_pk_bf16_f32 v65, v65, v65
    v_lshlrev_b32 v65, 16, v65
    v_mul_f32 v100, v65, v65
    v_mul_f32 v100, 0x3d372713, v100
    v_fma_f32 v100, v100, v65, v65
    v_mul_f32 v100, 0x40135761, v100
    v_exp_f32 v100, v100
    s_nop 0
    v_add_f32 v100, 1.0, v100
    v_rcp_f32 v100, v100
    s_nop 0
    v_sub_f32 v100, 1.0, v100
    v_mul_f32 v65, v65, v100
    v_cvt_pk_bf16_f32 v66, v66, v66
    v_lshlrev_b32 v66, 16, v66
    v_lshlrev_b32 v15, 16, v97
    v_add_f32 v66, v66, v15
    v_cvt_pk_bf16_f32 v66, v66, v66
    v_lshlrev_b32 v66, 16, v66
    v_mul_f32 v100, v66, v66
    v_mul_f32 v100, 0x3d372713, v100
    v_fma_f32 v100, v100, v66, v66
    v_mul_f32 v100, 0x40135761, v100
    v_exp_f32 v100, v100
    s_nop 0
    v_add_f32 v100, 1.0, v100
    v_rcp_f32 v100, v100
    s_nop 0
    v_sub_f32 v100, 1.0, v100
    v_mul_f32 v66, v66, v100
    v_cvt_pk_bf16_f32 v67, v67, v67
    v_lshlrev_b32 v67, 16, v67
    v_and_b32 v15, 0xffff0000, v97
    v_add_f32 v67, v67, v15
    v_cvt_pk_bf16_f32 v67, v67, v67
    v_lshlrev_b32 v67, 16, v67
    v_mul_f32 v100, v67, v67
    v_mul_f32 v100, 0x3d372713, v100
    v_fma_f32 v100, v100, v67, v67
    v_mul_f32 v100, 0x40135761, v100
    v_exp_f32 v100, v100
    s_nop 0
    v_add_f32 v100, 1.0, v100
    v_rcp_f32 v100, v100
    s_nop 0
    v_sub_f32 v100, 1.0, v100
    v_mul_f32 v67, v67, v100
    v_cvt_pk_bf16_f32 v96, v64, v65
    v_cvt_pk_bf16_f32 v97, v66, v67
    buffer_store_dwordx2 v[96:97], v14, s[36:39], 0 offen offset:384
    v_cvt_pk_bf16_f32 v68, v68, v68
    v_lshlrev_b32 v68, 16, v68
    v_lshlrev_b32 v15, 16, v98
    v_add_f32 v68, v68, v15
    v_cvt_pk_bf16_f32 v68, v68, v68
    v_lshlrev_b32 v68, 16, v68
    v_mul_f32 v100, v68, v68
    v_mul_f32 v100, 0x3d372713, v100
    v_fma_f32 v100, v100, v68, v68
    v_mul_f32 v100, 0x40135761, v100
    v_exp_f32 v100, v100
    s_nop 0
    v_add_f32 v100, 1.0, v100
    v_rcp_f32 v100, v100
    s_nop 0
    v_sub_f32 v100, 1.0, v100
    v_mul_f32 v68, v68, v100
    v_cvt_pk_bf16_f32 v69, v69, v69
    v_lshlrev_b32 v69, 16, v69
    v_and_b32 v15, 0xffff0000, v98
    v_add_f32 v69, v69, v15
    v_cvt_pk_bf16_f32 v69, v69, v69
    v_lshlrev_b32 v69, 16, v69
    v_mul_f32 v100, v69, v69
    v_mul_f32 v100, 0x3d372713, v100
    v_fma_f32 v100, v100, v69, v69
    v_mul_f32 v100, 0x40135761, v100
    v_exp_f32 v100, v100
    s_nop 0
    v_add_f32 v100, 1.0, v100
    v_rcp_f32 v100, v100
    s_nop 0
    v_sub_f32 v100, 1.0, v100
    v_mul_f32 v69, v69, v100
    v_cvt_pk_bf16_f32 v70, v70, v70
    v_lshlrev_b32 v70, 16, v70
    v_lshlrev_b32 v15, 16, v99
    v_add_f32 v70, v70, v15
    v_cvt_pk_bf16_f32 v70, v70, v70
    v_lshlrev_b32 v70, 16, v70
    v_mul_f32 v100, v70, v70
    v_mul_f32 v100, 0x3d372713, v100
    v_fma_f32 v100, v100, v70, v70
    v_mul_f32 v100, 0x40135761, v100
    v_exp_f32 v100, v100
    s_nop 0
    v_add_f32 v100, 1.0, v100
    v_rcp_f32 v100, v100
    s_nop 0
    v_sub_f32 v100, 1.0, v100
    v_mul_f32 v70, v70, v100
    v_cvt_pk_bf16_f32 v71, v71, v71
    v_lshlrev_b32 v71, 16, v71
    v_and_b32 v15, 0xffff0000, v99
    v_add_f32 v71, v71, v15
    v_cvt_pk_bf16_f32 v71, v71, v71
    v_lshlrev_b32 v71, 16, v71
    v_mul_f32 v100, v71, v71
    v_mul_f32 v100, 0x3d372713, v100
    v_fma_f32 v100, v100, v71, v71
    v_mul_f32 v100, 0x40135761, v100
    v_exp_f32 v100, v100
    s_nop 0
    v_add_f32 v100, 1.0, v100
    v_rcp_f32 v100, v100
    s_nop 0
    v_sub_f32 v100, 1.0, v100
    v_mul_f32 v71, v71, v100
    v_cvt_pk_bf16_f32 v98, v68, v69
    v_cvt_pk_bf16_f32 v99, v70, v71
    buffer_store_dwordx2 v[98:99], v14, s[36:39], 0 offen offset:416
L_end_g1a_kernel:
    s_endpgm
.globl g2a_kernel
.p2align 8
.type g2a_kernel,@function
g2a_kernel:
    s_cmp_ge_u32 s2, 256
    s_cbranch_scc1 L_end_g2a_kernel
    s_load_dwordx16 s[4:19], s[0:1], 0
    s_load_dwordx4 s[20:23], s[0:1], 64
    s_load_dwordx2 s[24:25], s[0:1], 80
    s_waitcnt lgkmcnt(0)
    s_add_u32 s28, s24, 0x1500000
    s_addc_u32 s29, s25, 0
    s_mov_b32 s30, 0x6c0000
    s_mov_b32 s31, 0x00020000
    s_add_u32 s32, s24, 0xc00000
    s_addc_u32 s33, s25, 0
    s_mov_b32 s34, 0x21c000
    s_mov_b32 s35, 0x00020000
    s_add_u32 s44, s18, 0x0
    s_addc_u32 s45, s19, 0
    s_mov_b32 s46, 0x500
    s_mov_b32 s47, 0x00020000
    s_add_u32 s48, s24, 0xf00000
    s_addc_u32 s49, s25, 0
    s_mov_b32 s50, 0x280000
    s_mov_b32 s51, 0x00020000
    s_add_u32 s36, s24, 0x1c00000
    s_addc_u32 s37, s25, 0
    s_mov_b32 s38, 0x280000
    s_mov_b32 s39, 0x00020000
    v_and_b32 v1, 63, v0
    v_lshrrev_b32 v2, 6, v0
    s_nop 1
    v_readfirstlane_b32 s26, v2
    s_nop 3
    s_and_b32 s27, s2, 31
    s_lshr_b32 s40, s2, 5
    v_and_b32 v2, 15, v1
    v_lshrrev_b32 v3, 4, v1
    v_lshrrev_b32 v6, 3, v0
    v_and_b32 v7, 7, v0
    v_lshlrev_b32 v7, 4, v7
    v_mul_u32_u24 v4, 3456, v6
    v_add_u32 v4, v4, v7
    v_mul_u32_u24 v5, 144, v6
    v_add_u32 v5, v5, v7
    s_mul_i32 s52, s27, 221184
    s_add_u32 s53, s52, 110592
    s_mul_i32 s54, s40, 276480
    s_add_u32 s55, s54, 110592
    s_add_u32 s56, s54, 221184
    v_add_u32 v8, 20736, v5
    v_lshlrev_b32 v7, 4, v3
    v_mul_u32_u24 v10, 144, v2
    v_add_u32 v10, v10, v7
    s_mul_i32 s41, s26, 2304
    v_add_u32 v9, s41, v10
    v_add_u32 v10, 9216, v10
    v_add_u32 v11, 20736, v9
    v_add_u32 v12, 20736, v10
    v_mov_b32 v16, 0
    v_mov_b32 v17, 0
    v_mov_b32 v18, 0
    v_mov_b32 v19, 0
    v_mov_b32 v20, 0
    v_mov_b32 v21, 0
    v_mov_b32 v22, 0
    v_mov_b32 v23, 0
    v_mov_b32 v24, 0
    v_mov_b32 v25, 0
    v_mov_b32 v26, 0
    v_mov_b32 v27, 0
    v_mov_b32 v28, 0
    v_mov_b32 v29, 0
    v_mov_b32 v30, 0
    v_mov_b32 v31, 0
    v_mov_b32 v32, 0
    v_mov_b32 v33, 0
    v_mov_b32 v34, 0
    v_mov_b32 v35, 0
    s_mul_i32 s43, s40, 80
    v_lshlrev_b32 v14, 2, v3
    v_add_u32 v14, s43, v14
    v_lshlrev_b32 v14, 1, v14
    s_lshl_b32 s43, s27, 6
    s_lshl_b32 s41, s26, 4
    s_add_u32 s43, s43, s41
    v_add_u32 v13, s43, v2
    v_mul_u32_u24 v13, 1280, v13
    v_add_u32 v13, v13, v14
    buffer_load_dwordx2 v[204:205], v14, s[44:47], 0 offen offset:0
    buffer_load_dwordx2 v[214:215], v13, s[48:51], 0 offen offset:0
    buffer_load_dwordx2 v[206:207], v14, s[44:47], 0 offen offset:32
    buffer_load_dwordx2 v[216:217], v13, s[48:51], 0 offen offset:32
    buffer_load_dwordx2 v[208:209], v14, s[44:47], 0 offen offset:64
    buffer_load_dwordx2 v[218:219], v13, s[48:51], 0 offen offset:64
    buffer_load_dwordx2 v[210:211], v14, s[44:47], 0 offen offset:96
    buffer_load_dwordx2 v[220:221], v13, s[48:51], 0 offen offset:96
    buffer_load_dwordx2 v[212:213], v14, s[44:47], 0 offen offset:128
    buffer_load_dwordx2 v[222:223], v13, s[48:51], 0 offen offset:128
    buffer_load_dwordx4 v[36:39], v4, s[28:31], s52 offen offset:0
    buffer_load_dwordx4 v[40:43], v4, s[28:31], s53 offen offset:0
    buffer_load_dwordx4 v[44:47], v4, s[32:35], s54 offen offset:0
    buffer_load_dwordx4 v[48:51], v4, s[32:35], s55 offen offset:0
    buffer_load_dwordx4 v[52:55], v4, s[32:35], s56 offen offset:0
    buffer_load_dwordx4 v[96:99], v4, s[28:31], s52 offen offset:128
    buffer_load_dwordx4 v[100:103], v4, s[28:31], s53 offen offset:128
    buffer_load_dwordx4 v[104:107], v4, s[32:35], s54 offen offset:128
    buffer_load_dwordx4 v[108:111], v4, s[32:35], s55 offen offset:128
    buffer_load_dwordx4 v[112:115], v4, s[32:35], s56 offen offset:128
    s_waitcnt vmcnt(5)
    ds_write_b128 v5, v[36:39] offset:0
    ds_write_b128 v5, v[40:43] offset:4608
    ds_write_b128 v5, v[44:47] offset:9216
    ds_write_b128 v5, v[48:51] offset:13824
    s_cmp_ge_u32 s26, 2
    s_cbranch_scc1 L_112_g2a_kernel
    ds_write_b128 v5, v[52:55] offset:18432
L_112_g2a_kernel:
    s_waitcnt lgkmcnt(0)
    s_barrier
    s_mov_b32 s62, 0
L_loop_g2a_kernel:
    buffer_load_dwordx4 v[36:39], v4, s[28:31], s52 offen offset:256
    buffer_load_dwordx4 v[40:43], v4, s[28:31], s53 offen offset:256
    buffer_load_dwordx4 v[44:47], v4, s[32:35], s54 offen offset:256
    buffer_load_dwordx4 v[48:51], v4, s[32:35], s55 offen offset:256
    buffer_load_dwordx4 v[52:55], v4, s[32:35], s56 offen offset:256
    ds_read_b128 v[156:159], v9 offset:0
    ds_read_b128 v[160:163], v10 offset:0
    ds_read_b128 v[164:167], v10 offset:2304
    ds_read_b128 v[168:171], v10 offset:4608
    ds_read_b128 v[172:175], v10 offset:6912
    ds_read_b128 v[176:179], v10 offset:9216
    ds_read_b128 v[180:183], v9 offset:64
    ds_read_b128 v[184:187], v10 offset:64
    ds_read_b128 v[188:191], v10 offset:2368
    ds_read_b128 v[192:195], v10 offset:4672
    ds_read_b128 v[196:199], v10 offset:6976
    ds_read_b128 v[200:203], v10 offset:9280
    s_waitcnt lgkmcnt(6)
    v_mfma_f32_16x16x32_bf16 v[16:19], v[160:163], v[156:159], v[16:19]
    v_mfma_f32_16x16x32_bf16 v[20:23], v[164:167], v[156:159], v[20:23]
    v_mfma_f32_16x16x32_bf16 v[24:27], v[168:171], v[156:159], v[24:27]
    v_mfma_f32_16x16x32_bf16 v[28:31], v[172:175], v[156:159], v[28:31]
    v_mfma_f32_16x16x32_bf16 v[32:35], v[176:179], v[156:159], v[32:35]
    s_waitcnt lgkmcnt(0)
    v_mfma_f32_16x16x32_bf16 v[16:19], v[184:187], v[180:183], v[16:19]
    v_mfma_f32_16x16x32_bf16 v[20:23], v[188:191], v[180:183], v[20:23]
    v_mfma_f32_16x16x32_bf16 v[24:27], v[192:195], v[180:183], v[24:27]
    v_mfma_f32_16x16x32_bf16 v[28:31], v[196:199], v[180:183], v[28:31]
    v_mfma_f32_16x16x32_bf16 v[32:35], v[200:203], v[180:183], v[32:35]
    s_waitcnt vmcnt(5)
    ds_write_b128 v8, v[96:99] offset:0
    ds_write_b128 v8, v[100:103] offset:4608
    ds_write_b128 v8, v[104:107] offset:9216
    ds_write_b128 v8, v[108:111] offset:13824
    s_cmp_ge_u32 s26, 2
    s_cbranch_scc1 L_154_g2a_kernel
    ds_write_b128 v8, v[112:115] offset:18432
L_154_g2a_kernel:
    s_waitcnt lgkmcnt(0)
    s_barrier
    buffer_load_dwordx4 v[96:99], v4, s[28:31], s52 offen offset:384
    buffer_load_dwordx4 v[100:103], v4, s[28:31], s53 offen offset:384
    buffer_load_dwordx4 v[104:107], v4, s[32:35], s54 offen offset:384
    buffer_load_dwordx4 v[108:111], v4, s[32:35], s55 offen offset:384
    buffer_load_dwordx4 v[112:115], v4, s[32:35], s56 offen offset:384
    ds_read_b128 v[156:159], v11 offset:0
    ds_read_b128 v[160:163], v12 offset:0
    ds_read_b128 v[164:167], v12 offset:2304
    ds_read_b128 v[168:171], v12 offset:4608
    ds_read_b128 v[172:175], v12 offset:6912
    ds_read_b128 v[176:179], v12 offset:9216
    ds_read_b128 v[180:183], v11 offset:64
    ds_read_b128 v[184:187], v12 offset:64
    ds_read_b128 v[188:191], v12 offset:2368
    ds_read_b128 v[192:195], v12 offset:4672
    ds_read_b128 v[196:199], v12 offset:6976
    ds_read_b128 v[200:203], v12 offset:9280
    s_waitcnt lgkmcnt(6)
    v_mfma_f32_16x16x32_bf16 v[16:19], v[160:163], v[156:159], v[16:19]
    v_mfma_f32_16x16x32_bf16 v[20:23], v[164:167], v[156:159], v[20:23]
    v_mfma_f32_16x16x32_bf16 v[24:27], v[168:171], v[156:159], v[24:27]
    v_mfma_f32_16x16x32_bf16 v[28:31], v[172:175], v[156:159], v[28:31]
    v_mfma_f32_16x16x32_bf16 v[32:35], v[176:179], v[156:159], v[32:35]
    s_waitcnt lgkmcnt(0)
    v_mfma_f32_16x16x32_bf16 v[16:19], v[184:187], v[180:183], v[16:19]
    v_mfma_f32_16x16x32_bf16 v[20:23], v[188:191], v[180:183], v[20:23]
    v_mfma_f32_16x16x32_bf16 v[24:27], v[192:195], v[180:183], v[24:27]
    v_mfma_f32_16x16x32_bf16 v[28:31], v[196:199], v[180:183], v[28:31]
    v_mfma_f32_16x16x32_bf16 v[32:35], v[200:203], v[180:183], v[32:35]
    s_waitcnt vmcnt(5)
    ds_write_b128 v5, v[36:39] offset:0
    ds_write_b128 v5, v[40:43] offset:4608
    ds_write_b128 v5, v[44:47] offset:9216
    ds_write_b128 v5, v[48:51] offset:13824
    s_cmp_ge_u32 s26, 2
    s_cbranch_scc1 L_194_g2a_kernel
    ds_write_b128 v5, v[52:55] offset:18432
L_194_g2a_kernel:
    s_waitcnt lgkmcnt(0)
    s_barrier
    s_add_u32 s52, s52, 256
    s_add_u32 s53, s53, 256
    s_add_u32 s54, s54, 256
    s_add_u32 s55, s55, 256
    s_add_u32 s56, s56, 256
    s_add_u32 s62, s62, 1
    s_cmp_lt_u32 s62, 13
    s_cbranch_scc1 L_loop_g2a_kernel
    ds_read_b128 v[156:159], v9 offset:0
    ds_read_b128 v[160:163], v10 offset:0
    ds_read_b128 v[164:167], v10 offset:2304
    ds_read_b128 v[168:171], v10 offset:4608
    ds_read_b128 v[172:175], v10 offset:6912
    ds_read_b128 v[176:179], v10 offset:9216
    ds_read_b128 v[180:183], v9 offset:64
    ds_read_b128 v[184:187], v10 offset:64
    ds_read_b128 v[188:191], v10 offset:2368
    ds_read_b128 v[192:195], v10 offset:4672
    ds_read_b128 v[196:199], v10 offset:6976
    ds_read_b128 v[200:203], v10 offset:9280
    s_waitcnt lgkmcnt(6)
    v_mfma_f32_16x16x32_bf16 v[16:19], v[160:163], v[156:159], v[16:19]
    v_mfma_f32_16x16x32_bf16 v[20:23], v[164:167], v[156:159], v[20:23]
    v_mfma_f32_16x16x32_bf16 v[24:27], v[168:171], v[156:159], v[24:27]
    v_mfma_f32_16x16x32_bf16 v[28:31], v[172:175], v[156:159], v[28:31]
    v_mfma_f32_16x16x32_bf16 v[32:35], v[176:179], v[156:159], v[32:35]
    s_waitcnt lgkmcnt(0)
    v_mfma_f32_16x16x32_bf16 v[16:19], v[184:187], v[180:183], v[16:19]
    v_mfma_f32_16x16x32_bf16 v[20:23], v[188:191], v[180:183], v[20:23]
    v_mfma_f32_16x16x32_bf16 v[24:27], v[192:195], v[180:183], v[24:27]
    v_mfma_f32_16x16x32_bf16 v[28:31], v[196:199], v[180:183], v[28:31]
    v_mfma_f32_16x16x32_bf16 v[32:35], v[200:203], v[180:183], v[32:35]
    s_waitcnt vmcnt(0)
    s_nop 7
    s_nop 3
    v_cvt_pk_bf16_f32 v16, v16, v16
    v_lshlrev_b32 v16, 16, v16
    v_lshlrev_b32 v14, 16, v204
    v_add_f32 v16, v16, v14
    v_cvt_pk_bf16_f32 v16, v16, v16
    v_lshlrev_b32 v16, 16, v16
    v_lshlrev_b32 v14, 16, v214
    v_add_f32 v16, v16, v14
    v_cvt_pk_bf16_f32 v17, v17, v17
    v_lshlrev_b32 v17, 16, v17
    v_and_b32 v14, 0xffff0000, v204
    v_add_f32 v17, v17, v14
    v_cvt_pk_bf16_f32 v17, v17, v17
    v_lshlrev_b32 v17, 16, v17
    v_and_b32 v14, 0xffff0000, v214
    v_add_f32 v17, v17, v14
    v_cvt_pk_bf16_f32 v18, v18, v18
    v_lshlrev_b32 v18, 16, v18
    v_lshlrev_b32 v14, 16, v205
    v_add_f32 v18, v18, v14
    v_cvt_pk_bf16_f32 v18, v18, v18
    v_lshlrev_b32 v18, 16, v18
    v_lshlrev_b32 v14, 16, v215
    v_add_f32 v18, v18, v14
    v_cvt_pk_bf16_f32 v19, v19, v19
    v_lshlrev_b32 v19, 16, v19
    v_and_b32 v14, 0xffff0000, v205
    v_add_f32 v19, v19, v14
    v_cvt_pk_bf16_f32 v19, v19, v19
    v_lshlrev_b32 v19, 16, v19
    v_and_b32 v14, 0xffff0000, v215
    v_add_f32 v19, v19, v14
    v_cvt_pk_bf16_f32 v204, v16, v17
    v_cvt_pk_bf16_f32 v205, v18, v19
    buffer_store_dwordx2 v[204:205], v13, s[36:39], 0 offen offset:0
    v_cvt_pk_bf16_f32 v20, v20, v20
    v_lshlrev_b32 v20, 16, v20
    v_lshlrev_b32 v14, 16, v206
    v_add_f32 v20, v20, v14
    v_cvt_pk_bf16_f32 v20, v20, v20
    v_lshlrev_b32 v20, 16, v20
    v_lshlrev_b32 v14, 16, v216
    v_add_f32 v20, v20, v14
    v_cvt_pk_bf16_f32 v21, v21, v21
    v_lshlrev_b32 v21, 16, v21
    v_and_b32 v14, 0xffff0000, v206
    v_add_f32 v21, v21, v14
    v_cvt_pk_bf16_f32 v21, v21, v21
    v_lshlrev_b32 v21, 16, v21
    v_and_b32 v14, 0xffff0000, v216
    v_add_f32 v21, v21, v14
    v_cvt_pk_bf16_f32 v22, v22, v22
    v_lshlrev_b32 v22, 16, v22
    v_lshlrev_b32 v14, 16, v207
    v_add_f32 v22, v22, v14
    v_cvt_pk_bf16_f32 v22, v22, v22
    v_lshlrev_b32 v22, 16, v22
    v_lshlrev_b32 v14, 16, v217
    v_add_f32 v22, v22, v14
    v_cvt_pk_bf16_f32 v23, v23, v23
    v_lshlrev_b32 v23, 16, v23
    v_and_b32 v14, 0xffff0000, v207
    v_add_f32 v23, v23, v14
    v_cvt_pk_bf16_f32 v23, v23, v23
    v_lshlrev_b32 v23, 16, v23
    v_and_b32 v14, 0xffff0000, v217
    v_add_f32 v23, v23, v14
    v_cvt_pk_bf16_f32 v206, v20, v21
    v_cvt_pk_bf16_f32 v207, v22, v23
    buffer_store_dwordx2 v[206:207], v13, s[36:39], 0 offen offset:32
    v_cvt_pk_bf16_f32 v24, v24, v24
    v_lshlrev_b32 v24, 16, v24
    v_lshlrev_b32 v14, 16, v208
    v_add_f32 v24, v24, v14
    v_cvt_pk_bf16_f32 v24, v24, v24
    v_lshlrev_b32 v24, 16, v24
    v_lshlrev_b32 v14, 16, v218
    v_add_f32 v24, v24, v14
    v_cvt_pk_bf16_f32 v25, v25, v25
    v_lshlrev_b32 v25, 16, v25
    v_and_b32 v14, 0xffff0000, v208
    v_add_f32 v25, v25, v14
    v_cvt_pk_bf16_f32 v25, v25, v25
    v_lshlrev_b32 v25, 16, v25
    v_and_b32 v14, 0xffff0000, v218
    v_add_f32 v25, v25, v14
    v_cvt_pk_bf16_f32 v26, v26, v26
    v_lshlrev_b32 v26, 16, v26
    v_lshlrev_b32 v14, 16, v209
    v_add_f32 v26, v26, v14
    v_cvt_pk_bf16_f32 v26, v26, v26
    v_lshlrev_b32 v26, 16, v26
    v_lshlrev_b32 v14, 16, v219
    v_add_f32 v26, v26, v14
    v_cvt_pk_bf16_f32 v27, v27, v27
    v_lshlrev_b32 v27, 16, v27
    v_and_b32 v14, 0xffff0000, v209
    v_add_f32 v27, v27, v14
    v_cvt_pk_bf16_f32 v27, v27, v27
    v_lshlrev_b32 v27, 16, v27
    v_and_b32 v14, 0xffff0000, v219
    v_add_f32 v27, v27, v14
    v_cvt_pk_bf16_f32 v208, v24, v25
    v_cvt_pk_bf16_f32 v209, v26, v27
    buffer_store_dwordx2 v[208:209], v13, s[36:39], 0 offen offset:64
    v_cvt_pk_bf16_f32 v28, v28, v28
    v_lshlrev_b32 v28, 16, v28
    v_lshlrev_b32 v14, 16, v210
    v_add_f32 v28, v28, v14
    v_cvt_pk_bf16_f32 v28, v28, v28
    v_lshlrev_b32 v28, 16, v28
    v_lshlrev_b32 v14, 16, v220
    v_add_f32 v28, v28, v14
    v_cvt_pk_bf16_f32 v29, v29, v29
    v_lshlrev_b32 v29, 16, v29
    v_and_b32 v14, 0xffff0000, v210
    v_add_f32 v29, v29, v14
    v_cvt_pk_bf16_f32 v29, v29, v29
    v_lshlrev_b32 v29, 16, v29
    v_and_b32 v14, 0xffff0000, v220
    v_add_f32 v29, v29, v14
    v_cvt_pk_bf16_f32 v30, v30, v30
    v_lshlrev_b32 v30, 16, v30
    v_lshlrev_b32 v14, 16, v211
    v_add_f32 v30, v30, v14
    v_cvt_pk_bf16_f32 v30, v30, v30
    v_lshlrev_b32 v30, 16, v30
    v_lshlrev_b32 v14, 16, v221
    v_add_f32 v30, v30, v14
    v_cvt_pk_bf16_f32 v31, v31, v31
    v_lshlrev_b32 v31, 16, v31
    v_and_b32 v14, 0xffff0000, v211
    v_add_f32 v31, v31, v14
    v_cvt_pk_bf16_f32 v31, v31, v31
    v_lshlrev_b32 v31, 16, v31
    v_and_b32 v14, 0xffff0000, v221
    v_add_f32 v31, v31, v14
    v_cvt_pk_bf16_f32 v210, v28, v29
    v_cvt_pk_bf16_f32 v211, v30, v31
    buffer_store_dwordx2 v[210:211], v13, s[36:39], 0 offen offset:96
    v_cvt_pk_bf16_f32 v32, v32, v32
    v_lshlrev_b32 v32, 16, v32
    v_lshlrev_b32 v14, 16, v212
    v_add_f32 v32, v32, v14
    v_cvt_pk_bf16_f32 v32, v32, v32
    v_lshlrev_b32 v32, 16, v32
    v_lshlrev_b32 v14, 16, v222
    v_add_f32 v32, v32, v14
    v_cvt_pk_bf16_f32 v33, v33, v33
    v_lshlrev_b32 v33, 16, v33
    v_and_b32 v14, 0xffff0000, v212
    v_add_f32 v33, v33, v14
    v_cvt_pk_bf16_f32 v33, v33, v33
    v_lshlrev_b32 v33, 16, v33
    v_and_b32 v14, 0xffff0000, v222
    v_add_f32 v33, v33, v14
    v_cvt_pk_bf16_f32 v34, v34, v34
    v_lshlrev_b32 v34, 16, v34
    v_lshlrev_b32 v14, 16, v213
    v_add_f32 v34, v34, v14
    v_cvt_pk_bf16_f32 v34, v34, v34
    v_lshlrev_b32 v34, 16, v34
    v_lshlrev_b32 v14, 16, v223
    v_add_f32 v34, v34, v14
    v_cvt_pk_bf16_f32 v35, v35, v35
    v_lshlrev_b32 v35, 16, v35
    v_and_b32 v14, 0xffff0000, v213
    v_add_f32 v35, v35, v14
    v_cvt_pk_bf16_f32 v35, v35, v35
    v_lshlrev_b32 v35, 16, v35
    v_and_b32 v14, 0xffff0000, v223
    v_add_f32 v35, v35, v14
    v_cvt_pk_bf16_f32 v212, v32, v33
    v_cvt_pk_bf16_f32 v213, v34, v35
    buffer_store_dwordx2 v[212:213], v13, s[36:39], 0 offen offset:128
L_end_g2a_kernel:
    s_endpgm
.globl rf2_kernel
.p2align 8
.type rf2_kernel,@function
rf2_kernel:
    s_cmp_ge_u32 s2, 256
    s_cbranch_scc1 L_end_rf2_kernel
    s_load_dwordx16 s[4:19], s[0:1], 0
    s_load_dwordx4 s[20:23], s[0:1], 64
    s_load_dwordx2 s[24:25], s[0:1], 80
    s_waitcnt lgkmcnt(0)
    s_add_u32 s28, s24, 0x1c00000
    s_addc_u32 s29, s25, 0
    s_mov_b32 s30, 0x280000
    s_mov_b32 s31, 0x00020000
    s_add_u32 s32, s24, 0x0
    s_addc_u32 s33, s25, 0
    s_mov_b32 s34, 0x504000
    s_mov_b32 s35, 0x00020000
    v_and_b32 v1, 63, v0
    v_lshrrev_b32 v2, 6, v0
    s_nop 1
    v_readfirstlane_b32 s26, v2
    s_nop 3
    s_lshl_b32 s27, s2, 3
    s_add_u32 s27, s27, s26
    s_mul_i32 s27, s27, 1280
    v_lshlrev_b32 v2, 2, v1
    buffer_load_dword v3, v2, s[28:31], s27 offen offset:0
    buffer_load_dword v4, v2, s[28:31], s27 offen offset:256
    buffer_load_dword v5, v2, s[28:31], s27 offen offset:512
    buffer_load_dword v6, v2, s[28:31], s27 offen offset:768
    buffer_load_dword v7, v2, s[28:31], s27 offen offset:1024
    s_waitcnt vmcnt(0)
    v_lshlrev_b32 v8, 16, v3
    v_and_b32 v3, 0xffff0000, v3
    v_lshlrev_b32 v9, 16, v4
    v_and_b32 v4, 0xffff0000, v4
    v_lshlrev_b32 v10, 16, v5
    v_and_b32 v5, 0xffff0000, v5
    v_lshlrev_b32 v11, 16, v6
    v_and_b32 v6, 0xffff0000, v6
    v_lshlrev_b32 v12, 16, v7
    v_and_b32 v7, 0xffff0000, v7
    v_add_f32 v13, v8, v3
    v_add_f32 v13, v13, v9
    v_add_f32 v13, v13, v4
    v_add_f32 v13, v13, v10
    v_add_f32 v13, v13, v5
    v_add_f32 v13, v13, v11
    v_add_f32 v13, v13, v6
    v_add_f32 v13, v13, v12
    v_add_f32 v13, v13, v7
    ds_swizzle_b32 v16, v13 offset:0x41f
    s_waitcnt lgkmcnt(0)
    v_add_f32 v13, v13, v16
    ds_swizzle_b32 v16, v13 offset:0x81f
    s_waitcnt lgkmcnt(0)
    v_add_f32 v13, v13, v16
    ds_swizzle_b32 v16, v13 offset:0x101f
    s_waitcnt lgkmcnt(0)
    v_add_f32 v13, v13, v16
    ds_swizzle_b32 v16, v13 offset:0x201f
    s_waitcnt lgkmcnt(0)
    v_add_f32 v13, v13, v16
    ds_swizzle_b32 v16, v13 offset:0x401f
    s_waitcnt lgkmcnt(0)
    v_add_f32 v13, v13, v16
    s_nop 1
    v_readlane_b32 s60, v13, 32
    s_nop 3
    v_add_f32 v13, s60, v13
    s_nop 1
    v_readlane_b32 s60, v13, 0
    s_nop 3
    v_mov_b32 v15, s60
    v_mul_f32 v15, 0x3acccccd, v15
    v_mov_b32 v13, 0
    v_sub_f32 v14, v8, v15
    v_fmac_f32 v13, v14, v14
    v_sub_f32 v14, v3, v15
    v_fmac_f32 v13, v14, v14
    v_sub_f32 v14, v9, v15
    v_fmac_f32 v13, v14, v14
    v_sub_f32 v14, v4, v15
    v_fmac_f32 v13, v14, v14
    v_sub_f32 v14, v10, v15
    v_fmac_f32 v13, v14, v14
    v_sub_f32 v14, v5, v15
    v_fmac_f32 v13, v14, v14
    v_sub_f32 v14, v11, v15
    v_fmac_f32 v13, v14, v14
    v_sub_f32 v14, v6, v15
    v_fmac_f32 v13, v14, v14
    v_sub_f32 v14, v12, v15
    v_fmac_f32 v13, v14, v14
    v_sub_f32 v14, v7, v15
    v_fmac_f32 v13, v14, v14
    ds_swizzle_b32 v16, v13 offset:0x41f
    s_waitcnt lgkmcnt(0)
    v_add_f32 v13, v13, v16
    ds_swizzle_b32 v16, v13 offset:0x81f
    s_waitcnt lgkmcnt(0)
    v_add_f32 v13, v13, v16
    ds_swizzle_b32 v16, v13 offset:0x101f
    s_waitcnt lgkmcnt(0)
    v_add_f32 v13, v13, v16
    ds_swizzle_b32 v16, v13 offset:0x201f
    s_waitcnt lgkmcnt(0)
    v_add_f32 v13, v13, v16
    ds_swizzle_b32 v16, v13 offset:0x401f
    s_waitcnt lgkmcnt(0)
    v_add_f32 v13, v13, v16
    s_nop 1
    v_readlane_b32 s60, v13, 32
    s_nop 3
    v_add_f32 v13, s60, v13
    s_nop 1
    v_readlane_b32 s60, v13, 0
    s_nop 3
    v_mov_b32 v13, s60
    v_mul_f32 v13, 0x3acccccd, v13
    v_cvt_pk_bf16_f32 v15, v15, v15
    v_lshlrev_b32 v15, 16, v15
    v_cvt_pk_bf16_f32 v13, v13, v13
    v_lshlrev_b32 v13, 16, v13
    v_add_f32 v13, 0x3727c5ac, v13
    v_cvt_pk_bf16_f32 v13, v13, v13
    v_lshlrev_b32 v13, 16, v13
    v_sqrt_f32 v13, v13
    s_nop 0
    v_cvt_pk_bf16_f32 v13, v13, v13
    v_lshlrev_b32 v13, 16, v13
    v_rcp_f32 v13, v13
    s_nop 0
    v_sub_f32 v8, v8, v15
    v_cvt_pk_bf16_f32 v8, v8, v8
    v_lshlrev_b32 v8, 16, v8
    v_mul_f32 v8, v8, v13
    v_cvt_pk_bf16_f32 v8, v8, v8
    v_lshlrev_b32 v8, 16, v8
    v_sub_f32 v3, v3, v15
    v_cvt_pk_bf16_f32 v3, v3, v3
    v_lshlrev_b32 v3, 16, v3
    v_mul_f32 v3, v3, v13
    v_cvt_pk_bf16_f32 v3, v3, v3
    v_lshlrev_b32 v3, 16, v3
    v_sub_f32 v9, v9, v15
    v_cvt_pk_bf16_f32 v9, v9, v9
    v_lshlrev_b32 v9, 16, v9
    v_mul_f32 v9, v9, v13
    v_cvt_pk_bf16_f32 v9, v9, v9
    v_lshlrev_b32 v9, 16, v9
    v_sub_f32 v4, v4, v15
    v_cvt_pk_bf16_f32 v4, v4, v4
    v_lshlrev_b32 v4, 16, v4
    v_mul_f32 v4, v4, v13
    v_cvt_pk_bf16_f32 v4, v4, v4
    v_lshlrev_b32 v4, 16, v4
    v_sub_f32 v10, v10, v15
    v_cvt_pk_bf16_f32 v10, v10, v10
    v_lshlrev_b32 v10, 16, v10
    v_mul_f32 v10, v10, v13
    v_cvt_pk_bf16_f32 v10, v10, v10
    v_lshlrev_b32 v10, 16, v10
    v_sub_f32 v5, v5, v15
    v_cvt_pk_bf16_f32 v5, v5, v5
    v_lshlrev_b32 v5, 16, v5
    v_mul_f32 v5, v5, v13
    v_cvt_pk_bf16_f32 v5, v5, v5
    v_lshlrev_b32 v5, 16, v5
    v_sub_f32 v11, v11, v15
    v_cvt_pk_bf16_f32 v11, v11, v11
    v_lshlrev_b32 v11, 16, v11
    v_mul_f32 v11, v11, v13
    v_cvt_pk_bf16_f32 v11, v11, v11
    v_lshlrev_b32 v11, 16, v11
    v_sub_f32 v6, v6, v15
    v_cvt_pk_bf16_f32 v6, v6, v6
    v_lshlrev_b32 v6, 16, v6
    v_mul_f32 v6, v6, v13
    v_cvt_pk_bf16_f32 v6, v6, v6
    v_lshlrev_b32 v6, 16, v6
    v_sub_f32 v12, v12, v15
    v_cvt_pk_bf16_f32 v12, v12, v12
    v_lshlrev_b32 v12, 16, v12
    v_mul_f32 v12, v12, v13
    v_cvt_pk_bf16_f32 v12, v12, v12
    v_lshlrev_b32 v12, 16, v12
    v_sub_f32 v7, v7, v15
    v_cvt_pk_bf16_f32 v7, v7, v7
    v_lshlrev_b32 v7, 16, v7
    v_mul_f32 v7, v7, v13
    v_cvt_pk_bf16_f32 v7, v7, v7
    v_lshlrev_b32 v7, 16, v7
    v_add_f32 v13, v9, v12
    v_add_f32 v14, v4, v7
    v_add_f32 v15, v10, v11
    v_add_f32 v16, v5, v6
    v_sub_f32 v17, v9, v12
    v_sub_f32 v18, v4, v7
    v_sub_f32 v19, v10, v11
    v_sub_f32 v20, v5, v6
    v_add_f32 v21, v8, v13
    v_add_f32 v22, v3, v14
    v_add_f32 v23, v21, v15
    v_add_f32 v24, v22, v16
    v_mov_b32 v21, v8
    v_fmac_f32 v21, 0x3e9e377a, v13
    v_fmac_f32 v21, 0xbf4f1bbd, v15
    v_mov_b32 v25, v8
    v_fmac_f32 v25, 0xbf4f1bbd, v13
    v_fmac_f32 v25, 0x3e9e377a, v15
    v_mul_f32 v27, 0x3f737871, v17
    v_fmac_f32 v27, 0x3f167918, v19
    v_mul_f32 v29, 0x3f167918, v17
    v_fmac_f32 v29, 0xbf737871, v19
    v_mov_b32 v22, v3
    v_fmac_f32 v22, 0x3e9e377a, v14
    v_fmac_f32 v22, 0xbf4f1bbd, v16
    v_mov_b32 v26, v3
    v_fmac_f32 v26, 0xbf4f1bbd, v14
    v_fmac_f32 v26, 0x3e9e377a, v16
    v_mul_f32 v28, 0x3f737871, v18
    v_fmac_f32 v28, 0x3f167918, v20
    v_mul_f32 v30, 0x3f167918, v18
    v_fmac_f32 v30, 0xbf737871, v20
    v_add_f32 v3, v21, v28
    v_sub_f32 v4, v22, v27
    v_sub_f32 v5, v21, v28
    v_add_f32 v6, v22, v27
    v_add_f32 v7, v25, v30
    v_sub_f32 v8, v26, v29
    v_sub_f32 v9, v25, v30
    v_add_f32 v10, v26, v29
    s_mul_i32 s27, s26, 2576
    v_mul_u32_u24 v11, 40, v1
    v_add_u32 v11, s27, v11
    v_mov_b32 v12, v23
    v_mov_b32 v13, v24
    ds_write_b64 v11, v[12:13] offset:0
    v_mov_b32 v12, v3
    v_mov_b32 v13, v4
    ds_write_b64 v11, v[12:13] offset:8
    v_mov_b32 v12, v7
    v_mov_b32 v13, v8
    ds_write_b64 v11, v[12:13] offset:16
    v_mov_b32 v12, v9
    v_mov_b32 v13, v10
    ds_write_b64 v11, v[12:13] offset:24
    v_mov_b32 v12, v5
    v_mov_b32 v13, v6
    ds_write_b64 v11, v[12:13] offset:32
    s_waitcnt lgkmcnt(0)
    s_mov_b64 s[40:41], exec
    s_mov_b32 s42, -1
    s_mov_b32 s43, 0xff
    s_mov_b64 exec, s[42:43]
    v_lshlrev_b32 v3, 3, v1
    v_add_u32 v3, s27, v3
    ds_read_b64 v[4:5], v3 offset:0
    ds_read_b64 v[6:7], v3 offset:320
    ds_read_b64 v[8:9], v3 offset:640
    ds_read_b64 v[12:13], v3 offset:960
    ds_read_b64 v[14:15], v3 offset:1280
    ds_read_b64 v[16:17], v3 offset:1600
    ds_read_b64 v[18:19], v3 offset:1920
    ds_read_b64 v[20:21], v3 offset:2240
    s_waitcnt lgkmcnt(0)
    v_mul_u32_u24 v10, 205, v1
    v_lshrrev_b32 v10, 10, v10
    v_mul_u32_u24 v22, 5, v10
    v_sub_u32 v22, v1, v22
    v_mul_u32_u24 v10, 40, v10
    v_add_u32 v10, v10, v22
    v_lshlrev_b32 v10, 3, v10
    v_add_u32 v10, s27, v10
    v_cvt_f32_u32 v22, v22
    v_mul_f32 v22, 0x3ccccccd, v22
    v_mul_f32 v23, 0x3f800000, v22
    v_cos_f32 v24, v23
    v_sin_f32 v25, v23
    s_nop 0
    v_mul_f32 v26, v6, v24
    v_fma_f32 v26, v7, v25, v26
    v_mul_f32 v27, v7, v24
    v_fma_f32 v27, -v6, v25, v27
    v_mul_f32 v6, 0x40000000, v22
    v_cos_f32 v7, v6
    v_sin_f32 v23, v6
    s_nop 0
    v_mul_f32 v24, v8, v7
    v_fma_f32 v24, v9, v23, v24
    v_mul_f32 v25, v9, v7
    v_fma_f32 v25, -v8, v23, v25
    v_mul_f32 v6, 0x40400000, v22
    v_cos_f32 v7, v6
    v_sin_f32 v8, v6
    s_nop 0
    v_mul_f32 v9, v12, v7
    v_fma_f32 v9, v13, v8, v9
    v_mul_f32 v23, v13, v7
    v_fma_f32 v23, -v12, v8, v23
    v_mul_f32 v6, 0x40800000, v22
    v_cos_f32 v7, v6
    v_sin_f32 v8, v6
    s_nop 0
    v_mul_f32 v12, v14, v7
    v_fma_f32 v12, v15, v8, v12
    v_mul_f32 v13, v15, v7
    v_fma_f32 v13, -v14, v8, v13
    v_mul_f32 v6, 0x40a00000, v22
    v_cos_f32 v7, v6
    v_sin_f32 v8, v6
    s_nop 0
    v_mul_f32 v14, v16, v7
    v_fma_f32 v14, v17, v8, v14
    v_mul_f32 v15, v17, v7
    v_fma_f32 v15, -v16, v8, v15
    v_mul_f32 v6, 0x40c00000, v22
    v_cos_f32 v7, v6
    v_sin_f32 v8, v6
    s_nop 0
    v_mul_f32 v16, v18, v7
    v_fma_f32 v16, v19, v8, v16
    v_mul_f32 v17, v19, v7
    v_fma_f32 v17, -v18, v8, v17
    v_mul_f32 v6, 0x40e00000, v22
    v_cos_f32 v7, v6
    v_sin_f32 v8, v6
    s_nop 0
    v_mul_f32 v18, v20, v7
    v_fma_f32 v18, v21, v8, v18
    v_mul_f32 v19, v21, v7
    v_fma_f32 v19, -v20, v8, v19
    v_add_f32 v6, v4, v12
    v_add_f32 v7, v5, v13
    v_sub_f32 v8, v4, v12
    v_sub_f32 v20, v5, v13
    v_add_f32 v21, v24, v16
    v_add_f32 v28, v25, v17
    v_sub_f32 v29, v24, v16
    v_sub_f32 v30, v25, v17
    v_add_f32 v4, v6, v21
    v_add_f32 v5, v7, v28
    v_sub_f32 v12, v6, v21
    v_sub_f32 v13, v7, v28
    v_add_f32 v16, v8, v30
    v_sub_f32 v17, v20, v29
    v_sub_f32 v24, v8, v30
    v_add_f32 v25, v20, v29
    v_add_f32 v6, v26, v14
    v_add_f32 v7, v27, v15
    v_sub_f32 v8, v26, v14
    v_sub_f32 v20, v27, v15
    v_add_f32 v21, v9, v18
    v_add_f32 v28, v23, v19
    v_sub_f32 v29, v9, v18
    v_sub_f32 v30, v23, v19
    v_add_f32 v9, v6, v21
    v_add_f32 v14, v7, v28
    v_sub_f32 v15, v6, v21
    v_sub_f32 v18, v7, v28
    v_add_f32 v19, v8, v30
    v_sub_f32 v23, v20, v29
    v_sub_f32 v26, v8, v30
    v_add_f32 v27, v20, v29
    v_add_f32 v6, v19, v23
    v_sub_f32 v7, v23, v19
    v_mul_f32 v6, 0x3f3504f3, v6
    v_mul_f32 v7, 0x3f3504f3, v7
    v_add_f32 v8, v26, v27
    v_sub_f32 v19, v27, v26
    v_mul_f32 v8, 0x3f3504f3, v8
    v_mul_f32 v19, 0x3f3504f3, v19
    v_add_f32 v20, v4, v9
    v_add_f32 v21, v5, v14
    v_sub_f32 v23, v4, v9
    v_sub_f32 v26, v5, v14
    v_add_f32 v27, v16, v6
    v_add_f32 v28, v17, v7
    v_sub_f32 v29, v16, v6
    v_sub_f32 v30, v17, v7
    v_add_f32 v31, v12, v18
    v_sub_f32 v32, v13, v15
    v_sub_f32 v33, v12, v18
    v_add_f32 v34, v13, v15
    v_add_f32 v35, v24, v19
    v_sub_f32 v36, v25, v8
    v_sub_f32 v37, v24, v19
    v_add_f32 v38, v25, v8
    v_mov_b32 v4, v20
    v_mov_b32 v5, v21
    ds_write_b64 v10, v[4:5] offset:0
    v_mov_b32 v4, v27
    v_mov_b32 v5, v28
    ds_write_b64 v10, v[4:5] offset:40
    v_mov_b32 v4, v31
    v_mov_b32 v5, v32
    ds_write_b64 v10, v[4:5] offset:80
    v_mov_b32 v4, v35
    v_mov_b32 v5, v36
    ds_write_b64 v10, v[4:5] offset:120
    v_mov_b32 v4, v23
    v_mov_b32 v5, v26
    ds_write_b64 v10, v[4:5] offset:160
    v_mov_b32 v4, v29
    v_mov_b32 v5, v30
    ds_write_b64 v10, v[4:5] offset:200
    v_mov_b32 v4, v33
    v_mov_b32 v5, v34
    ds_write_b64 v10, v[4:5] offset:240
    v_mov_b32 v4, v37
    v_mov_b32 v5, v38
    ds_write_b64 v10, v[4:5] offset:280
    s_waitcnt lgkmcnt(0)
    ds_read_b64 v[4:5], v3 offset:0
    ds_read_b64 v[6:7], v3 offset:320
    ds_read_b64 v[8:9], v3 offset:640
    ds_read_b64 v[12:13], v3 offset:960
    ds_read_b64 v[14:15], v3 offset:1280
    ds_read_b64 v[16:17], v3 offset:1600
    ds_read_b64 v[18:19], v3 offset:1920
    ds_read_b64 v[20:21], v3 offset:2240
    s_waitcnt lgkmcnt(0)
    v_mov_b32 v22, v1
    v_cvt_f32_u32 v22, v22
    v_mul_f32 v22, 0x3b4ccccd, v22
    v_mul_f32 v23, 0x3f800000, v22
    v_cos_f32 v24, v23
    v_sin_f32 v25, v23
    s_nop 0
    v_mul_f32 v26, v6, v24
    v_fma_f32 v26, v7, v25, v26
    v_mul_f32 v27, v7, v24
    v_fma_f32 v27, -v6, v25, v27
    v_mul_f32 v6, 0x40000000, v22
    v_cos_f32 v7, v6
    v_sin_f32 v23, v6
    s_nop 0
    v_mul_f32 v24, v8, v7
    v_fma_f32 v24, v9, v23, v24
    v_mul_f32 v25, v9, v7
    v_fma_f32 v25, -v8, v23, v25
    v_mul_f32 v6, 0x40400000, v22
    v_cos_f32 v7, v6
    v_sin_f32 v8, v6
    s_nop 0
    v_mul_f32 v9, v12, v7
    v_fma_f32 v9, v13, v8, v9
    v_mul_f32 v23, v13, v7
    v_fma_f32 v23, -v12, v8, v23
    v_mul_f32 v6, 0x40800000, v22
    v_cos_f32 v7, v6
    v_sin_f32 v8, v6
    s_nop 0
    v_mul_f32 v12, v14, v7
    v_fma_f32 v12, v15, v8, v12
    v_mul_f32 v13, v15, v7
    v_fma_f32 v13, -v14, v8, v13
    v_mul_f32 v6, 0x40a00000, v22
    v_cos_f32 v7, v6
    v_sin_f32 v8, v6
    s_nop 0
    v_mul_f32 v14, v16, v7
    v_fma_f32 v14, v17, v8, v14
    v_mul_f32 v15, v17, v7
    v_fma_f32 v15, -v16, v8, v15
    v_mul_f32 v6, 0x40c00000, v22
    v_cos_f32 v7, v6
    v_sin_f32 v8, v6
    s_nop 0
    v_mul_f32 v16, v18, v7
    v_fma_f32 v16, v19, v8, v16
    v_mul_f32 v17, v19, v7
    v_fma_f32 v17, -v18, v8, v17
    v_mul_f32 v6, 0x40e00000, v22
    v_cos_f32 v7, v6
    v_sin_f32 v8, v6
    s_nop 0
    v_mul_f32 v18, v20, v7
    v_fma_f32 v18, v21, v8, v18
    v_mul_f32 v19, v21, v7
    v_fma_f32 v19, -v20, v8, v19
    v_add_f32 v6, v4, v12
    v_add_f32 v7, v5, v13
    v_sub_f32 v8, v4, v12
    v_sub_f32 v20, v5, v13
    v_add_f32 v21, v24, v16
    v_add_f32 v28, v25, v17
    v_sub_f32 v29, v24, v16
    v_sub_f32 v30, v25, v17
    v_add_f32 v4, v6, v21
    v_add_f32 v5, v7, v28
    v_sub_f32 v12, v6, v21
    v_sub_f32 v13, v7, v28
    v_add_f32 v16, v8, v30
    v_sub_f32 v17, v20, v29
    v_sub_f32 v24, v8, v30
    v_add_f32 v25, v20, v29
    v_add_f32 v6, v26, v14
    v_add_f32 v7, v27, v15
    v_sub_f32 v8, v26, v14
    v_sub_f32 v20, v27, v15
    v_add_f32 v21, v9, v18
    v_add_f32 v28, v23, v19
    v_sub_f32 v29, v9, v18
    v_sub_f32 v30, v23, v19
    v_add_f32 v9, v6, v21
    v_add_f32 v14, v7, v28
    v_sub_f32 v15, v6, v21
    v_sub_f32 v18, v7, v28
    v_add_f32 v19, v8, v30
    v_sub_f32 v23, v20, v29
    v_sub_f32 v26, v8, v30
    v_add_f32 v27, v20, v29
    v_add_f32 v6, v19, v23
    v_sub_f32 v7, v23, v19
    v_mul_f32 v6, 0x3f3504f3, v6
    v_mul_f32 v7, 0x3f3504f3, v7
    v_add_f32 v8, v26, v27
    v_sub_f32 v19, v27, v26
    v_mul_f32 v8, 0x3f3504f3, v8
    v_mul_f32 v19, 0x3f3504f3, v19
    v_add_f32 v20, v4, v9
    v_add_f32 v21, v5, v14
    v_sub_f32 v23, v4, v9
    v_sub_f32 v26, v5, v14
    v_add_f32 v27, v16, v6
    v_add_f32 v28, v17, v7
    v_sub_f32 v29, v16, v6
    v_sub_f32 v30, v17, v7
    v_add_f32 v31, v12, v18
    v_sub_f32 v32, v13, v15
    v_sub_f32 v33, v12, v18
    v_add_f32 v34, v13, v15
    v_add_f32 v35, v24, v19
    v_sub_f32 v36, v25, v8
    v_sub_f32 v37, v24, v19
    v_add_f32 v38, v25, v8
    v_mov_b32 v4, v20
    v_mov_b32 v5, v21
    ds_write_b64 v3, v[4:5] offset:0
    v_mov_b32 v4, v27
    v_mov_b32 v5, v28
    ds_write_b64 v3, v[4:5] offset:320
    v_mov_b32 v4, v31
    v_mov_b32 v5, v32
    ds_write_b64 v3, v[4:5] offset:640
    v_mov_b32 v4, v35
    v_mov_b32 v5, v36
    ds_write_b64 v3, v[4:5] offset:960
    v_mov_b32 v4, v23
    v_mov_b32 v5, v26
    ds_write_b64 v3, v[4:5] offset:1280
    v_mov_b32 v4, v29
    v_mov_b32 v5, v30
    ds_write_b64 v3, v[4:5] offset:1600
    v_mov_b32 v4, v33
    v_mov_b32 v5, v34
    ds_write_b64 v3, v[4:5] offset:1920
    v_mov_b32 v4, v37
    v_mov_b32 v5, v38
    ds_write_b64 v3, v[4:5] offset:2240
    s_mov_b64 exec, s[40:41]
    s_waitcnt lgkmcnt(0)
    s_barrier
    v_and_b32 v4, 7, v0
    v_lshrrev_b32 v5, 3, v0
    v_mul_u32_u24 v6, 2576, v4
    s_lshl_b32 s27, s2, 3
    v_add_u32 v4, s27, v4
    v_add_u32 v7, 0, v5
    v_cmp_eq_u32 vcc, 320, v7
    v_cndmask_b32 v8, v7, 0, vcc
    v_sub_u32 v9, 320, v7
    v_cmp_eq_u32 vcc, 0, v7
    v_cndmask_b32 v9, v9, 0, vcc
    v_lshlrev_b32 v8, 3, v8
    v_add_u32 v8, v8, v6
    v_lshlrev_b32 v9, 3, v9
    v_add_u32 v9, v9, v6
    ds_read_b64 v[12:13], v8 offset:0
    s_waitcnt lgkmcnt(0)
    ds_read_b64 v[14:15], v9 offset:0
    s_waitcnt lgkmcnt(0)
    v_add_f32 v16, v12, v14
    v_sub_f32 v17, v13, v15
    v_sub_f32 v18, v12, v14
    v_add_f32 v19, v13, v15
    v_mov_b32 v8, v7
    v_cvt_f32_u32 v8, v8
    v_mul_f32 v8, 0x3acccccd, v8
    v_cos_f32 v20, v8
    v_sin_f32 v21, v8
    s_nop 0
    v_fma_f32 v24, -v21, v18, v16
    v_fma_f32 v24, v20, v19, v24
    v_fma_f32 v25, -v21, v19, v17
    v_fma_f32 v25, -v20, v18, v25
    v_mul_f32 v24, 0.5, v24
    v_mul_f32 v25, 0.5, v25
    v_lshlrev_b32 v7, 11, v7
    v_add_u32 v7, v7, v4
    v_lshlrev_b32 v7, 3, v7
    buffer_store_dwordx2 v[24:25], v7, s[32:35], 0 offen
    s_nop 1
    v_add_u32 v7, 64, v5
    v_cmp_eq_u32 vcc, 320, v7
    v_cndmask_b32 v8, v7, 0, vcc
    v_sub_u32 v9, 320, v7
    v_cmp_eq_u32 vcc, 0, v7
    v_cndmask_b32 v9, v9, 0, vcc
    v_lshlrev_b32 v8, 3, v8
    v_add_u32 v8, v8, v6
    v_lshlrev_b32 v9, 3, v9
    v_add_u32 v9, v9, v6
    ds_read_b64 v[12:13], v8 offset:0
    s_waitcnt lgkmcnt(0)
    ds_read_b64 v[14:15], v9 offset:0
    s_waitcnt lgkmcnt(0)
    v_add_f32 v16, v12, v14
    v_sub_f32 v17, v13, v15
    v_sub_f32 v18, v12, v14
    v_add_f32 v19, v13, v15
    v_mov_b32 v8, v7
    v_cvt_f32_u32 v8, v8
    v_mul_f32 v8, 0x3acccccd, v8
    v_cos_f32 v20, v8
    v_sin_f32 v21, v8
    s_nop 0
    v_fma_f32 v24, -v21, v18, v16
    v_fma_f32 v24, v20, v19, v24
    v_fma_f32 v25, -v21, v19, v17
    v_fma_f32 v25, -v20, v18, v25
    v_mul_f32 v24, 0.5, v24
    v_mul_f32 v25, 0.5, v25
    v_lshlrev_b32 v7, 11, v7
    v_add_u32 v7, v7, v4
    v_lshlrev_b32 v7, 3, v7
    buffer_store_dwordx2 v[24:25], v7, s[32:35], 0 offen
    s_nop 1
    v_add_u32 v7, 128, v5
    v_cmp_eq_u32 vcc, 320, v7
    v_cndmask_b32 v8, v7, 0, vcc
    v_sub_u32 v9, 320, v7
    v_cmp_eq_u32 vcc, 0, v7
    v_cndmask_b32 v9, v9, 0, vcc
    v_lshlrev_b32 v8, 3, v8
    v_add_u32 v8, v8, v6
    v_lshlrev_b32 v9, 3, v9
    v_add_u32 v9, v9, v6
    ds_read_b64 v[12:13], v8 offset:0
    s_waitcnt lgkmcnt(0)
    ds_read_b64 v[14:15], v9 offset:0
    s_waitcnt lgkmcnt(0)
    v_add_f32 v16, v12, v14
    v_sub_f32 v17, v13, v15
    v_sub_f32 v18, v12, v14
    v_add_f32 v19, v13, v15
    v_mov_b32 v8, v7
    v_cvt_f32_u32 v8, v8
    v_mul_f32 v8, 0x3acccccd, v8
    v_cos_f32 v20, v8
    v_sin_f32 v21, v8
    s_nop 0
    v_fma_f32 v24, -v21, v18, v16
    v_fma_f32 v24, v20, v19, v24
    v_fma_f32 v25, -v21, v19, v17
    v_fma_f32 v25, -v20, v18, v25
    v_mul_f32 v24, 0.5, v24
    v_mul_f32 v25, 0.5, v25
    v_lshlrev_b32 v7, 11, v7
    v_add_u32 v7, v7, v4
    v_lshlrev_b32 v7, 3, v7
    buffer_store_dwordx2 v[24:25], v7, s[32:35], 0 offen
    s_nop 1
    v_add_u32 v7, 192, v5
    v_cmp_eq_u32 vcc, 320, v7
    v_cndmask_b32 v8, v7, 0, vcc
    v_sub_u32 v9, 320, v7
    v_cmp_eq_u32 vcc, 0, v7
    v_cndmask_b32 v9, v9, 0, vcc
    v_lshlrev_b32 v8, 3, v8
    v_add_u32 v8, v8, v6
    v_lshlrev_b32 v9, 3, v9
    v_add_u32 v9, v9, v6
    ds_read_b64 v[12:13], v8 offset:0
    s_waitcnt lgkmcnt(0)
    ds_read_b64 v[14:15], v9 offset:0
    s_waitcnt lgkmcnt(0)
    v_add_f32 v16, v12, v14
    v_sub_f32 v17, v13, v15
    v_sub_f32 v18, v12, v14
    v_add_f32 v19, v13, v15
    v_mov_b32 v8, v7
    v_cvt_f32_u32 v8, v8
    v_mul_f32 v8, 0x3acccccd, v8
    v_cos_f32 v20, v8
    v_sin_f32 v21, v8
    s_nop 0
    v_fma_f32 v24, -v21, v18, v16
    v_fma_f32 v24, v20, v19, v24
    v_fma_f32 v25, -v21, v19, v17
    v_fma_f32 v25, -v20, v18, v25
    v_mul_f32 v24, 0.5, v24
    v_mul_f32 v25, 0.5, v25
    v_lshlrev_b32 v7, 11, v7
    v_add_u32 v7, v7, v4
    v_lshlrev_b32 v7, 3, v7
    buffer_store_dwordx2 v[24:25], v7, s[32:35], 0 offen
    s_nop 1
    v_add_u32 v7, 256, v5
    v_cmp_eq_u32 vcc, 320, v7
    v_cndmask_b32 v8, v7, 0, vcc
    v_sub_u32 v9, 320, v7
    v_cmp_eq_u32 vcc, 0, v7
    v_cndmask_b32 v9, v9, 0, vcc
    v_lshlrev_b32 v8, 3, v8
    v_add_u32 v8, v8, v6
    v_lshlrev_b32 v9, 3, v9
    v_add_u32 v9, v9, v6
    ds_read_b64 v[12:13], v8 offset:0
    s_waitcnt lgkmcnt(0)
    ds_read_b64 v[14:15], v9 offset:0
    s_waitcnt lgkmcnt(0)
    v_add_f32 v16, v12, v14
    v_sub_f32 v17, v13, v15
    v_sub_f32 v18, v12, v14
    v_add_f32 v19, v13, v15
    v_mov_b32 v8, v7
    v_cvt_f32_u32 v8, v8
    v_mul_f32 v8, 0x3acccccd, v8
    v_cos_f32 v20, v8
    v_sin_f32 v21, v8
    s_nop 0
    v_fma_f32 v24, -v21, v18, v16
    v_fma_f32 v24, v20, v19, v24
    v_fma_f32 v25, -v21, v19, v17
    v_fma_f32 v25, -v20, v18, v25
    v_mul_f32 v24, 0.5, v24
    v_mul_f32 v25, 0.5, v25
    v_lshlrev_b32 v7, 11, v7
    v_add_u32 v7, v7, v4
    v_lshlrev_b32 v7, 3, v7
    buffer_store_dwordx2 v[24:25], v7, s[32:35], 0 offen
    s_nop 1
    v_add_u32 v7, 320, v5
    v_cmp_eq_u32 vcc, 320, v7
    s_and_saveexec_b64 s[40:41], vcc
    v_cmp_eq_u32 vcc, 320, v7
    v_cndmask_b32 v8, v7, 0, vcc
    v_sub_u32 v9, 320, v7
    v_cmp_eq_u32 vcc, 0, v7
    v_cndmask_b32 v9, v9, 0, vcc
    v_lshlrev_b32 v8, 3, v8
    v_add_u32 v8, v8, v6
    v_lshlrev_b32 v9, 3, v9
    v_add_u32 v9, v9, v6
    ds_read_b64 v[12:13], v8 offset:0
    s_waitcnt lgkmcnt(0)
    ds_read_b64 v[14:15], v9 offset:0
    s_waitcnt lgkmcnt(0)
    v_add_f32 v16, v12, v14
    v_sub_f32 v17, v13, v15
    v_sub_f32 v18, v12, v14
    v_add_f32 v19, v13, v15
    v_mov_b32 v8, v7
    v_cvt_f32_u32 v8, v8
    v_mul_f32 v8, 0x3acccccd, v8
    v_cos_f32 v20, v8
    v_sin_f32 v21, v8
    s_nop 0
    v_fma_f32 v24, -v21, v18, v16
    v_fma_f32 v24, v20, v19, v24
    v_fma_f32 v25, -v21, v19, v17
    v_fma_f32 v25, -v20, v18, v25
    v_mul_f32 v24, 0.5, v24
    v_mul_f32 v25, 0.5, v25
    v_lshlrev_b32 v7, 11, v7
    v_add_u32 v7, v7, v4
    v_lshlrev_b32 v7, 3, v7
    buffer_store_dwordx2 v[24:25], v7, s[32:35], 0 offen
    s_nop 1
L_end_rf2_kernel:
    s_endpgm
.globl col2_kernel
.p2align 8
.type col2_kernel,@function
col2_kernel:
    s_cmp_ge_u32 s2, 321
    s_cbranch_scc1 L_end_col2_kernel
    s_load_dwordx16 s[4:19], s[0:1], 0
    s_load_dwordx4 s[20:23], s[0:1], 64
    s_load_dwordx2 s[24:25], s[0:1], 80
    s_waitcnt lgkmcnt(0)
    s_mul_i32 s27, s2, 16384
    s_lshl_b32 s26, s2, 13
    s_add_u32 s28, s24, 0x0
    s_addc_u32 s29, s25, 0
    s_mov_b32 s30, 0x504000
    s_mov_b32 s31, 0x00020000
    s_add_u32 s32, s24, 0x600000
    s_addc_u32 s33, s25, 0
    s_mov_b32 s34, 0x282000
    s_mov_b32 s35, 0x00020000
    v_lshlrev_b32 v1, 3, v0
    s_add_u32 s40, s27, 0
    buffer_load_dwordx2 v[2:3], v1, s[28:31], s40 offen
    s_add_u32 s40, s27, 2048
    buffer_load_dwordx2 v[4:5], v1, s[28:31], s40 offen
    s_add_u32 s40, s27, 4096
    buffer_load_dwordx2 v[6:7], v1, s[28:31], s40 offen
    s_add_u32 s40, s27, 6144
    buffer_load_dwordx2 v[8:9], v1, s[28:31], s40 offen
    s_add_u32 s40, s27, 8192
    buffer_load_dwordx2 v[10:11], v1, s[28:31], s40 offen
    s_add_u32 s40, s27, 10240
    buffer_load_dwordx2 v[12:13], v1, s[28:31], s40 offen
    s_add_u32 s40, s27, 12288
    buffer_load_dwordx2 v[14:15], v1, s[28:31], s40 offen
    s_add_u32 s40, s27, 14336
    buffer_load_dwordx2 v[16:17], v1, s[28:31], s40 offen
    v_lshlrev_b32 v18, 2, v0
    s_add_u32 s40, s26, 0
    buffer_load_dword v19, v18, s[32:35], s40 offen
    s_add_u32 s40, s26, 1024
    buffer_load_dword v20, v18, s[32:35], s40 offen
    s_add_u32 s40, s26, 2048
    buffer_load_dword v21, v18, s[32:35], s40 offen
    s_add_u32 s40, s26, 3072
    buffer_load_dword v22, v18, s[32:35], s40 offen
    s_add_u32 s40, s26, 4096
    buffer_load_dword v23, v18, s[32:35], s40 offen
    s_add_u32 s40, s26, 5120
    buffer_load_dword v24, v18, s[32:35], s40 offen
    s_add_u32 s40, s26, 6144
    buffer_load_dword v25, v18, s[32:35], s40 offen
    s_add_u32 s40, s26, 7168
    buffer_load_dword v26, v18, s[32:35], s40 offen
    s_waitcnt vmcnt(8)
    v_add_f32 v27, v2, v10
    v_add_f32 v28, v3, v11
    v_sub_f32 v29, v2, v10
    v_sub_f32 v30, v3, v11
    v_add_f32 v31, v6, v14
    v_add_f32 v32, v7, v15
    v_sub_f32 v33, v6, v14
    v_sub_f32 v34, v7, v15
    v_add_f32 v2, v27, v31
    v_add_f32 v3, v28, v32
    v_sub_f32 v6, v27, v31
    v_sub_f32 v7, v28, v32
    v_add_f32 v10, v29, v34
    v_sub_f32 v11, v30, v33
    v_sub_f32 v14, v29, v34
    v_add_f32 v15, v30, v33
    v_add_f32 v27, v4, v12
    v_add_f32 v28, v5, v13
    v_sub_f32 v29, v4, v12
    v_sub_f32 v30, v5, v13
    v_add_f32 v31, v8, v16
    v_add_f32 v32, v9, v17
    v_sub_f32 v33, v8, v16
    v_sub_f32 v34, v9, v17
    v_add_f32 v4, v27, v31
    v_add_f32 v5, v28, v32
    v_sub_f32 v8, v27, v31
    v_sub_f32 v9, v28, v32
    v_add_f32 v12, v29, v34
    v_sub_f32 v13, v30, v33
    v_sub_f32 v16, v29, v34
    v_add_f32 v17, v30, v33
    v_add_f32 v27, v12, v13
    v_sub_f32 v28, v13, v12
    v_mul_f32 v27, 0x3f3504f3, v27
    v_mul_f32 v28, 0x3f3504f3, v28
    v_add_f32 v12, v16, v17
    v_sub_f32 v13, v17, v16
    v_mul_f32 v12, 0x3f3504f3, v12
    v_mul_f32 v13, 0x3f3504f3, v13
    v_add_f32 v16, v2, v4
    v_add_f32 v17, v3, v5
    v_sub_f32 v29, v2, v4
    v_sub_f32 v30, v3, v5
    v_add_f32 v31, v10, v27
    v_add_f32 v32, v11, v28
    v_sub_f32 v33, v10, v27
    v_sub_f32 v34, v11, v28
    v_add_f32 v35, v6, v9
    v_sub_f32 v36, v7, v8
    v_sub_f32 v37, v6, v9
    v_add_f32 v38, v7, v8
    v_add_f32 v39, v14, v13
    v_sub_f32 v40, v15, v12
    v_sub_f32 v41, v14, v13
    v_add_f32 v42, v15, v12
    v_and_b32 v3, 0, v0
    v_lshrrev_b32 v2, 0, v0
    v_lshlrev_b32 v2, 3, v2
    v_add_u32 v2, v2, v3
    v_lshlrev_b32 v2, 3, v2
    v_mov_b32 v4, v16
    v_mov_b32 v5, v17
    ds_write_b64 v2, v[4:5] offset:0
    v_mov_b32 v4, v31
    v_mov_b32 v5, v32
    ds_write_b64 v2, v[4:5] offset:8
    v_mov_b32 v4, v35
    v_mov_b32 v5, v36
    ds_write_b64 v2, v[4:5] offset:16
    v_mov_b32 v4, v39
    v_mov_b32 v5, v40
    ds_write_b64 v2, v[4:5] offset:24
    v_mov_b32 v4, v29
    v_mov_b32 v5, v30
    ds_write_b64 v2, v[4:5] offset:32
    v_mov_b32 v4, v33
    v_mov_b32 v5, v34
    ds_write_b64 v2, v[4:5] offset:40
    v_mov_b32 v4, v37
    v_mov_b32 v5, v38
    ds_write_b64 v2, v[4:5] offset:48
    v_mov_b32 v4, v41
    v_mov_b32 v5, v42
    ds_write_b64 v2, v[4:5] offset:56
    s_waitcnt lgkmcnt(0)
    s_barrier
    ds_read_b64 v[2:3], v1 offset:0
    ds_read_b64 v[4:5], v1 offset:2048
    ds_read_b64 v[6:7], v1 offset:4096
    ds_read_b64 v[8:9], v1 offset:6144
    ds_read_b64 v[10:11], v1 offset:8192
    ds_read_b64 v[12:13], v1 offset:10240
    ds_read_b64 v[14:15], v1 offset:12288
    ds_read_b64 v[16:17], v1 offset:14336
    s_waitcnt lgkmcnt(0)
    v_and_b32 v27, 7, v0
    v_cvt_f32_u32 v27, v27
    v_mul_f32 v27, 0x3c800000, v27
    v_mul_f32 v28, 0x3f800000, v27
    v_cos_f32 v29, v28
    v_sin_f32 v30, v28
    s_nop 0
    v_mul_f32 v31, v4, v29
    v_fma_f32 v31, v5, v30, v31
    v_mul_f32 v32, v5, v29
    v_fma_f32 v32, -v4, v30, v32
    v_mul_f32 v4, 0x40000000, v27
    v_cos_f32 v5, v4
    v_sin_f32 v28, v4
    s_nop 0
    v_mul_f32 v29, v6, v5
    v_fma_f32 v29, v7, v28, v29
    v_mul_f32 v30, v7, v5
    v_fma_f32 v30, -v6, v28, v30
    v_mul_f32 v4, 0x40400000, v27
    v_cos_f32 v5, v4
    v_sin_f32 v6, v4
    s_nop 0
    v_mul_f32 v7, v8, v5
    v_fma_f32 v7, v9, v6, v7
    v_mul_f32 v28, v9, v5
    v_fma_f32 v28, -v8, v6, v28
    v_mul_f32 v4, 0x40800000, v27
    v_cos_f32 v5, v4
    v_sin_f32 v6, v4
    s_nop 0
    v_mul_f32 v8, v10, v5
    v_fma_f32 v8, v11, v6, v8
    v_mul_f32 v9, v11, v5
    v_fma_f32 v9, -v10, v6, v9
    v_mul_f32 v4, 0x40a00000, v27
    v_cos_f32 v5, v4
    v_sin_f32 v6, v4
    s_nop 0
    v_mul_f32 v10, v12, v5
    v_fma_f32 v10, v13, v6, v10
    v_mul_f32 v11, v13, v5
    v_fma_f32 v11, -v12, v6, v11
    v_mul_f32 v4, 0x40c00000, v27
    v_cos_f32 v5, v4
    v_sin_f32 v6, v4
    s_nop 0
    v_mul_f32 v12, v14, v5
    v_fma_f32 v12, v15, v6, v12
    v_mul_f32 v13, v15, v5
    v_fma_f32 v13, -v14, v6, v13
    v_mul_f32 v4, 0x40e00000, v27
    v_cos_f32 v5, v4
    v_sin_f32 v6, v4
    s_nop 0
    v_mul_f32 v14, v16, v5
    v_fma_f32 v14, v17, v6, v14
    v_mul_f32 v15, v17, v5
    v_fma_f32 v15, -v16, v6, v15
    v_add_f32 v4, v2, v8
    v_add_f32 v5, v3, v9
    v_sub_f32 v6, v2, v8
    v_sub_f32 v16, v3, v9
    v_add_f32 v17, v29, v12
    v_add_f32 v27, v30, v13
    v_sub_f32 v33, v29, v12
    v_sub_f32 v34, v30, v13
    v_add_f32 v2, v4, v17
    v_add_f32 v3, v5, v27
    v_sub_f32 v8, v4, v17
    v_sub_f32 v9, v5, v27
    v_add_f32 v12, v6, v34
    v_sub_f32 v13, v16, v33
    v_sub_f32 v29, v6, v34
    v_add_f32 v30, v16, v33
    v_add_f32 v4, v31, v10
    v_add_f32 v5, v32, v11
    v_sub_f32 v6, v31, v10
    v_sub_f32 v16, v32, v11
    v_add_f32 v17, v7, v14
    v_add_f32 v27, v28, v15
    v_sub_f32 v33, v7, v14
    v_sub_f32 v34, v28, v15
    v_add_f32 v7, v4, v17
    v_add_f32 v10, v5, v27
    v_sub_f32 v11, v4, v17
    v_sub_f32 v14, v5, v27
    v_add_f32 v15, v6, v34
    v_sub_f32 v28, v16, v33
    v_sub_f32 v31, v6, v34
    v_add_f32 v32, v16, v33
    v_add_f32 v4, v15, v28
    v_sub_f32 v5, v28, v15
    v_mul_f32 v4, 0x3f3504f3, v4
    v_mul_f32 v5, 0x3f3504f3, v5
    v_add_f32 v6, v31, v32
    v_sub_f32 v15, v32, v31
    v_mul_f32 v6, 0x3f3504f3, v6
    v_mul_f32 v15, 0x3f3504f3, v15
    v_add_f32 v16, v2, v7
    v_add_f32 v17, v3, v10
    v_sub_f32 v27, v2, v7
    v_sub_f32 v28, v3, v10
    v_add_f32 v31, v12, v4
    v_add_f32 v32, v13, v5
    v_sub_f32 v33, v12, v4
    v_sub_f32 v34, v13, v5
    v_add_f32 v35, v8, v14
    v_sub_f32 v36, v9, v11
    v_sub_f32 v37, v8, v14
    v_add_f32 v38, v9, v11
    v_add_f32 v39, v29, v15
    v_sub_f32 v40, v30, v6
    v_sub_f32 v41, v29, v15
    v_add_f32 v42, v30, v6
    v_and_b32 v3, 7, v0
    v_lshrrev_b32 v2, 3, v0
    v_lshlrev_b32 v2, 6, v2
    v_add_u32 v2, v2, v3
    v_lshlrev_b32 v2, 3, v2
    v_mov_b32 v4, v16
    v_mov_b32 v5, v17
    ds_write_b64 v2, v[4:5] offset:16384
    v_mov_b32 v4, v31
    v_mov_b32 v5, v32
    ds_write_b64 v2, v[4:5] offset:16448
    v_mov_b32 v4, v35
    v_mov_b32 v5, v36
    ds_write_b64 v2, v[4:5] offset:16512
    v_mov_b32 v4, v39
    v_mov_b32 v5, v40
    ds_write_b64 v2, v[4:5] offset:16576
    v_mov_b32 v4, v27
    v_mov_b32 v5, v28
    ds_write_b64 v2, v[4:5] offset:16640
    v_mov_b32 v4, v33
    v_mov_b32 v5, v34
    ds_write_b64 v2, v[4:5] offset:16704
    v_mov_b32 v4, v37
    v_mov_b32 v5, v38
    ds_write_b64 v2, v[4:5] offset:16768
    v_mov_b32 v4, v41
    v_mov_b32 v5, v42
    ds_write_b64 v2, v[4:5] offset:16832
    s_waitcnt lgkmcnt(0)
    s_barrier
    ds_read_b64 v[2:3], v1 offset:16384
    ds_read_b64 v[4:5], v1 offset:18432
    ds_read_b64 v[6:7], v1 offset:20480
    ds_read_b64 v[8:9], v1 offset:22528
    ds_read_b64 v[10:11], v1 offset:24576
    ds_read_b64 v[12:13], v1 offset:26624
    ds_read_b64 v[14:15], v1 offset:28672
    ds_read_b64 v[16:17], v1 offset:30720
    s_waitcnt lgkmcnt(0)
    v_and_b32 v27, 63, v0
    v_cvt_f32_u32 v27, v27
    v_mul_f32 v27, 0x3b000000, v27
    v_mul_f32 v28, 0x3f800000, v27
    v_cos_f32 v29, v28
    v_sin_f32 v30, v28
    s_nop 0
    v_mul_f32 v31, v4, v29
    v_fma_f32 v31, v5, v30, v31
    v_mul_f32 v32, v5, v29
    v_fma_f32 v32, -v4, v30, v32
    v_mul_f32 v4, 0x40000000, v27
    v_cos_f32 v5, v4
    v_sin_f32 v28, v4
    s_nop 0
    v_mul_f32 v29, v6, v5
    v_fma_f32 v29, v7, v28, v29
    v_mul_f32 v30, v7, v5
    v_fma_f32 v30, -v6, v28, v30
    v_mul_f32 v4, 0x40400000, v27
    v_cos_f32 v5, v4
    v_sin_f32 v6, v4
    s_nop 0
    v_mul_f32 v7, v8, v5
    v_fma_f32 v7, v9, v6, v7
    v_mul_f32 v28, v9, v5
    v_fma_f32 v28, -v8, v6, v28
    v_mul_f32 v4, 0x40800000, v27
    v_cos_f32 v5, v4
    v_sin_f32 v6, v4
    s_nop 0
    v_mul_f32 v8, v10, v5
    v_fma_f32 v8, v11, v6, v8
    v_mul_f32 v9, v11, v5
    v_fma_f32 v9, -v10, v6, v9
    v_mul_f32 v4, 0x40a00000, v27
    v_cos_f32 v5, v4
    v_sin_f32 v6, v4
    s_nop 0
    v_mul_f32 v10, v12, v5
    v_fma_f32 v10, v13, v6, v10
    v_mul_f32 v11, v13, v5
    v_fma_f32 v11, -v12, v6, v11
    v_mul_f32 v4, 0x40c00000, v27
    v_cos_f32 v5, v4
    v_sin_f32 v6, v4
    s_nop 0
    v_mul_f32 v12, v14, v5
    v_fma_f32 v12, v15, v6, v12
    v_mul_f32 v13, v15, v5
    v_fma_f32 v13, -v14, v6, v13
    v_mul_f32 v4, 0x40e00000, v27
    v_cos_f32 v5, v4
    v_sin_f32 v6, v4
    s_nop 0
    v_mul_f32 v14, v16, v5
    v_fma_f32 v14, v17, v6, v14
    v_mul_f32 v15, v17, v5
    v_fma_f32 v15, -v16, v6, v15
    v_add_f32 v4, v2, v8
    v_add_f32 v5, v3, v9
    v_sub_f32 v6, v2, v8
    v_sub_f32 v16, v3, v9
    v_add_f32 v17, v29, v12
    v_add_f32 v27, v30, v13
    v_sub_f32 v33, v29, v12
    v_sub_f32 v34, v30, v13
    v_add_f32 v2, v4, v17
    v_add_f32 v3, v5, v27
    v_sub_f32 v8, v4, v17
    v_sub_f32 v9, v5, v27
    v_add_f32 v12, v6, v34
    v_sub_f32 v13, v16, v33
    v_sub_f32 v29, v6, v34
    v_add_f32 v30, v16, v33
    v_add_f32 v4, v31, v10
    v_add_f32 v5, v32, v11
    v_sub_f32 v6, v31, v10
    v_sub_f32 v16, v32, v11
    v_add_f32 v17, v7, v14
    v_add_f32 v27, v28, v15
    v_sub_f32 v33, v7, v14
    v_sub_f32 v34, v28, v15
    v_add_f32 v7, v4, v17
    v_add_f32 v10, v5, v27
    v_sub_f32 v11, v4, v17
    v_sub_f32 v14, v5, v27
    v_add_f32 v15, v6, v34
    v_sub_f32 v28, v16, v33
    v_sub_f32 v31, v6, v34
    v_add_f32 v32, v16, v33
    v_add_f32 v4, v15, v28
    v_sub_f32 v5, v28, v15
    v_mul_f32 v4, 0x3f3504f3, v4
    v_mul_f32 v5, 0x3f3504f3, v5
    v_add_f32 v6, v31, v32
    v_sub_f32 v15, v32, v31
    v_mul_f32 v6, 0x3f3504f3, v6
    v_mul_f32 v15, 0x3f3504f3, v15
    v_add_f32 v16, v2, v7
    v_add_f32 v17, v3, v10
    v_sub_f32 v27, v2, v7
    v_sub_f32 v28, v3, v10
    v_add_f32 v31, v12, v4
    v_add_f32 v32, v13, v5
    v_sub_f32 v33, v12, v4
    v_sub_f32 v34, v13, v5
    v_add_f32 v35, v8, v14
    v_sub_f32 v36, v9, v11
    v_sub_f32 v37, v8, v14
    v_add_f32 v38, v9, v11
    v_add_f32 v39, v29, v15
    v_sub_f32 v40, v30, v6
    v_sub_f32 v41, v29, v15
    v_add_f32 v42, v30, v6
    v_and_b32 v3, 63, v0
    v_lshrrev_b32 v2, 6, v0
    v_lshlrev_b32 v2, 9, v2
    v_add_u32 v2, v2, v3
    v_lshlrev_b32 v2, 3, v2
    v_mov_b32 v4, v16
    v_mov_b32 v5, v17
    ds_write_b64 v2, v[4:5] offset:0
    v_mov_b32 v4, v31
    v_mov_b32 v5, v32
    ds_write_b64 v2, v[4:5] offset:512
    v_mov_b32 v4, v35
    v_mov_b32 v5, v36
    ds_write_b64 v2, v[4:5] offset:1024
    v_mov_b32 v4, v39
    v_mov_b32 v5, v40
    ds_write_b64 v2, v[4:5] offset:1536
    v_mov_b32 v4, v27
    v_mov_b32 v5, v28
    ds_write_b64 v2, v[4:5] offset:2048
    v_mov_b32 v4, v33
    v_mov_b32 v5, v34
    ds_write_b64 v2, v[4:5] offset:2560
    v_mov_b32 v4, v37
    v_mov_b32 v5, v38
    ds_write_b64 v2, v[4:5] offset:3072
    v_mov_b32 v4, v41
    v_mov_b32 v5, v42
    ds_write_b64 v2, v[4:5] offset:3584
    s_waitcnt lgkmcnt(0)
    s_barrier
    ds_read_b64 v[2:3], v1 offset:0
    ds_read_b64 v[4:5], v1 offset:4096
    ds_read_b64 v[6:7], v1 offset:8192
    ds_read_b64 v[8:9], v1 offset:12288
    s_waitcnt lgkmcnt(0)
    v_add_u32 v10, 0, v0
    v_cvt_f32_u32 v10, v10
    v_mul_f32 v10, 0x3a000000, v10
    v_mul_f32 v11, 0x3f800000, v10
    v_cos_f32 v12, v11
    v_sin_f32 v13, v11
    s_nop 0
    v_mul_f32 v14, v4, v12
    v_fma_f32 v14, v5, v13, v14
    v_mul_f32 v15, v5, v12
    v_fma_f32 v15, -v4, v13, v15
    v_mul_f32 v4, 0x40000000, v10
    v_cos_f32 v5, v4
    v_sin_f32 v11, v4
    s_nop 0
    v_mul_f32 v12, v6, v5
    v_fma_f32 v12, v7, v11, v12
    v_mul_f32 v13, v7, v5
    v_fma_f32 v13, -v6, v11, v13
    v_mul_f32 v4, 0x40400000, v10
    v_cos_f32 v5, v4
    v_sin_f32 v6, v4
    s_nop 0
    v_mul_f32 v7, v8, v5
    v_fma_f32 v7, v9, v6, v7
    v_mul_f32 v11, v9, v5
    v_fma_f32 v11, -v8, v6, v11
    v_add_f32 v4, v2, v12
    v_add_f32 v5, v3, v13
    v_sub_f32 v6, v2, v12
    v_sub_f32 v8, v3, v13
    v_add_f32 v9, v14, v7
    v_add_f32 v10, v15, v11
    v_sub_f32 v16, v14, v7
    v_sub_f32 v17, v15, v11
    v_add_f32 v2, v4, v9
    v_add_f32 v3, v5, v10
    v_sub_f32 v7, v4, v9
    v_sub_f32 v11, v5, v10
    v_add_f32 v12, v6, v17
    v_sub_f32 v13, v8, v16
    v_sub_f32 v14, v6, v17
    v_add_f32 v15, v8, v16
    ds_read_b64 v[4:5], v1 offset:2048
    ds_read_b64 v[8:9], v1 offset:6144
    ds_read_b64 v[16:17], v1 offset:10240
    ds_read_b64 v[28:29], v1 offset:14336
    s_waitcnt lgkmcnt(0)
    v_add_u32 v6, 256, v0
    v_cvt_f32_u32 v6, v6
    v_mul_f32 v6, 0x3a000000, v6
    v_mul_f32 v10, 0x3f800000, v6
    v_cos_f32 v27, v10
    v_sin_f32 v30, v10
    s_nop 0
    v_mul_f32 v31, v8, v27
    v_fma_f32 v31, v9, v30, v31
    v_mul_f32 v32, v9, v27
    v_fma_f32 v32, -v8, v30, v32
    v_mul_f32 v8, 0x40000000, v6
    v_cos_f32 v9, v8
    v_sin_f32 v10, v8
    s_nop 0
    v_mul_f32 v27, v16, v9
    v_fma_f32 v27, v17, v10, v27
    v_mul_f32 v30, v17, v9
    v_fma_f32 v30, -v16, v10, v30
    v_mul_f32 v8, 0x40400000, v6
    v_cos_f32 v9, v8
    v_sin_f32 v10, v8
    s_nop 0
    v_mul_f32 v16, v28, v9
    v_fma_f32 v16, v29, v10, v16
    v_mul_f32 v17, v29, v9
    v_fma_f32 v17, -v28, v10, v17
    v_add_f32 v6, v4, v27
    v_add_f32 v8, v5, v30
    v_sub_f32 v9, v4, v27
    v_sub_f32 v10, v5, v30
    v_add_f32 v28, v31, v16
    v_add_f32 v29, v32, v17
    v_sub_f32 v33, v31, v16
    v_sub_f32 v34, v32, v17
    v_add_f32 v4, v6, v28
    v_add_f32 v5, v8, v29
    v_sub_f32 v16, v6, v28
    v_sub_f32 v17, v8, v29
    v_add_f32 v27, v9, v34
    v_sub_f32 v30, v10, v33
    v_sub_f32 v31, v9, v34
    v_add_f32 v32, v10, v33
    s_waitcnt vmcnt(0)
    v_lshlrev_b32 v6, 16, v19
    v_and_b32 v8, 0xffff0000, v19
    v_mul_f32 v6, 0x354ccccd, v6
    v_mul_f32 v8, 0x354ccccd, v8
    v_mul_f32 v9, v2, v6
    v_fma_f32 v9, -v3, v8, v9
    v_mul_f32 v10, v3, v6
    v_fma_f32 v10, v2, v8, v10
    v_lshlrev_b32 v2, 16, v20
    v_and_b32 v3, 0xffff0000, v20
    v_mul_f32 v2, 0x354ccccd, v2
    v_mul_f32 v3, 0x354ccccd, v3
    v_mul_f32 v6, v4, v2
    v_fma_f32 v6, -v5, v3, v6
    v_mul_f32 v8, v5, v2
    v_fma_f32 v8, v4, v3, v8
    v_lshlrev_b32 v2, 16, v21
    v_and_b32 v3, 0xffff0000, v21
    v_mul_f32 v2, 0x354ccccd, v2
    v_mul_f32 v3, 0x354ccccd, v3
    v_mul_f32 v4, v12, v2
    v_fma_f32 v4, -v13, v3, v4
    v_mul_f32 v5, v13, v2
    v_fma_f32 v5, v12, v3, v5
    v_lshlrev_b32 v2, 16, v22
    v_and_b32 v3, 0xffff0000, v22
    v_mul_f32 v2, 0x354ccccd, v2
    v_mul_f32 v3, 0x354ccccd, v3
    v_mul_f32 v12, v27, v2
    v_fma_f32 v12, -v30, v3, v12
    v_mul_f32 v13, v30, v2
    v_fma_f32 v13, v27, v3, v13
    v_lshlrev_b32 v2, 16, v23
    v_and_b32 v3, 0xffff0000, v23
    v_mul_f32 v2, 0x354ccccd, v2
    v_mul_f32 v3, 0x354ccccd, v3
    v_mul_f32 v27, v7, v2
    v_fma_f32 v27, -v11, v3, v27
    v_mul_f32 v28, v11, v2
    v_fma_f32 v28, v7, v3, v28
    v_lshlrev_b32 v2, 16, v24
    v_and_b32 v3, 0xffff0000, v24
    v_mul_f32 v2, 0x354ccccd, v2
    v_mul_f32 v3, 0x354ccccd, v3
    v_mul_f32 v7, v16, v2
    v_fma_f32 v7, -v17, v3, v7
    v_mul_f32 v11, v17, v2
    v_fma_f32 v11, v16, v3, v11
    v_lshlrev_b32 v2, 16, v25
    v_and_b32 v3, 0xffff0000, v25
    v_mul_f32 v2, 0x354ccccd, v2
    v_mul_f32 v3, 0x354ccccd, v3
    v_mul_f32 v16, v14, v2
    v_fma_f32 v16, -v15, v3, v16
    v_mul_f32 v17, v15, v2
    v_fma_f32 v17, v14, v3, v17
    v_lshlrev_b32 v2, 16, v26
    v_and_b32 v3, 0xffff0000, v26
    v_mul_f32 v2, 0x354ccccd, v2
    v_mul_f32 v3, 0x354ccccd, v3
    v_mul_f32 v14, v31, v2
    v_fma_f32 v14, -v32, v3, v14
    v_mul_f32 v15, v32, v2
    v_fma_f32 v15, v31, v3, v15
    v_add_f32 v2, v9, v27
    v_add_f32 v3, v10, v28
    v_sub_f32 v29, v9, v27
    v_sub_f32 v30, v10, v28
    v_add_f32 v31, v4, v16
    v_add_f32 v32, v5, v17
    v_sub_f32 v33, v4, v16
    v_sub_f32 v34, v5, v17
    v_add_f32 v4, v2, v31
    v_add_f32 v5, v3, v32
    v_sub_f32 v9, v2, v31
    v_sub_f32 v10, v3, v32
    v_sub_f32 v16, v29, v34
    v_add_f32 v17, v30, v33
    v_add_f32 v27, v29, v34
    v_sub_f32 v28, v30, v33
    v_add_f32 v2, v6, v7
    v_add_f32 v3, v8, v11
    v_sub_f32 v29, v6, v7
    v_sub_f32 v30, v8, v11
    v_add_f32 v31, v12, v14
    v_add_f32 v32, v13, v15
    v_sub_f32 v33, v12, v14
    v_sub_f32 v34, v13, v15
    v_add_f32 v6, v2, v31
    v_add_f32 v7, v3, v32
    v_sub_f32 v8, v2, v31
    v_sub_f32 v11, v3, v32
    v_sub_f32 v12, v29, v34
    v_add_f32 v13, v30, v33
    v_add_f32 v14, v29, v34
    v_sub_f32 v15, v30, v33
    v_sub_f32 v2, v12, v13
    v_add_f32 v3, v13, v12
    v_mul_f32 v2, 0x3f3504f3, v2
    v_mul_f32 v3, 0x3f3504f3, v3
    v_sub_f32 v12, v14, v15
    v_add_f32 v13, v15, v14
    v_mul_f32 v12, 0x3f3504f3, v12
    v_mul_f32 v13, 0x3f3504f3, v13
    v_add_f32 v14, v4, v6
    v_add_f32 v15, v5, v7
    v_sub_f32 v29, v4, v6
    v_sub_f32 v30, v5, v7
    v_add_f32 v31, v16, v2
    v_add_f32 v32, v17, v3
    v_sub_f32 v33, v16, v2
    v_sub_f32 v34, v17, v3
    v_sub_f32 v35, v9, v11
    v_add_f32 v36, v10, v8
    v_add_f32 v37, v9, v11
    v_sub_f32 v38, v10, v8
    v_sub_f32 v39, v27, v13
    v_add_f32 v40, v28, v12
    v_add_f32 v41, v27, v13
    v_sub_f32 v42, v28, v12
    v_and_b32 v3, 0, v0
    v_lshrrev_b32 v2, 0, v0
    v_lshlrev_b32 v2, 3, v2
    v_add_u32 v2, v2, v3
    v_lshlrev_b32 v2, 3, v2
    v_mov_b32 v4, v14
    v_mov_b32 v5, v15
    ds_write_b64 v2, v[4:5] offset:16384
    v_mov_b32 v4, v31
    v_mov_b32 v5, v32
    ds_write_b64 v2, v[4:5] offset:16392
    v_mov_b32 v4, v35
    v_mov_b32 v5, v36
    ds_write_b64 v2, v[4:5] offset:16400
    v_mov_b32 v4, v39
    v_mov_b32 v5, v40
    ds_write_b64 v2, v[4:5] offset:16408
    v_mov_b32 v4, v29
    v_mov_b32 v5, v30
    ds_write_b64 v2, v[4:5] offset:16416
    v_mov_b32 v4, v33
    v_mov_b32 v5, v34
    ds_write_b64 v2, v[4:5] offset:16424
    v_mov_b32 v4, v37
    v_mov_b32 v5, v38
    ds_write_b64 v2, v[4:5] offset:16432
    v_mov_b32 v4, v41
    v_mov_b32 v5, v42
    ds_write_b64 v2, v[4:5] offset:16440
    s_waitcnt lgkmcnt(0)
    s_barrier
    ds_read_b64 v[2:3], v1 offset:16384
    ds_read_b64 v[4:5], v1 offset:18432
    ds_read_b64 v[6:7], v1 offset:20480
    ds_read_b64 v[8:9], v1 offset:22528
    ds_read_b64 v[10:11], v1 offset:24576
    ds_read_b64 v[12:13], v1 offset:26624
    ds_read_b64 v[14:15], v1 offset:28672
    ds_read_b64 v[16:17], v1 offset:30720
    s_waitcnt lgkmcnt(0)
    v_and_b32 v27, 7, v0
    v_cvt_f32_u32 v27, v27
    v_mul_f32 v27, 0x3c800000, v27
    v_mul_f32 v28, 0x3f800000, v27
    v_cos_f32 v29, v28
    v_sin_f32 v30, v28
    s_nop 0
    v_mul_f32 v31, v4, v29
    v_fma_f32 v31, -v5, v30, v31
    v_mul_f32 v32, v5, v29
    v_fma_f32 v32, v4, v30, v32
    v_mul_f32 v4, 0x40000000, v27
    v_cos_f32 v5, v4
    v_sin_f32 v28, v4
    s_nop 0
    v_mul_f32 v29, v6, v5
    v_fma_f32 v29, -v7, v28, v29
    v_mul_f32 v30, v7, v5
    v_fma_f32 v30, v6, v28, v30
    v_mul_f32 v4, 0x40400000, v27
    v_cos_f32 v5, v4
    v_sin_f32 v6, v4
    s_nop 0
    v_mul_f32 v7, v8, v5
    v_fma_f32 v7, -v9, v6, v7
    v_mul_f32 v28, v9, v5
    v_fma_f32 v28, v8, v6, v28
    v_mul_f32 v4, 0x40800000, v27
    v_cos_f32 v5, v4
    v_sin_f32 v6, v4
    s_nop 0
    v_mul_f32 v8, v10, v5
    v_fma_f32 v8, -v11, v6, v8
    v_mul_f32 v9, v11, v5
    v_fma_f32 v9, v10, v6, v9
    v_mul_f32 v4, 0x40a00000, v27
    v_cos_f32 v5, v4
    v_sin_f32 v6, v4
    s_nop 0
    v_mul_f32 v10, v12, v5
    v_fma_f32 v10, -v13, v6, v10
    v_mul_f32 v11, v13, v5
    v_fma_f32 v11, v12, v6, v11
    v_mul_f32 v4, 0x40c00000, v27
    v_cos_f32 v5, v4
    v_sin_f32 v6, v4
    s_nop 0
    v_mul_f32 v12, v14, v5
    v_fma_f32 v12, -v15, v6, v12
    v_mul_f32 v13, v15, v5
    v_fma_f32 v13, v14, v6, v13
    v_mul_f32 v4, 0x40e00000, v27
    v_cos_f32 v5, v4
    v_sin_f32 v6, v4
    s_nop 0
    v_mul_f32 v14, v16, v5
    v_fma_f32 v14, -v17, v6, v14
    v_mul_f32 v15, v17, v5
    v_fma_f32 v15, v16, v6, v15
    v_add_f32 v4, v2, v8
    v_add_f32 v5, v3, v9
    v_sub_f32 v6, v2, v8
    v_sub_f32 v16, v3, v9
    v_add_f32 v17, v29, v12
    v_add_f32 v27, v30, v13
    v_sub_f32 v33, v29, v12
    v_sub_f32 v34, v30, v13
    v_add_f32 v2, v4, v17
    v_add_f32 v3, v5, v27
    v_sub_f32 v8, v4, v17
    v_sub_f32 v9, v5, v27
    v_sub_f32 v12, v6, v34
    v_add_f32 v13, v16, v33
    v_add_f32 v29, v6, v34
    v_sub_f32 v30, v16, v33
    v_add_f32 v4, v31, v10
    v_add_f32 v5, v32, v11
    v_sub_f32 v6, v31, v10
    v_sub_f32 v16, v32, v11
    v_add_f32 v17, v7, v14
    v_add_f32 v27, v28, v15
    v_sub_f32 v33, v7, v14
    v_sub_f32 v34, v28, v15
    v_add_f32 v7, v4, v17
    v_add_f32 v10, v5, v27
    v_sub_f32 v11, v4, v17
    v_sub_f32 v14, v5, v27
    v_sub_f32 v15, v6, v34
    v_add_f32 v28, v16, v33
    v_add_f32 v31, v6, v34
    v_sub_f32 v32, v16, v33
    v_sub_f32 v4, v15, v28
    v_add_f32 v5, v28, v15
    v_mul_f32 v4, 0x3f3504f3, v4
    v_mul_f32 v5, 0x3f3504f3, v5
    v_sub_f32 v6, v31, v32
    v_add_f32 v15, v32, v31
    v_mul_f32 v6, 0x3f3504f3, v6
    v_mul_f32 v15, 0x3f3504f3, v15
    v_add_f32 v16, v2, v7
    v_add_f32 v17, v3, v10
    v_sub_f32 v27, v2, v7
    v_sub_f32 v28, v3, v10
    v_add_f32 v31, v12, v4
    v_add_f32 v32, v13, v5
    v_sub_f32 v33, v12, v4
    v_sub_f32 v34, v13, v5
    v_sub_f32 v35, v8, v14
    v_add_f32 v36, v9, v11
    v_add_f32 v37, v8, v14
    v_sub_f32 v38, v9, v11
    v_sub_f32 v39, v29, v15
    v_add_f32 v40, v30, v6
    v_add_f32 v41, v29, v15
    v_sub_f32 v42, v30, v6
    v_and_b32 v3, 7, v0
    v_lshrrev_b32 v2, 3, v0
    v_lshlrev_b32 v2, 6, v2
    v_add_u32 v2, v2, v3
    v_lshlrev_b32 v2, 3, v2
    v_mov_b32 v4, v16
    v_mov_b32 v5, v17
    ds_write_b64 v2, v[4:5] offset:0
    v_mov_b32 v4, v31
    v_mov_b32 v5, v32
    ds_write_b64 v2, v[4:5] offset:64
    v_mov_b32 v4, v35
    v_mov_b32 v5, v36
    ds_write_b64 v2, v[4:5] offset:128
    v_mov_b32 v4, v39
    v_mov_b32 v5, v40
    ds_write_b64 v2, v[4:5] offset:192
    v_mov_b32 v4, v27
    v_mov_b32 v5, v28
    ds_write_b64 v2, v[4:5] offset:256
    v_mov_b32 v4, v33
    v_mov_b32 v5, v34
    ds_write_b64 v2, v[4:5] offset:320
    v_mov_b32 v4, v37
    v_mov_b32 v5, v38
    ds_write_b64 v2, v[4:5] offset:384
    v_mov_b32 v4, v41
    v_mov_b32 v5, v42
    ds_write_b64 v2, v[4:5] offset:448
    s_waitcnt lgkmcnt(0)
    s_barrier
    ds_read_b64 v[2:3], v1 offset:0
    ds_read_b64 v[4:5], v1 offset:2048
    ds_read_b64 v[6:7], v1 offset:4096
    ds_read_b64 v[8:9], v1 offset:6144
    ds_read_b64 v[10:11], v1 offset:8192
    ds_read_b64 v[12:13], v1 offset:10240
    ds_read_b64 v[14:15], v1 offset:12288
    ds_read_b64 v[16:17], v1 offset:14336
    s_waitcnt lgkmcnt(0)
    v_and_b32 v27, 63, v0
    v_cvt_f32_u32 v27, v27
    v_mul_f32 v27, 0x3b000000, v27
    v_mul_f32 v28, 0x3f800000, v27
    v_cos_f32 v29, v28
    v_sin_f32 v30, v28
    s_nop 0
    v_mul_f32 v31, v4, v29
    v_fma_f32 v31, -v5, v30, v31
    v_mul_f32 v32, v5, v29
    v_fma_f32 v32, v4, v30, v32
    v_mul_f32 v4, 0x40000000, v27
    v_cos_f32 v5, v4
    v_sin_f32 v28, v4
    s_nop 0
    v_mul_f32 v29, v6, v5
    v_fma_f32 v29, -v7, v28, v29
    v_mul_f32 v30, v7, v5
    v_fma_f32 v30, v6, v28, v30
    v_mul_f32 v4, 0x40400000, v27
    v_cos_f32 v5, v4
    v_sin_f32 v6, v4
    s_nop 0
    v_mul_f32 v7, v8, v5
    v_fma_f32 v7, -v9, v6, v7
    v_mul_f32 v28, v9, v5
    v_fma_f32 v28, v8, v6, v28
    v_mul_f32 v4, 0x40800000, v27
    v_cos_f32 v5, v4
    v_sin_f32 v6, v4
    s_nop 0
    v_mul_f32 v8, v10, v5
    v_fma_f32 v8, -v11, v6, v8
    v_mul_f32 v9, v11, v5
    v_fma_f32 v9, v10, v6, v9
    v_mul_f32 v4, 0x40a00000, v27
    v_cos_f32 v5, v4
    v_sin_f32 v6, v4
    s_nop 0
    v_mul_f32 v10, v12, v5
    v_fma_f32 v10, -v13, v6, v10
    v_mul_f32 v11, v13, v5
    v_fma_f32 v11, v12, v6, v11
    v_mul_f32 v4, 0x40c00000, v27
    v_cos_f32 v5, v4
    v_sin_f32 v6, v4
    s_nop 0
    v_mul_f32 v12, v14, v5
    v_fma_f32 v12, -v15, v6, v12
    v_mul_f32 v13, v15, v5
    v_fma_f32 v13, v14, v6, v13
    v_mul_f32 v4, 0x40e00000, v27
    v_cos_f32 v5, v4
    v_sin_f32 v6, v4
    s_nop 0
    v_mul_f32 v14, v16, v5
    v_fma_f32 v14, -v17, v6, v14
    v_mul_f32 v15, v17, v5
    v_fma_f32 v15, v16, v6, v15
    v_add_f32 v4, v2, v8
    v_add_f32 v5, v3, v9
    v_sub_f32 v6, v2, v8
    v_sub_f32 v16, v3, v9
    v_add_f32 v17, v29, v12
    v_add_f32 v27, v30, v13
    v_sub_f32 v33, v29, v12
    v_sub_f32 v34, v30, v13
    v_add_f32 v2, v4, v17
    v_add_f32 v3, v5, v27
    v_sub_f32 v8, v4, v17
    v_sub_f32 v9, v5, v27
    v_sub_f32 v12, v6, v34
    v_add_f32 v13, v16, v33
    v_add_f32 v29, v6, v34
    v_sub_f32 v30, v16, v33
    v_add_f32 v4, v31, v10
    v_add_f32 v5, v32, v11
    v_sub_f32 v6, v31, v10
    v_sub_f32 v16, v32, v11
    v_add_f32 v17, v7, v14
    v_add_f32 v27, v28, v15
    v_sub_f32 v33, v7, v14
    v_sub_f32 v34, v28, v15
    v_add_f32 v7, v4, v17
    v_add_f32 v10, v5, v27
    v_sub_f32 v11, v4, v17
    v_sub_f32 v14, v5, v27
    v_sub_f32 v15, v6, v34
    v_add_f32 v28, v16, v33
    v_add_f32 v31, v6, v34
    v_sub_f32 v32, v16, v33
    v_sub_f32 v4, v15, v28
    v_add_f32 v5, v28, v15
    v_mul_f32 v4, 0x3f3504f3, v4
    v_mul_f32 v5, 0x3f3504f3, v5
    v_sub_f32 v6, v31, v32
    v_add_f32 v15, v32, v31
    v_mul_f32 v6, 0x3f3504f3, v6
    v_mul_f32 v15, 0x3f3504f3, v15
    v_add_f32 v16, v2, v7
    v_add_f32 v17, v3, v10
    v_sub_f32 v27, v2, v7
    v_sub_f32 v28, v3, v10
    v_add_f32 v31, v12, v4
    v_add_f32 v32, v13, v5
    v_sub_f32 v33, v12, v4
    v_sub_f32 v34, v13, v5
    v_sub_f32 v35, v8, v14
    v_add_f32 v36, v9, v11
    v_add_f32 v37, v8, v14
    v_sub_f32 v38, v9, v11
    v_sub_f32 v39, v29, v15
    v_add_f32 v40, v30, v6
    v_add_f32 v41, v29, v15
    v_sub_f32 v42, v30, v6
    v_and_b32 v3, 63, v0
    v_lshrrev_b32 v2, 6, v0
    v_lshlrev_b32 v2, 9, v2
    v_add_u32 v2, v2, v3
    v_lshlrev_b32 v2, 3, v2
    v_mov_b32 v4, v16
    v_mov_b32 v5, v17
    ds_write_b64 v2, v[4:5] offset:16384
    v_mov_b32 v4, v31
    v_mov_b32 v5, v32
    ds_write_b64 v2, v[4:5] offset:16896
    v_mov_b32 v4, v35
    v_mov_b32 v5, v36
    ds_write_b64 v2, v[4:5] offset:17408
    v_mov_b32 v4, v39
    v_mov_b32 v5, v40
    ds_write_b64 v2, v[4:5] offset:17920
    v_mov_b32 v4, v27
    v_mov_b32 v5, v28
    ds_write_b64 v2, v[4:5] offset:18432
    v_mov_b32 v4, v33
    v_mov_b32 v5, v34
    ds_write_b64 v2, v[4:5] offset:18944
    v_mov_b32 v4, v37
    v_mov_b32 v5, v38
    ds_write_b64 v2, v[4:5] offset:19456
    v_mov_b32 v4, v41
    v_mov_b32 v5, v42
    ds_write_b64 v2, v[4:5] offset:19968
    s_waitcnt lgkmcnt(0)
    s_barrier
    ds_read_b64 v[2:3], v1 offset:16384
    ds_read_b64 v[4:5], v1 offset:20480
    ds_read_b64 v[6:7], v1 offset:24576
    ds_read_b64 v[8:9], v1 offset:28672
    s_waitcnt lgkmcnt(0)
    v_add_u32 v10, 0, v0
    v_cvt_f32_u32 v10, v10
    v_mul_f32 v10, 0x3a000000, v10
    v_mul_f32 v11, 0x3f800000, v10
    v_cos_f32 v12, v11
    v_sin_f32 v13, v11
    s_nop 0
    v_mul_f32 v14, v4, v12
    v_fma_f32 v14, -v5, v13, v14
    v_mul_f32 v15, v5, v12
    v_fma_f32 v15, v4, v13, v15
    v_mul_f32 v4, 0x40000000, v10
    v_cos_f32 v5, v4
    v_sin_f32 v11, v4
    s_nop 0
    v_mul_f32 v12, v6, v5
    v_fma_f32 v12, -v7, v11, v12
    v_mul_f32 v13, v7, v5
    v_fma_f32 v13, v6, v11, v13
    v_mul_f32 v4, 0x40400000, v10
    v_cos_f32 v5, v4
    v_sin_f32 v6, v4
    s_nop 0
    v_mul_f32 v7, v8, v5
    v_fma_f32 v7, -v9, v6, v7
    v_mul_f32 v11, v9, v5
    v_fma_f32 v11, v8, v6, v11
    v_add_f32 v4, v2, v12
    v_add_f32 v5, v3, v13
    v_sub_f32 v6, v2, v12
    v_sub_f32 v8, v3, v13
    v_add_f32 v9, v14, v7
    v_add_f32 v10, v15, v11
    v_sub_f32 v16, v14, v7
    v_sub_f32 v17, v15, v11
    v_add_f32 v2, v4, v9
    v_add_f32 v3, v5, v10
    v_sub_f32 v7, v4, v9
    v_sub_f32 v11, v5, v10
    v_sub_f32 v12, v6, v17
    v_add_f32 v13, v8, v16
    v_add_f32 v14, v6, v17
    v_sub_f32 v15, v8, v16
    ds_read_b64 v[4:5], v1 offset:18432
    ds_read_b64 v[8:9], v1 offset:22528
    ds_read_b64 v[16:17], v1 offset:26624
    ds_read_b64 v[28:29], v1 offset:30720
    s_waitcnt lgkmcnt(0)
    v_add_u32 v6, 256, v0
    v_cvt_f32_u32 v6, v6
    v_mul_f32 v6, 0x3a000000, v6
    v_mul_f32 v10, 0x3f800000, v6
    v_cos_f32 v27, v10
    v_sin_f32 v30, v10
    s_nop 0
    v_mul_f32 v31, v8, v27
    v_fma_f32 v31, -v9, v30, v31
    v_mul_f32 v32, v9, v27
    v_fma_f32 v32, v8, v30, v32
    v_mul_f32 v8, 0x40000000, v6
    v_cos_f32 v9, v8
    v_sin_f32 v10, v8
    s_nop 0
    v_mul_f32 v27, v16, v9
    v_fma_f32 v27, -v17, v10, v27
    v_mul_f32 v30, v17, v9
    v_fma_f32 v30, v16, v10, v30
    v_mul_f32 v8, 0x40400000, v6
    v_cos_f32 v9, v8
    v_sin_f32 v10, v8
    s_nop 0
    v_mul_f32 v16, v28, v9
    v_fma_f32 v16, -v29, v10, v16
    v_mul_f32 v17, v29, v9
    v_fma_f32 v17, v28, v10, v17
    v_add_f32 v6, v4, v27
    v_add_f32 v8, v5, v30
    v_sub_f32 v9, v4, v27
    v_sub_f32 v10, v5, v30
    v_add_f32 v28, v31, v16
    v_add_f32 v29, v32, v17
    v_sub_f32 v33, v31, v16
    v_sub_f32 v34, v32, v17
    v_add_f32 v4, v6, v28
    v_add_f32 v5, v8, v29
    v_sub_f32 v16, v6, v28
    v_sub_f32 v17, v8, v29
    v_sub_f32 v27, v9, v34
    v_add_f32 v30, v10, v33
    v_add_f32 v31, v9, v34
    v_sub_f32 v32, v10, v33
    v_mov_b32 v8, v2
    v_mov_b32 v9, v3
    s_add_u32 s40, s27, 0
    buffer_store_dwordx2 v[8:9], v1, s[28:31], s40 offen
    v_mov_b32 v28, v4
    v_mov_b32 v29, v5
    s_add_u32 s40, s27, 2048
    buffer_store_dwordx2 v[28:29], v1, s[28:31], s40 offen
    v_mov_b32 v34, v12
    v_mov_b32 v35, v13
    s_add_u32 s40, s27, 4096
    buffer_store_dwordx2 v[34:35], v1, s[28:31], s40 offen
    v_mov_b32 v36, v27
    v_mov_b32 v37, v30
    s_add_u32 s40, s27, 6144
    buffer_store_dwordx2 v[36:37], v1, s[28:31], s40 offen
    v_mov_b32 v38, v7
    v_mov_b32 v39, v11
    s_add_u32 s40, s27, 8192
    buffer_store_dwordx2 v[38:39], v1, s[28:31], s40 offen
    v_mov_b32 v40, v16
    v_mov_b32 v41, v17
    s_add_u32 s40, s27, 10240
    buffer_store_dwordx2 v[40:41], v1, s[28:31], s40 offen
    v_mov_b32 v42, v14
    v_mov_b32 v43, v15
    s_add_u32 s40, s27, 12288
    buffer_store_dwordx2 v[42:43], v1, s[28:31], s40 offen
    v_mov_b32 v44, v31
    v_mov_b32 v45, v32
    s_add_u32 s40, s27, 14336
    buffer_store_dwordx2 v[44:45], v1, s[28:31], s40 offen
L_end_col2_kernel:
    s_endpgm
.globl ri2_kernel
.p2align 8
.type ri2_kernel,@function
ri2_kernel:
    s_cmp_ge_u32 s2, 256
    s_cbranch_scc1 L_end_ri2_kernel
    s_load_dwordx16 s[4:19], s[0:1], 0
    s_load_dwordx4 s[20:23], s[0:1], 64
    s_load_dwordx2 s[24:25], s[0:1], 80
    s_waitcnt lgkmcnt(0)
    s_add_u32 s28, s24, 0x1c00000
    s_addc_u32 s29, s25, 0
    s_mov_b32 s30, 0x280000
    s_mov_b32 s31, 0x00020000
    s_add_u32 s32, s24, 0x0
    s_addc_u32 s33, s25, 0
    s_mov_b32 s34, 0x504000
    s_mov_b32 s35, 0x00020000
    s_add_u32 s36, s24, 0x1f00000
    s_addc_u32 s37, s25, 0
    s_mov_b32 s38, 0x280000
    s_mov_b32 s39, 0x00020000
    s_add_u32 s44, s24, 0x1200000
    s_addc_u32 s45, s25, 0
    s_mov_b32 s46, 0x280000
    s_mov_b32 s47, 0x00020000
    v_and_b32 v1, 63, v0
    v_lshrrev_b32 v2, 6, v0
    s_nop 1
    v_readfirstlane_b32 s26, v2
    s_nop 3
    v_and_b32 v2, 7, v0
    v_lshrrev_b32 v3, 3, v0
    v_mul_u32_u24 v4, 2576, v2
    s_lshl_b32 s27, s2, 3
    v_add_u32 v2, s27, v2
    v_add_u32 v5, 0, v3
    v_lshlrev_b32 v23, 11, v5
    v_add_u32 v23, v23, v2
    v_lshlrev_b32 v23, 3, v23
    buffer_load_dwordx2 v[6:7], v23, s[32:35], 0 offen
    v_add_u32 v18, 64, v3
    v_lshlrev_b32 v23, 11, v18
    v_add_u32 v23, v23, v2
    v_lshlrev_b32 v23, 3, v23
    buffer_load_dwordx2 v[8:9], v23, s[32:35], 0 offen
    v_add_u32 v19, 128, v3
    v_lshlrev_b32 v23, 11, v19
    v_add_u32 v23, v23, v2
    v_lshlrev_b32 v23, 3, v23
    buffer_load_dwordx2 v[10:11], v23, s[32:35], 0 offen
    v_add_u32 v20, 192, v3
    v_lshlrev_b32 v23, 11, v20
    v_add_u32 v23, v23, v2
    v_lshlrev_b32 v23, 3, v23
    buffer_load_dwordx2 v[12:13], v23, s[32:35], 0 offen
    v_add_u32 v21, 256, v3
    v_lshlrev_b32 v23, 11, v21
    v_add_u32 v23, v23, v2
    v_lshlrev_b32 v23, 3, v23
    buffer_load_dwordx2 v[14:15], v23, s[32:35], 0 offen
    v_add_u32 v22, 320, v3
    v_lshlrev_b32 v23, 11, v22
    v_add_u32 v23, v23, v2
    v_lshlrev_b32 v23, 3, v23
    buffer_load_dwordx2 v[16:17], v23, s[32:35], 0 offen
    s_waitcnt vmcnt(0)
    v_cmp_eq_u32 vcc, 0, v5
    s_nop 1
    v_cndmask_b32 v7, v7, 0, vcc
    v_lshlrev_b32 v23, 3, v5
    v_add_u32 v23, v23, v4
    ds_write_b64 v23, v[6:7]
    v_lshlrev_b32 v23, 3, v18
    v_add_u32 v23, v23, v4
    ds_write_b64 v23, v[8:9]
    v_lshlrev_b32 v23, 3, v19
    v_add_u32 v23, v23, v4
    ds_write_b64 v23, v[10:11]
    v_lshlrev_b32 v23, 3, v20
    v_add_u32 v23, v23, v4
    ds_write_b64 v23, v[12:13]
    v_lshlrev_b32 v23, 3, v21
    v_add_u32 v23, v23, v4
    ds_write_b64 v23, v[14:15]
    v_cmp_eq_u32 vcc, 320, v22
    s_and_saveexec_b64 s[40:41], vcc
    v_cmp_eq_u32 vcc, 320, v22
    s_nop 1
    v_cndmask_b32 v17, v17, 0, vcc
    v_lshlrev_b32 v23, 3, v22
    v_add_u32 v23, v23, v4
    ds_write_b64 v23, v[16:17]
    s_waitcnt lgkmcnt(0)
    s_mov_b64 exec, s[40:41]
    s_barrier
    s_mul_i32 s27, s26, 2576
    v_lshlrev_b32 v5, 3, v1
    v_add_u32 v5, s27, v5
    s_mov_b32 s42, -1
    s_mov_b32 s43, 0xff
    s_mov_b64 exec, s[42:43]
    v_lshlrev_b32 v6, 3, v1
    v_sub_u32 v6, 320, v6
    v_add_u32 v6, s27, v6
    ds_read_b64 v[8:9], v5 offset:0
    ds_read_b64 v[10:11], v5 offset:320
    ds_read_b64 v[12:13], v5 offset:640
    ds_read_b64 v[14:15], v5 offset:960
    ds_read_b64 v[16:17], v5 offset:1280
    ds_read_b64 v[18:19], v5 offset:1600
    ds_read_b64 v[20:21], v5 offset:1920
    ds_read_b64 v[22:23], v5 offset:2240
    s_waitcnt lgkmcnt(0)
    ds_read_b64 v[24:25], v6 offset:2240
    ds_read_b64 v[26:27], v6 offset:1920
    ds_read_b64 v[28:29], v6 offset:1600
    ds_read_b64 v[30:31], v6 offset:1280
    ds_read_b64 v[32:33], v6 offset:960
    ds_read_b64 v[34:35], v6 offset:640
    ds_read_b64 v[36:37], v6 offset:320
    ds_read_b64 v[38:39], v6 offset:0
    s_waitcnt lgkmcnt(0)
    v_add_f32 v7, v8, v24
    v_sub_f32 v40, v9, v25
    v_sub_f32 v41, v8, v24
    v_add_f32 v42, v9, v25
    v_add_u32 v43, 0, v1
    v_cvt_f32_u32 v43, v43
    v_mul_f32 v43, 0x3acccccd, v43
    v_cos_f32 v44, v43
    v_sin_f32 v45, v43
    s_nop 0
    v_fma_f32 v7, -v45, v41, v7
    v_fma_f32 v7, -v44, v42, v7
    v_fma_f32 v40, -v45, v42, v40
    v_fma_f32 v40, v44, v41, v40
    v_add_f32 v8, v10, v26
    v_sub_f32 v9, v11, v27
    v_sub_f32 v24, v10, v26
    v_add_f32 v25, v11, v27
    v_add_u32 v41, 40, v1
    v_cvt_f32_u32 v41, v41
    v_mul_f32 v41, 0x3acccccd, v41
    v_cos_f32 v42, v41
    v_sin_f32 v43, v41
    s_nop 0
    v_fma_f32 v8, -v43, v24, v8
    v_fma_f32 v8, -v42, v25, v8
    v_fma_f32 v9, -v43, v25, v9
    v_fma_f32 v9, v42, v24, v9
    v_add_f32 v10, v12, v28
    v_sub_f32 v11, v13, v29
    v_sub_f32 v24, v12, v28
    v_add_f32 v25, v13, v29
    v_add_u32 v26, 80, v1
    v_cvt_f32_u32 v26, v26
    v_mul_f32 v26, 0x3acccccd, v26
    v_cos_f32 v27, v26
    v_sin_f32 v41, v26
    s_nop 0
    v_fma_f32 v10, -v41, v24, v10
    v_fma_f32 v10, -v27, v25, v10
    v_fma_f32 v11, -v41, v25, v11
    v_fma_f32 v11, v27, v24, v11
    v_add_f32 v12, v14, v30
    v_sub_f32 v13, v15, v31
    v_sub_f32 v24, v14, v30
    v_add_f32 v25, v15, v31
    v_add_u32 v26, 120, v1
    v_cvt_f32_u32 v26, v26
    v_mul_f32 v26, 0x3acccccd, v26
    v_cos_f32 v27, v26
    v_sin_f32 v28, v26
    s_nop 0
    v_fma_f32 v12, -v28, v24, v12
    v_fma_f32 v12, -v27, v25, v12
    v_fma_f32 v13, -v28, v25, v13
    v_fma_f32 v13, v27, v24, v13
    v_add_f32 v14, v16, v32
    v_sub_f32 v15, v17, v33
    v_sub_f32 v24, v16, v32
    v_add_f32 v25, v17, v33
    v_add_u32 v26, 160, v1
    v_cvt_f32_u32 v26, v26
    v_mul_f32 v26, 0x3acccccd, v26
    v_cos_f32 v27, v26
    v_sin_f32 v28, v26
    s_nop 0
    v_fma_f32 v14, -v28, v24, v14
    v_fma_f32 v14, -v27, v25, v14
    v_fma_f32 v15, -v28, v25, v15
    v_fma_f32 v15, v27, v24, v15
    v_add_f32 v16, v18, v34
    v_sub_f32 v17, v19, v35
    v_sub_f32 v24, v18, v34
    v_add_f32 v25, v19, v35
    v_add_u32 v26, 200, v1
    v_cvt_f32_u32 v26, v26
    v_mul_f32 v26, 0x3acccccd, v26
    v_cos_f32 v27, v26
    v_sin_f32 v28, v26
    s_nop 0
    v_fma_f32 v16, -v28, v24, v16
    v_fma_f32 v16, -v27, v25, v16
    v_fma_f32 v17, -v28, v25, v17
    v_fma_f32 v17, v27, v24, v17
    v_add_f32 v18, v20, v36
    v_sub_f32 v19, v21, v37
    v_sub_f32 v24, v20, v36
    v_add_f32 v25, v21, v37
    v_add_u32 v26, 240, v1
    v_cvt_f32_u32 v26, v26
    v_mul_f32 v26, 0x3acccccd, v26
    v_cos_f32 v27, v26
    v_sin_f32 v28, v26
    s_nop 0
    v_fma_f32 v18, -v28, v24, v18
    v_fma_f32 v18, -v27, v25, v18
    v_fma_f32 v19, -v28, v25, v19
    v_fma_f32 v19, v27, v24, v19
    v_add_f32 v20, v22, v38
    v_sub_f32 v21, v23, v39
    v_sub_f32 v24, v22, v38
    v_add_f32 v25, v23, v39
    v_add_u32 v26, 280, v1
    v_cvt_f32_u32 v26, v26
    v_mul_f32 v26, 0x3acccccd, v26
    v_cos_f32 v27, v26
    v_sin_f32 v28, v26
    s_nop 0
    v_fma_f32 v20, -v28, v24, v20
    v_fma_f32 v20, -v27, v25, v20
    v_fma_f32 v21, -v28, v25, v21
    v_fma_f32 v21, v27, v24, v21
    v_add_f32 v22, v7, v14
    v_add_f32 v23, v40, v15
    v_sub_f32 v24, v7, v14
    v_sub_f32 v25, v40, v15
    v_add_f32 v26, v10, v18
    v_add_f32 v27, v11, v19
    v_sub_f32 v28, v10, v18
    v_sub_f32 v29, v11, v19
    v_add_f32 v7, v22, v26
    v_add_f32 v10, v23, v27
    v_sub_f32 v11, v22, v26
    v_sub_f32 v14, v23, v27
    v_sub_f32 v15, v24, v29
    v_add_f32 v18, v25, v28
    v_add_f32 v19, v24, v29
    v_sub_f32 v30, v25, v28
    v_add_f32 v22, v8, v16
    v_add_f32 v23, v9, v17
    v_sub_f32 v24, v8, v16
    v_sub_f32 v25, v9, v17
    v_add_f32 v26, v12, v20
    v_add_f32 v27, v13, v21
    v_sub_f32 v28, v12, v20
    v_sub_f32 v29, v13, v21
    v_add_f32 v8, v22, v26
    v_add_f32 v9, v23, v27
    v_sub_f32 v12, v22, v26
    v_sub_f32 v13, v23, v27
    v_sub_f32 v16, v24, v29
    v_add_f32 v17, v25, v28
    v_add_f32 v20, v24, v29
    v_sub_f32 v21, v25, v28
    v_sub_f32 v22, v16, v17
    v_add_f32 v23, v17, v16
    v_mul_f32 v22, 0x3f3504f3, v22
    v_mul_f32 v23, 0x3f3504f3, v23
    v_sub_f32 v16, v20, v21
    v_add_f32 v17, v21, v20
    v_mul_f32 v16, 0x3f3504f3, v16
    v_mul_f32 v17, 0x3f3504f3, v17
    v_add_f32 v20, v7, v8
    v_add_f32 v21, v10, v9
    v_sub_f32 v24, v7, v8
    v_sub_f32 v25, v10, v9
    v_add_f32 v26, v15, v22
    v_add_f32 v27, v18, v23
    v_sub_f32 v28, v15, v22
    v_sub_f32 v29, v18, v23
    v_sub_f32 v31, v11, v13
    v_add_f32 v32, v14, v12
    v_add_f32 v33, v11, v13
    v_sub_f32 v34, v14, v12
    v_sub_f32 v35, v19, v17
    v_add_f32 v36, v30, v16
    v_add_f32 v37, v19, v17
    v_sub_f32 v38, v30, v16
    v_lshlrev_b32 v7, 6, v1
    v_add_u32 v7, s27, v7
    v_mov_b32 v8, v20
    v_mov_b32 v9, v21
    ds_write_b64 v7, v[8:9] offset:0
    v_mov_b32 v8, v26
    v_mov_b32 v9, v27
    ds_write_b64 v7, v[8:9] offset:8
    v_mov_b32 v8, v31
    v_mov_b32 v9, v32
    ds_write_b64 v7, v[8:9] offset:16
    v_mov_b32 v8, v35
    v_mov_b32 v9, v36
    ds_write_b64 v7, v[8:9] offset:24
    v_mov_b32 v8, v24
    v_mov_b32 v9, v25
    ds_write_b64 v7, v[8:9] offset:32
    v_mov_b32 v8, v28
    v_mov_b32 v9, v29
    ds_write_b64 v7, v[8:9] offset:40
    v_mov_b32 v8, v33
    v_mov_b32 v9, v34
    ds_write_b64 v7, v[8:9] offset:48
    v_mov_b32 v8, v37
    v_mov_b32 v9, v38
    ds_write_b64 v7, v[8:9] offset:56
    s_waitcnt lgkmcnt(0)
    ds_read_b64 v[8:9], v5 offset:0
    ds_read_b64 v[10:11], v5 offset:320
    ds_read_b64 v[12:13], v5 offset:640
    ds_read_b64 v[14:15], v5 offset:960
    ds_read_b64 v[16:17], v5 offset:1280
    ds_read_b64 v[18:19], v5 offset:1600
    ds_read_b64 v[20:21], v5 offset:1920
    ds_read_b64 v[22:23], v5 offset:2240
    s_waitcnt lgkmcnt(0)
    v_and_b32 v24, 7, v1
    v_lshrrev_b32 v7, 3, v1
    v_lshlrev_b32 v7, 6, v7
    v_add_u32 v7, v7, v24
    v_lshlrev_b32 v7, 3, v7
    v_add_u32 v7, s27, v7
    v_cvt_f32_u32 v24, v24
    v_mul_f32 v24, 0x3c800000, v24
    v_mul_f32 v25, 0x3f800000, v24
    v_cos_f32 v26, v25
    v_sin_f32 v27, v25
    s_nop 0
    v_mul_f32 v28, v10, v26
    v_fma_f32 v28, -v11, v27, v28
    v_mul_f32 v29, v11, v26
    v_fma_f32 v29, v10, v27, v29
    v_mul_f32 v10, 0x40000000, v24
    v_cos_f32 v11, v10
    v_sin_f32 v25, v10
    s_nop 0
    v_mul_f32 v26, v12, v11
    v_fma_f32 v26, -v13, v25, v26
    v_mul_f32 v27, v13, v11
    v_fma_f32 v27, v12, v25, v27
    v_mul_f32 v10, 0x40400000, v24
    v_cos_f32 v11, v10
    v_sin_f32 v12, v10
    s_nop 0
    v_mul_f32 v13, v14, v11
    v_fma_f32 v13, -v15, v12, v13
    v_mul_f32 v25, v15, v11
    v_fma_f32 v25, v14, v12, v25
    v_mul_f32 v10, 0x40800000, v24
    v_cos_f32 v11, v10
    v_sin_f32 v12, v10
    s_nop 0
    v_mul_f32 v14, v16, v11
    v_fma_f32 v14, -v17, v12, v14
    v_mul_f32 v15, v17, v11
    v_fma_f32 v15, v16, v12, v15
    v_mul_f32 v10, 0x40a00000, v24
    v_cos_f32 v11, v10
    v_sin_f32 v12, v10
    s_nop 0
    v_mul_f32 v16, v18, v11
    v_fma_f32 v16, -v19, v12, v16
    v_mul_f32 v17, v19, v11
    v_fma_f32 v17, v18, v12, v17
    v_mul_f32 v10, 0x40c00000, v24
    v_cos_f32 v11, v10
    v_sin_f32 v12, v10
    s_nop 0
    v_mul_f32 v18, v20, v11
    v_fma_f32 v18, -v21, v12, v18
    v_mul_f32 v19, v21, v11
    v_fma_f32 v19, v20, v12, v19
    v_mul_f32 v10, 0x40e00000, v24
    v_cos_f32 v11, v10
    v_sin_f32 v12, v10
    s_nop 0
    v_mul_f32 v20, v22, v11
    v_fma_f32 v20, -v23, v12, v20
    v_mul_f32 v21, v23, v11
    v_fma_f32 v21, v22, v12, v21
    v_add_f32 v10, v8, v14
    v_add_f32 v11, v9, v15
    v_sub_f32 v12, v8, v14
    v_sub_f32 v22, v9, v15
    v_add_f32 v23, v26, v18
    v_add_f32 v30, v27, v19
    v_sub_f32 v31, v26, v18
    v_sub_f32 v32, v27, v19
    v_add_f32 v8, v10, v23
    v_add_f32 v9, v11, v30
    v_sub_f32 v14, v10, v23
    v_sub_f32 v15, v11, v30
    v_sub_f32 v18, v12, v32
    v_add_f32 v19, v22, v31
    v_add_f32 v26, v12, v32
    v_sub_f32 v27, v22, v31
    v_add_f32 v10, v28, v16
    v_add_f32 v11, v29, v17
    v_sub_f32 v12, v28, v16
    v_sub_f32 v22, v29, v17
    v_add_f32 v23, v13, v20
    v_add_f32 v30, v25, v21
    v_sub_f32 v31, v13, v20
    v_sub_f32 v32, v25, v21
    v_add_f32 v13, v10, v23
    v_add_f32 v16, v11, v30
    v_sub_f32 v17, v10, v23
    v_sub_f32 v20, v11, v30
    v_sub_f32 v21, v12, v32
    v_add_f32 v25, v22, v31
    v_add_f32 v28, v12, v32
    v_sub_f32 v29, v22, v31
    v_sub_f32 v10, v21, v25
    v_add_f32 v11, v25, v21
    v_mul_f32 v10, 0x3f3504f3, v10
    v_mul_f32 v11, 0x3f3504f3, v11
    v_sub_f32 v12, v28, v29
    v_add_f32 v21, v29, v28
    v_mul_f32 v12, 0x3f3504f3, v12
    v_mul_f32 v21, 0x3f3504f3, v21
    v_add_f32 v22, v8, v13
    v_add_f32 v23, v9, v16
    v_sub_f32 v25, v8, v13
    v_sub_f32 v28, v9, v16
    v_add_f32 v29, v18, v10
    v_add_f32 v30, v19, v11
    v_sub_f32 v31, v18, v10
    v_sub_f32 v32, v19, v11
    v_sub_f32 v33, v14, v20
    v_add_f32 v34, v15, v17
    v_add_f32 v35, v14, v20
    v_sub_f32 v36, v15, v17
    v_sub_f32 v37, v26, v21
    v_add_f32 v38, v27, v12
    v_add_f32 v39, v26, v21
    v_sub_f32 v40, v27, v12
    v_mov_b32 v8, v22
    v_mov_b32 v9, v23
    ds_write_b64 v7, v[8:9] offset:0
    v_mov_b32 v8, v29
    v_mov_b32 v9, v30
    ds_write_b64 v7, v[8:9] offset:64
    v_mov_b32 v8, v33
    v_mov_b32 v9, v34
    ds_write_b64 v7, v[8:9] offset:128
    v_mov_b32 v8, v37
    v_mov_b32 v9, v38
    ds_write_b64 v7, v[8:9] offset:192
    v_mov_b32 v8, v25
    v_mov_b32 v9, v28
    ds_write_b64 v7, v[8:9] offset:256
    v_mov_b32 v8, v31
    v_mov_b32 v9, v32
    ds_write_b64 v7, v[8:9] offset:320
    v_mov_b32 v8, v35
    v_mov_b32 v9, v36
    ds_write_b64 v7, v[8:9] offset:384
    v_mov_b32 v8, v39
    v_mov_b32 v9, v40
    ds_write_b64 v7, v[8:9] offset:448
    s_mov_b64 exec, s[40:41]
    s_waitcnt lgkmcnt(0)
    ds_read_b64 v[8:9], v5 offset:0
    ds_read_b64 v[10:11], v5 offset:512
    ds_read_b64 v[12:13], v5 offset:1024
    ds_read_b64 v[14:15], v5 offset:1536
    ds_read_b64 v[16:17], v5 offset:2048
    s_waitcnt lgkmcnt(0)
    v_mov_b32 v24, v1
    v_cvt_f32_u32 v24, v24
    v_mul_f32 v24, 0x3b4ccccd, v24
    v_mul_f32 v18, 0x3f800000, v24
    v_cos_f32 v19, v18
    v_sin_f32 v20, v18
    s_nop 0
    v_mul_f32 v21, v10, v19
    v_fma_f32 v21, -v11, v20, v21
    v_mul_f32 v22, v11, v19
    v_fma_f32 v22, v10, v20, v22
    v_mul_f32 v10, 0x40000000, v24
    v_cos_f32 v11, v10
    v_sin_f32 v18, v10
    s_nop 0
    v_mul_f32 v19, v12, v11
    v_fma_f32 v19, -v13, v18, v19
    v_mul_f32 v20, v13, v11
    v_fma_f32 v20, v12, v18, v20
    v_mul_f32 v10, 0x40400000, v24
    v_cos_f32 v11, v10
    v_sin_f32 v12, v10
    s_nop 0
    v_mul_f32 v13, v14, v11
    v_fma_f32 v13, -v15, v12, v13
    v_mul_f32 v18, v15, v11
    v_fma_f32 v18, v14, v12, v18
    v_mul_f32 v10, 0x40800000, v24
    v_cos_f32 v11, v10
    v_sin_f32 v12, v10
    s_nop 0
    v_mul_f32 v14, v16, v11
    v_fma_f32 v14, -v17, v12, v14
    v_mul_f32 v15, v17, v11
    v_fma_f32 v15, v16, v12, v15
    v_add_f32 v10, v21, v14
    v_add_f32 v11, v22, v15
    v_add_f32 v12, v19, v13
    v_add_f32 v16, v20, v18
    v_sub_f32 v17, v21, v14
    v_sub_f32 v23, v22, v15
    v_sub_f32 v25, v19, v13
    v_sub_f32 v26, v20, v18
    v_add_f32 v27, v8, v10
    v_add_f32 v28, v9, v11
    v_add_f32 v29, v27, v12
    v_add_f32 v30, v28, v16
    v_mov_b32 v27, v8
    v_fmac_f32 v27, 0x3e9e377a, v10
    v_fmac_f32 v27, 0xbf4f1bbd, v12
    v_mov_b32 v31, v8
    v_fmac_f32 v31, 0xbf4f1bbd, v10
    v_fmac_f32 v31, 0x3e9e377a, v12
    v_mul_f32 v33, 0x3f737871, v17
    v_fmac_f32 v33, 0x3f167918, v25
    v_mul_f32 v35, 0x3f167918, v17
    v_fmac_f32 v35, 0xbf737871, v25
    v_mov_b32 v28, v9
    v_fmac_f32 v28, 0x3e9e377a, v11
    v_fmac_f32 v28, 0xbf4f1bbd, v16
    v_mov_b32 v32, v9
    v_fmac_f32 v32, 0xbf4f1bbd, v11
    v_fmac_f32 v32, 0x3e9e377a, v16
    v_mul_f32 v34, 0x3f737871, v23
    v_fmac_f32 v34, 0x3f167918, v26
    v_mul_f32 v36, 0x3f167918, v23
    v_fmac_f32 v36, 0xbf737871, v26
    v_sub_f32 v8, v27, v34
    v_add_f32 v9, v28, v33
    v_add_f32 v10, v27, v34
    v_sub_f32 v11, v28, v33
    v_sub_f32 v12, v31, v36
    v_add_f32 v13, v32, v35
    v_add_f32 v14, v31, v36
    v_sub_f32 v15, v32, v35
    s_lshl_b32 s27, s2, 3
    s_add_u32 s27, s27, s26
    s_mul_i32 s27, s27, 1280
    v_lshlrev_b32 v16, 2, v1
    buffer_load_dword v17, v16, s[28:31], s27 offen offset:0
    buffer_load_dword v18, v16, s[28:31], s27 offen offset:256
    buffer_load_dword v19, v16, s[28:31], s27 offen offset:512
    buffer_load_dword v20, v16, s[28:31], s27 offen offset:768
    buffer_load_dword v21, v16, s[28:31], s27 offen offset:1024
    s_waitcnt vmcnt(0)
    v_cvt_pk_bf16_f32 v29, v29, v29
    v_lshlrev_b32 v29, 16, v29
    v_cvt_pk_bf16_f32 v30, v30, v30
    v_lshlrev_b32 v30, 16, v30
    v_lshlrev_b32 v22, 16, v17
    v_add_f32 v29, v29, v22
    v_and_b32 v22, 0xffff0000, v17
    v_add_f32 v30, v30, v22
    v_cvt_pk_bf16_f32 v17, v29, v30
    buffer_store_dword v17, v16, s[36:39], s27 offen offset:0
    v_lshlrev_b32 v29, 16, v17
    v_and_b32 v30, 0xffff0000, v17
    v_cvt_pk_bf16_f32 v8, v8, v8
    v_lshlrev_b32 v8, 16, v8
    v_cvt_pk_bf16_f32 v9, v9, v9
    v_lshlrev_b32 v9, 16, v9
    v_lshlrev_b32 v22, 16, v18
    v_add_f32 v8, v8, v22
    v_and_b32 v22, 0xffff0000, v18
    v_add_f32 v9, v9, v22
    v_cvt_pk_bf16_f32 v18, v8, v9
    buffer_store_dword v18, v16, s[36:39], s27 offen offset:256
    v_lshlrev_b32 v8, 16, v18
    v_and_b32 v9, 0xffff0000, v18
    v_cvt_pk_bf16_f32 v12, v12, v12
    v_lshlrev_b32 v12, 16, v12
    v_cvt_pk_bf16_f32 v13, v13, v13
    v_lshlrev_b32 v13, 16, v13
    v_lshlrev_b32 v22, 16, v19
    v_add_f32 v12, v12, v22
    v_and_b32 v22, 0xffff0000, v19
    v_add_f32 v13, v13, v22
    v_cvt_pk_bf16_f32 v19, v12, v13
    buffer_store_dword v19, v16, s[36:39], s27 offen offset:512
    v_lshlrev_b32 v12, 16, v19
    v_and_b32 v13, 0xffff0000, v19
    v_cvt_pk_bf16_f32 v14, v14, v14
    v_lshlrev_b32 v14, 16, v14
    v_cvt_pk_bf16_f32 v15, v15, v15
    v_lshlrev_b32 v15, 16, v15
    v_lshlrev_b32 v22, 16, v20
    v_add_f32 v14, v14, v22
    v_and_b32 v22, 0xffff0000, v20
    v_add_f32 v15, v15, v22
    v_cvt_pk_bf16_f32 v20, v14, v15
    buffer_store_dword v20, v16, s[36:39], s27 offen offset:768
    v_lshlrev_b32 v14, 16, v20
    v_and_b32 v15, 0xffff0000, v20
    v_cvt_pk_bf16_f32 v10, v10, v10
    v_lshlrev_b32 v10, 16, v10
    v_cvt_pk_bf16_f32 v11, v11, v11
    v_lshlrev_b32 v11, 16, v11
    v_lshlrev_b32 v22, 16, v21
    v_add_f32 v10, v10, v22
    v_and_b32 v22, 0xffff0000, v21
    v_add_f32 v11, v11, v22
    v_cvt_pk_bf16_f32 v21, v10, v11
    buffer_store_dword v21, v16, s[36:39], s27 offen offset:1024
    v_lshlrev_b32 v10, 16, v21
    v_and_b32 v11, 0xffff0000, v21
    v_add_f32 v22, v29, v30
    v_add_f32 v22, v22, v8
    v_add_f32 v22, v22, v9
    v_add_f32 v22, v22, v12
    v_add_f32 v22, v22, v13
    v_add_f32 v22, v22, v14
    v_add_f32 v22, v22, v15
    v_add_f32 v22, v22, v10
    v_add_f32 v22, v22, v11
    ds_swizzle_b32 v26, v22 offset:0x41f
    s_waitcnt lgkmcnt(0)
    v_add_f32 v22, v22, v26
    ds_swizzle_b32 v26, v22 offset:0x81f
    s_waitcnt lgkmcnt(0)
    v_add_f32 v22, v22, v26
    ds_swizzle_b32 v26, v22 offset:0x101f
    s_waitcnt lgkmcnt(0)
    v_add_f32 v22, v22, v26
    ds_swizzle_b32 v26, v22 offset:0x201f
    s_waitcnt lgkmcnt(0)
    v_add_f32 v22, v22, v26
    ds_swizzle_b32 v26, v22 offset:0x401f
    s_waitcnt lgkmcnt(0)
    v_add_f32 v22, v22, v26
    s_nop 1
    v_readlane_b32 s60, v22, 32
    s_nop 3
    v_add_f32 v22, s60, v22
    s_nop 1
    v_readlane_b32 s60, v22, 0
    s_nop 3
    v_mov_b32 v25, s60
    v_mul_f32 v25, 0x3acccccd, v25
    v_mov_b32 v22, 0
    v_sub_f32 v23, v29, v25
    v_fmac_f32 v22, v23, v23
    v_sub_f32 v23, v30, v25
    v_fmac_f32 v22, v23, v23
    v_sub_f32 v23, v8, v25
    v_fmac_f32 v22, v23, v23
    v_sub_f32 v23, v9, v25
    v_fmac_f32 v22, v23, v23
    v_sub_f32 v23, v12, v25
    v_fmac_f32 v22, v23, v23
    v_sub_f32 v23, v13, v25
    v_fmac_f32 v22, v23, v23
    v_sub_f32 v23, v14, v25
    v_fmac_f32 v22, v23, v23
    v_sub_f32 v23, v15, v25
    v_fmac_f32 v22, v23, v23
    v_sub_f32 v23, v10, v25
    v_fmac_f32 v22, v23, v23
    v_sub_f32 v23, v11, v25
    v_fmac_f32 v22, v23, v23
    ds_swizzle_b32 v26, v22 offset:0x41f
    s_waitcnt lgkmcnt(0)
    v_add_f32 v22, v22, v26
    ds_swizzle_b32 v26, v22 offset:0x81f
    s_waitcnt lgkmcnt(0)
    v_add_f32 v22, v22, v26
    ds_swizzle_b32 v26, v22 offset:0x101f
    s_waitcnt lgkmcnt(0)
    v_add_f32 v22, v22, v26
    ds_swizzle_b32 v26, v22 offset:0x201f
    s_waitcnt lgkmcnt(0)
    v_add_f32 v22, v22, v26
    ds_swizzle_b32 v26, v22 offset:0x401f
    s_waitcnt lgkmcnt(0)
    v_add_f32 v22, v22, v26
    s_nop 1
    v_readlane_b32 s60, v22, 32
    s_nop 3
    v_add_f32 v22, s60, v22
    s_nop 1
    v_readlane_b32 s60, v22, 0
    s_nop 3
    v_mov_b32 v22, s60
    v_mul_f32 v22, 0x3acccccd, v22
    v_cvt_pk_bf16_f32 v25, v25, v25
    v_lshlrev_b32 v25, 16, v25
    v_cvt_pk_bf16_f32 v22, v22, v22
    v_lshlrev_b32 v22, 16, v22
    v_add_f32 v22, 0x3727c5ac, v22
    v_cvt_pk_bf16_f32 v22, v22, v22
    v_lshlrev_b32 v22, 16, v22
    v_sqrt_f32 v22, v22
    s_nop 0
    v_cvt_pk_bf16_f32 v22, v22, v22
    v_lshlrev_b32 v22, 16, v22
    v_rcp_f32 v22, v22
    s_nop 0
    v_sub_f32 v29, v29, v25
    v_cvt_pk_bf16_f32 v29, v29, v29
    v_lshlrev_b32 v29, 16, v29
    v_mul_f32 v29, v29, v22
    v_cvt_pk_bf16_f32 v29, v29, v29
    v_lshlrev_b32 v29, 16, v29
    v_sub_f32 v30, v30, v25
    v_cvt_pk_bf16_f32 v30, v30, v30
    v_lshlrev_b32 v30, 16, v30
    v_mul_f32 v30, v30, v22
    v_cvt_pk_bf16_f32 v30, v30, v30
    v_lshlrev_b32 v30, 16, v30
    v_sub_f32 v8, v8, v25
    v_cvt_pk_bf16_f32 v8, v8, v8
    v_lshlrev_b32 v8, 16, v8
    v_mul_f32 v8, v8, v22
    v_cvt_pk_bf16_f32 v8, v8, v8
    v_lshlrev_b32 v8, 16, v8
    v_sub_f32 v9, v9, v25
    v_cvt_pk_bf16_f32 v9, v9, v9
    v_lshlrev_b32 v9, 16, v9
    v_mul_f32 v9, v9, v22
    v_cvt_pk_bf16_f32 v9, v9, v9
    v_lshlrev_b32 v9, 16, v9
    v_sub_f32 v12, v12, v25
    v_cvt_pk_bf16_f32 v12, v12, v12
    v_lshlrev_b32 v12, 16, v12
    v_mul_f32 v12, v12, v22
    v_cvt_pk_bf16_f32 v12, v12, v12
    v_lshlrev_b32 v12, 16, v12
    v_sub_f32 v13, v13, v25
    v_cvt_pk_bf16_f32 v13, v13, v13
    v_lshlrev_b32 v13, 16, v13
    v_mul_f32 v13, v13, v22
    v_cvt_pk_bf16_f32 v13, v13, v13
    v_lshlrev_b32 v13, 16, v13
    v_sub_f32 v14, v14, v25
    v_cvt_pk_bf16_f32 v14, v14, v14
    v_lshlrev_b32 v14, 16, v14
    v_mul_f32 v14, v14, v22
    v_cvt_pk_bf16_f32 v14, v14, v14
    v_lshlrev_b32 v14, 16, v14
    v_sub_f32 v15, v15, v25
    v_cvt_pk_bf16_f32 v15, v15, v15
    v_lshlrev_b32 v15, 16, v15
    v_mul_f32 v15, v15, v22
    v_cvt_pk_bf16_f32 v15, v15, v15
    v_lshlrev_b32 v15, 16, v15
    v_sub_f32 v10, v10, v25
    v_cvt_pk_bf16_f32 v10, v10, v10
    v_lshlrev_b32 v10, 16, v10
    v_mul_f32 v10, v10, v22
    v_cvt_pk_bf16_f32 v10, v10, v10
    v_lshlrev_b32 v10, 16, v10
    v_sub_f32 v11, v11, v25
    v_cvt_pk_bf16_f32 v11, v11, v11
    v_lshlrev_b32 v11, 16, v11
    v_mul_f32 v11, v11, v22
    v_cvt_pk_bf16_f32 v11, v11, v11
    v_lshlrev_b32 v11, 16, v11
    s_nop 2
    v_cvt_pk_bf16_f32 v22, v29, v30
    buffer_store_dword v22, v16, s[44:47], s27 offen offset:0
    v_cvt_pk_bf16_f32 v23, v8, v9
    buffer_store_dword v23, v16, s[44:47], s27 offen offset:256
    v_cvt_pk_bf16_f32 v25, v12, v13
    buffer_store_dword v25, v16, s[44:47], s27 offen offset:512
    v_cvt_pk_bf16_f32 v26, v14, v15
    buffer_store_dword v26, v16, s[44:47], s27 offen offset:768
    v_cvt_pk_bf16_f32 v27, v10, v11
    buffer_store_dword v27, v16, s[44:47], s27 offen offset:1024
L_end_ri2_kernel:
    s_endpgm
.globl g1b_kernel
.p2align 8
.type g1b_kernel,@function
g1b_kernel:
    s_cmp_ge_u32 s2, 256
    s_cbranch_scc1 L_end_g1b_kernel
    s_load_dwordx16 s[4:19], s[0:1], 0
    s_load_dwordx4 s[20:23], s[0:1], 64
    s_load_dwordx2 s[24:25], s[0:1], 80
    s_waitcnt lgkmcnt(0)
    s_add_u32 s28, s24, 0x1200000
    s_addc_u32 s29, s25, 0
    s_mov_b32 s30, 0x280000
    s_mov_b32 s31, 0x00020000
    s_add_u32 s32, s24, 0x900000
    s_addc_u32 s33, s25, 0
    s_mov_b32 s34, 0x21c000
    s_mov_b32 s35, 0x00020000
    s_add_u32 s36, s24, 0x1500000
    s_addc_u32 s37, s25, 0
    s_mov_b32 s38, 0x6c0000
    s_mov_b32 s39, 0x00020000
    s_add_u32 s44, s14, 0x0
    s_addc_u32 s45, s15, 0
    s_mov_b32 s46, 0xd80
    s_mov_b32 s47, 0x00020000
    v_and_b32 v1, 63, v0
    v_lshrrev_b32 v2, 6, v0
    s_nop 1
    v_readfirstlane_b32 s26, v2
    s_nop 3
    s_and_b32 s27, s2, 31
    s_lshr_b32 s40, s2, 5
    s_mul_i32 s40, s40, 27
    s_lshr_b32 s40, s40, 1
    s_lshl_b32 s40, s40, 4
    v_and_b32 v2, 15, v1
    v_lshrrev_b32 v3, 4, v1
    v_lshrrev_b32 v6, 3, v0
    v_and_b32 v7, 7, v0
    v_lshlrev_b32 v7, 4, v7
    v_mul_u32_u24 v4, 1280, v6
    v_add_u32 v4, v4, v7
    v_mul_u32_u24 v5, 144, v6
    v_add_u32 v5, v5, v7
    v_add_u32 v8, 41472, v5
    s_mul_i32 s52, s27, 81920
    s_add_u32 s53, s52, 40960
    s_mul_i32 s54, s40, 1280
    s_add_u32 s55, s54, 40960
    s_add_u32 s56, s54, 81920
    s_add_u32 s57, s54, 122880
    s_add_u32 s58, s54, 163840
    s_add_u32 s59, s54, 204800
    s_add_u32 s60, s54, 245760
    v_lshlrev_b32 v7, 4, v3
    v_mul_u32_u24 v10, 144, v2
    v_add_u32 v10, v10, v7
    s_mul_i32 s41, s26, 2304
    v_add_u32 v9, s41, v10
    v_add_u32 v10, 9216, v10
    v_add_u32 v11, 41472, v9
    v_add_u32 v12, 41472, v10
    v_mov_b32 v16, 0
    v_mov_b32 v17, 0
    v_mov_b32 v18, 0
    v_mov_b32 v19, 0
    v_mov_b32 v20, 0
    v_mov_b32 v21, 0
    v_mov_b32 v22, 0
    v_mov_b32 v23, 0
    v_mov_b32 v24, 0
    v_mov_b32 v25, 0
    v_mov_b32 v26, 0
    v_mov_b32 v27, 0
    v_mov_b32 v28, 0
    v_mov_b32 v29, 0
    v_mov_b32 v30, 0
    v_mov_b32 v31, 0
    v_mov_b32 v32, 0
    v_mov_b32 v33, 0
    v_mov_b32 v34, 0
    v_mov_b32 v35, 0
    v_mov_b32 v36, 0
    v_mov_b32 v37, 0
    v_mov_b32 v38, 0
    v_mov_b32 v39, 0
    v_mov_b32 v40, 0
    v_mov_b32 v41, 0
    v_mov_b32 v42, 0
    v_mov_b32 v43, 0
    v_mov_b32 v44, 0
    v_mov_b32 v45, 0
    v_mov_b32 v46, 0
    v_mov_b32 v47, 0
    v_mov_b32 v48, 0
    v_mov_b32 v49, 0
    v_mov_b32 v50, 0
    v_mov_b32 v51, 0
    v_mov_b32 v52, 0
    v_mov_b32 v53, 0
    v_mov_b32 v54, 0
    v_mov_b32 v55, 0
    v_mov_b32 v56, 0
    v_mov_b32 v57, 0
    v_mov_b32 v58, 0
    v_mov_b32 v59, 0
    v_mov_b32 v60, 0
    v_mov_b32 v61, 0
    v_mov_b32 v62, 0
    v_mov_b32 v63, 0
    v_mov_b32 v64, 0
    v_mov_b32 v65, 0
    v_mov_b32 v66, 0
    v_mov_b32 v67, 0
    v_mov_b32 v68, 0
    v_mov_b32 v69, 0
    v_mov_b32 v70, 0
    v_mov_b32 v71, 0
    buffer_load_dwordx4 v[72:75], v4, s[28:31], s52 offen offset:0
    buffer_load_dwordx4 v[76:79], v4, s[28:31], s53 offen offset:0
    buffer_load_dwordx4 v[80:83], v4, s[32:35], s54 offen offset:0
    buffer_load_dwordx4 v[84:87], v4, s[32:35], s55 offen offset:0
    buffer_load_dwordx4 v[88:91], v4, s[32:35], s56 offen offset:0
    buffer_load_dwordx4 v[92:95], v4, s[32:35], s57 offen offset:0
    buffer_load_dwordx4 v[96:99], v4, s[32:35], s58 offen offset:0
    buffer_load_dwordx4 v[100:103], v4, s[32:35], s59 offen offset:0
    buffer_load_dwordx4 v[104:107], v4, s[32:35], s60 offen offset:0
    buffer_load_dwordx4 v[108:111], v4, s[28:31], s52 offen offset:128
    buffer_load_dwordx4 v[112:115], v4, s[28:31], s53 offen offset:128
    buffer_load_dwordx4 v[116:119], v4, s[32:35], s54 offen offset:128
    buffer_load_dwordx4 v[120:123], v4, s[32:35], s55 offen offset:128
    buffer_load_dwordx4 v[124:127], v4, s[32:35], s56 offen offset:128
    buffer_load_dwordx4 v[128:131], v4, s[32:35], s57 offen offset:128
    buffer_load_dwordx4 v[132:135], v4, s[32:35], s58 offen offset:128
    buffer_load_dwordx4 v[136:139], v4, s[32:35], s59 offen offset:128
    buffer_load_dwordx4 v[140:143], v4, s[32:35], s60 offen offset:128
    s_waitcnt vmcnt(9)
    ds_write_b128 v5, v[72:75] offset:0
    ds_write_b128 v5, v[76:79] offset:4608
    ds_write_b128 v5, v[80:83] offset:9216
    ds_write_b128 v5, v[84:87] offset:13824
    ds_write_b128 v5, v[88:91] offset:18432
    ds_write_b128 v5, v[92:95] offset:23040
    ds_write_b128 v5, v[96:99] offset:27648
    ds_write_b128 v5, v[100:103] offset:32256
    ds_write_b128 v5, v[104:107] offset:36864
    s_waitcnt lgkmcnt(0)
    s_barrier
    s_mov_b32 s62, 0
L_loop_g1b_kernel:
    buffer_load_dwordx4 v[72:75], v4, s[28:31], s52 offen offset:256
    buffer_load_dwordx4 v[76:79], v4, s[28:31], s53 offen offset:256
    buffer_load_dwordx4 v[80:83], v4, s[32:35], s54 offen offset:256
    buffer_load_dwordx4 v[84:87], v4, s[32:35], s55 offen offset:256
    buffer_load_dwordx4 v[88:91], v4, s[32:35], s56 offen offset:256
    buffer_load_dwordx4 v[92:95], v4, s[32:35], s57 offen offset:256
    buffer_load_dwordx4 v[96:99], v4, s[32:35], s58 offen offset:256
    buffer_load_dwordx4 v[100:103], v4, s[32:35], s59 offen offset:256
    buffer_load_dwordx4 v[104:107], v4, s[32:35], s60 offen offset:256
    ds_read_b128 v[144:147], v9 offset:0
    ds_read_b128 v[148:151], v10 offset:0
    ds_read_b128 v[152:155], v10 offset:2304
    ds_read_b128 v[156:159], v10 offset:4608
    ds_read_b128 v[160:163], v10 offset:6912
    ds_read_b128 v[164:167], v10 offset:9216
    ds_read_b128 v[168:171], v10 offset:11520
    ds_read_b128 v[172:175], v10 offset:13824
    ds_read_b128 v[176:179], v10 offset:16128
    ds_read_b128 v[180:183], v10 offset:18432
    ds_read_b128 v[184:187], v10 offset:20736
    ds_read_b128 v[188:191], v10 offset:23040
    ds_read_b128 v[192:195], v10 offset:25344
    ds_read_b128 v[196:199], v10 offset:27648
    ds_read_b128 v[200:203], v10 offset:29952
    s_waitcnt lgkmcnt(13)
    v_mfma_f32_16x16x32_bf16 v[16:19], v[148:151], v[144:147], v[16:19]
    s_waitcnt lgkmcnt(12)
    v_mfma_f32_16x16x32_bf16 v[20:23], v[152:155], v[144:147], v[20:23]
    s_waitcnt lgkmcnt(11)
    v_mfma_f32_16x16x32_bf16 v[24:27], v[156:159], v[144:147], v[24:27]
    s_waitcnt lgkmcnt(10)
    v_mfma_f32_16x16x32_bf16 v[28:31], v[160:163], v[144:147], v[28:31]
    s_waitcnt lgkmcnt(9)
    v_mfma_f32_16x16x32_bf16 v[32:35], v[164:167], v[144:147], v[32:35]
    s_waitcnt lgkmcnt(8)
    v_mfma_f32_16x16x32_bf16 v[36:39], v[168:171], v[144:147], v[36:39]
    s_waitcnt lgkmcnt(7)
    v_mfma_f32_16x16x32_bf16 v[40:43], v[172:175], v[144:147], v[40:43]
    s_waitcnt lgkmcnt(6)
    v_mfma_f32_16x16x32_bf16 v[44:47], v[176:179], v[144:147], v[44:47]
    s_waitcnt lgkmcnt(5)
    v_mfma_f32_16x16x32_bf16 v[48:51], v[180:183], v[144:147], v[48:51]
    s_waitcnt lgkmcnt(4)
    v_mfma_f32_16x16x32_bf16 v[52:55], v[184:187], v[144:147], v[52:55]
    s_waitcnt lgkmcnt(3)
    v_mfma_f32_16x16x32_bf16 v[56:59], v[188:191], v[144:147], v[56:59]
    s_waitcnt lgkmcnt(2)
    v_mfma_f32_16x16x32_bf16 v[60:63], v[192:195], v[144:147], v[60:63]
    s_waitcnt lgkmcnt(1)
    v_mfma_f32_16x16x32_bf16 v[64:67], v[196:199], v[144:147], v[64:67]
    s_waitcnt lgkmcnt(0)
    v_mfma_f32_16x16x32_bf16 v[68:71], v[200:203], v[144:147], v[68:71]
    ds_read_b128 v[144:147], v9 offset:64
    ds_read_b128 v[148:151], v10 offset:64
    ds_read_b128 v[152:155], v10 offset:2368
    ds_read_b128 v[156:159], v10 offset:4672
    ds_read_b128 v[160:163], v10 offset:6976
    ds_read_b128 v[164:167], v10 offset:9280
    ds_read_b128 v[168:171], v10 offset:11584
    ds_read_b128 v[172:175], v10 offset:13888
    ds_read_b128 v[176:179], v10 offset:16192
    ds_read_b128 v[180:183], v10 offset:18496
    ds_read_b128 v[184:187], v10 offset:20800
    ds_read_b128 v[188:191], v10 offset:23104
    ds_read_b128 v[192:195], v10 offset:25408
    ds_read_b128 v[196:199], v10 offset:27712
    ds_read_b128 v[200:203], v10 offset:30016
    s_waitcnt lgkmcnt(13)
    v_mfma_f32_16x16x32_bf16 v[16:19], v[148:151], v[144:147], v[16:19]
    s_waitcnt lgkmcnt(12)
    v_mfma_f32_16x16x32_bf16 v[20:23], v[152:155], v[144:147], v[20:23]
    s_waitcnt lgkmcnt(11)
    v_mfma_f32_16x16x32_bf16 v[24:27], v[156:159], v[144:147], v[24:27]
    s_waitcnt lgkmcnt(10)
    v_mfma_f32_16x16x32_bf16 v[28:31], v[160:163], v[144:147], v[28:31]
    s_waitcnt lgkmcnt(9)
    v_mfma_f32_16x16x32_bf16 v[32:35], v[164:167], v[144:147], v[32:35]
    s_waitcnt lgkmcnt(8)
    v_mfma_f32_16x16x32_bf16 v[36:39], v[168:171], v[144:147], v[36:39]
    s_waitcnt lgkmcnt(7)
    v_mfma_f32_16x16x32_bf16 v[40:43], v[172:175], v[144:147], v[40:43]
    s_waitcnt lgkmcnt(6)
    v_mfma_f32_16x16x32_bf16 v[44:47], v[176:179], v[144:147], v[44:47]
    s_waitcnt lgkmcnt(5)
    v_mfma_f32_16x16x32_bf16 v[48:51], v[180:183], v[144:147], v[48:51]
    s_waitcnt lgkmcnt(4)
    v_mfma_f32_16x16x32_bf16 v[52:55], v[184:187], v[144:147], v[52:55]
    s_waitcnt lgkmcnt(3)
    v_mfma_f32_16x16x32_bf16 v[56:59], v[188:191], v[144:147], v[56:59]
    s_waitcnt lgkmcnt(2)
    v_mfma_f32_16x16x32_bf16 v[60:63], v[192:195], v[144:147], v[60:63]
    s_waitcnt lgkmcnt(1)
    v_mfma_f32_16x16x32_bf16 v[64:67], v[196:199], v[144:147], v[64:67]
    s_waitcnt lgkmcnt(0)
    v_mfma_f32_16x16x32_bf16 v[68:71], v[200:203], v[144:147], v[68:71]
    s_waitcnt vmcnt(9)
    ds_write_b128 v8, v[108:111] offset:0
    ds_write_b128 v8, v[112:115] offset:4608
    ds_write_b128 v8, v[116:119] offset:9216
    ds_write_b128 v8, v[120:123] offset:13824
    ds_write_b128 v8, v[124:127] offset:18432
    ds_write_b128 v8, v[128:131] offset:23040
    ds_write_b128 v8, v[132:135] offset:27648
    ds_write_b128 v8, v[136:139] offset:32256
    ds_write_b128 v8, v[140:143] offset:36864
    s_waitcnt lgkmcnt(0)
    s_barrier
    buffer_load_dwordx4 v[108:111], v4, s[28:31], s52 offen offset:384
    buffer_load_dwordx4 v[112:115], v4, s[28:31], s53 offen offset:384
    buffer_load_dwordx4 v[116:119], v4, s[32:35], s54 offen offset:384
    buffer_load_dwordx4 v[120:123], v4, s[32:35], s55 offen offset:384
    buffer_load_dwordx4 v[124:127], v4, s[32:35], s56 offen offset:384
    buffer_load_dwordx4 v[128:131], v4, s[32:35], s57 offen offset:384
    buffer_load_dwordx4 v[132:135], v4, s[32:35], s58 offen offset:384
    buffer_load_dwordx4 v[136:139], v4, s[32:35], s59 offen offset:384
    buffer_load_dwordx4 v[140:143], v4, s[32:35], s60 offen offset:384
    ds_read_b128 v[144:147], v11 offset:0
    ds_read_b128 v[148:151], v12 offset:0
    ds_read_b128 v[152:155], v12 offset:2304
    ds_read_b128 v[156:159], v12 offset:4608
    ds_read_b128 v[160:163], v12 offset:6912
    ds_read_b128 v[164:167], v12 offset:9216
    ds_read_b128 v[168:171], v12 offset:11520
    ds_read_b128 v[172:175], v12 offset:13824
    ds_read_b128 v[176:179], v12 offset:16128
    ds_read_b128 v[180:183], v12 offset:18432
    ds_read_b128 v[184:187], v12 offset:20736
    ds_read_b128 v[188:191], v12 offset:23040
    ds_read_b128 v[192:195], v12 offset:25344
    ds_read_b128 v[196:199], v12 offset:27648
    ds_read_b128 v[200:203], v12 offset:29952
    s_waitcnt lgkmcnt(13)
    v_mfma_f32_16x16x32_bf16 v[16:19], v[148:151], v[144:147], v[16:19]
    s_waitcnt lgkmcnt(12)
    v_mfma_f32_16x16x32_bf16 v[20:23], v[152:155], v[144:147], v[20:23]
    s_waitcnt lgkmcnt(11)
    v_mfma_f32_16x16x32_bf16 v[24:27], v[156:159], v[144:147], v[24:27]
    s_waitcnt lgkmcnt(10)
    v_mfma_f32_16x16x32_bf16 v[28:31], v[160:163], v[144:147], v[28:31]
    s_waitcnt lgkmcnt(9)
    v_mfma_f32_16x16x32_bf16 v[32:35], v[164:167], v[144:147], v[32:35]
    s_waitcnt lgkmcnt(8)
    v_mfma_f32_16x16x32_bf16 v[36:39], v[168:171], v[144:147], v[36:39]
    s_waitcnt lgkmcnt(7)
    v_mfma_f32_16x16x32_bf16 v[40:43], v[172:175], v[144:147], v[40:43]
    s_waitcnt lgkmcnt(6)
    v_mfma_f32_16x16x32_bf16 v[44:47], v[176:179], v[144:147], v[44:47]
    s_waitcnt lgkmcnt(5)
    v_mfma_f32_16x16x32_bf16 v[48:51], v[180:183], v[144:147], v[48:51]
    s_waitcnt lgkmcnt(4)
    v_mfma_f32_16x16x32_bf16 v[52:55], v[184:187], v[144:147], v[52:55]
    s_waitcnt lgkmcnt(3)
    v_mfma_f32_16x16x32_bf16 v[56:59], v[188:191], v[144:147], v[56:59]
    s_waitcnt lgkmcnt(2)
    v_mfma_f32_16x16x32_bf16 v[60:63], v[192:195], v[144:147], v[60:63]
    s_waitcnt lgkmcnt(1)
    v_mfma_f32_16x16x32_bf16 v[64:67], v[196:199], v[144:147], v[64:67]
    s_waitcnt lgkmcnt(0)
    v_mfma_f32_16x16x32_bf16 v[68:71], v[200:203], v[144:147], v[68:71]
    ds_read_b128 v[144:147], v11 offset:64
    ds_read_b128 v[148:151], v12 offset:64
    ds_read_b128 v[152:155], v12 offset:2368
    ds_read_b128 v[156:159], v12 offset:4672
    ds_read_b128 v[160:163], v12 offset:6976
    ds_read_b128 v[164:167], v12 offset:9280
    ds_read_b128 v[168:171], v12 offset:11584
    ds_read_b128 v[172:175], v12 offset:13888
    ds_read_b128 v[176:179], v12 offset:16192
    ds_read_b128 v[180:183], v12 offset:18496
    ds_read_b128 v[184:187], v12 offset:20800
    ds_read_b128 v[188:191], v12 offset:23104
    ds_read_b128 v[192:195], v12 offset:25408
    ds_read_b128 v[196:199], v12 offset:27712
    ds_read_b128 v[200:203], v12 offset:30016
    s_waitcnt lgkmcnt(13)
    v_mfma_f32_16x16x32_bf16 v[16:19], v[148:151], v[144:147], v[16:19]
    s_waitcnt lgkmcnt(12)
    v_mfma_f32_16x16x32_bf16 v[20:23], v[152:155], v[144:147], v[20:23]
    s_waitcnt lgkmcnt(11)
    v_mfma_f32_16x16x32_bf16 v[24:27], v[156:159], v[144:147], v[24:27]
    s_waitcnt lgkmcnt(10)
    v_mfma_f32_16x16x32_bf16 v[28:31], v[160:163], v[144:147], v[28:31]
    s_waitcnt lgkmcnt(9)
    v_mfma_f32_16x16x32_bf16 v[32:35], v[164:167], v[144:147], v[32:35]
    s_waitcnt lgkmcnt(8)
    v_mfma_f32_16x16x32_bf16 v[36:39], v[168:171], v[144:147], v[36:39]
    s_waitcnt lgkmcnt(7)
    v_mfma_f32_16x16x32_bf16 v[40:43], v[172:175], v[144:147], v[40:43]
    s_waitcnt lgkmcnt(6)
    v_mfma_f32_16x16x32_bf16 v[44:47], v[176:179], v[144:147], v[44:47]
    s_waitcnt lgkmcnt(5)
    v_mfma_f32_16x16x32_bf16 v[48:51], v[180:183], v[144:147], v[48:51]
    s_waitcnt lgkmcnt(4)
    v_mfma_f32_16x16x32_bf16 v[52:55], v[184:187], v[144:147], v[52:55]
    s_waitcnt lgkmcnt(3)
    v_mfma_f32_16x16x32_bf16 v[56:59], v[188:191], v[144:147], v[56:59]
    s_waitcnt lgkmcnt(2)
    v_mfma_f32_16x16x32_bf16 v[60:63], v[192:195], v[144:147], v[60:63]
    s_waitcnt lgkmcnt(1)
    v_mfma_f32_16x16x32_bf16 v[64:67], v[196:199], v[144:147], v[64:67]
    s_waitcnt lgkmcnt(0)
    v_mfma_f32_16x16x32_bf16 v[68:71], v[200:203], v[144:147], v[68:71]
    s_waitcnt vmcnt(9)
    ds_write_b128 v5, v[72:75] offset:0
    ds_write_b128 v5, v[76:79] offset:4608
    ds_write_b128 v5, v[80:83] offset:9216
    ds_write_b128 v5, v[84:87] offset:13824
    ds_write_b128 v5, v[88:91] offset:18432
    ds_write_b128 v5, v[92:95] offset:23040
    ds_write_b128 v5, v[96:99] offset:27648
    ds_write_b128 v5, v[100:103] offset:32256
    ds_write_b128 v5, v[104:107] offset:36864
    s_waitcnt lgkmcnt(0)
    s_barrier
    s_add_u32 s52, s52, 256
    s_add_u32 s53, s53, 256
    s_add_u32 s54, s54, 256
    s_add_u32 s55, s55, 256
    s_add_u32 s56, s56, 256
    s_add_u32 s57, s57, 256
    s_add_u32 s58, s58, 256
    s_add_u32 s59, s59, 256
    s_add_u32 s60, s60, 256
    s_add_u32 s62, s62, 1
    s_cmp_lt_u32 s62, 5
    s_cbranch_scc1 L_loop_g1b_kernel
    s_waitcnt vmcnt(0)
    v_lshlrev_b32 v13, 2, v3
    v_add_u32 v13, s40, v13
    v_lshlrev_b32 v13, 1, v13
    s_lshl_b32 s42, s27, 6
    s_lshl_b32 s41, s26, 4
    s_add_u32 s42, s42, s41
    v_add_u32 v14, s42, v2
    s_mov_b32 s42, 3456
    v_mul_lo_u32 v14, s42, v14
    v_add_u32 v14, v14, v13
    buffer_load_dwordx2 v[72:73], v13, s[44:47], 0 offen offset:0
    buffer_load_dwordx2 v[74:75], v13, s[44:47], 0 offen offset:32
    buffer_load_dwordx2 v[76:77], v13, s[44:47], 0 offen offset:64
    buffer_load_dwordx2 v[78:79], v13, s[44:47], 0 offen offset:96
    buffer_load_dwordx2 v[80:81], v13, s[44:47], 0 offen offset:128
    buffer_load_dwordx2 v[82:83], v13, s[44:47], 0 offen offset:160
    buffer_load_dwordx2 v[84:85], v13, s[44:47], 0 offen offset:192
    buffer_load_dwordx2 v[86:87], v13, s[44:47], 0 offen offset:224
    buffer_load_dwordx2 v[88:89], v13, s[44:47], 0 offen offset:256
    buffer_load_dwordx2 v[90:91], v13, s[44:47], 0 offen offset:288
    buffer_load_dwordx2 v[92:93], v13, s[44:47], 0 offen offset:320
    buffer_load_dwordx2 v[94:95], v13, s[44:47], 0 offen offset:352
    buffer_load_dwordx2 v[96:97], v13, s[44:47], 0 offen offset:384
    buffer_load_dwordx2 v[98:99], v13, s[44:47], 0 offen offset:416
    s_waitcnt vmcnt(0)
    v_cvt_pk_bf16_f32 v16, v16, v16
    v_lshlrev_b32 v16, 16, v16
    v_lshlrev_b32 v15, 16, v72
    v_add_f32 v16, v16, v15
    v_cvt_pk_bf16_f32 v16, v16, v16
    v_lshlrev_b32 v16, 16, v16
    v_mul_f32 v100, v16, v16
    v_mul_f32 v100, 0x3d372713, v100
    v_fma_f32 v100, v100, v16, v16
    v_mul_f32 v100, 0x40135761, v100
    v_exp_f32 v100, v100
    s_nop 0
    v_add_f32 v100, 1.0, v100
    v_rcp_f32 v100, v100
    s_nop 0
    v_sub_f32 v100, 1.0, v100
    v_mul_f32 v16, v16, v100
    v_cvt_pk_bf16_f32 v17, v17, v17
    v_lshlrev_b32 v17, 16, v17
    v_and_b32 v15, 0xffff0000, v72
    v_add_f32 v17, v17, v15
    v_cvt_pk_bf16_f32 v17, v17, v17
    v_lshlrev_b32 v17, 16, v17
    v_mul_f32 v100, v17, v17
    v_mul_f32 v100, 0x3d372713, v100
    v_fma_f32 v100, v100, v17, v17
    v_mul_f32 v100, 0x40135761, v100
    v_exp_f32 v100, v100
    s_nop 0
    v_add_f32 v100, 1.0, v100
    v_rcp_f32 v100, v100
    s_nop 0
    v_sub_f32 v100, 1.0, v100
    v_mul_f32 v17, v17, v100
    v_cvt_pk_bf16_f32 v18, v18, v18
    v_lshlrev_b32 v18, 16, v18
    v_lshlrev_b32 v15, 16, v73
    v_add_f32 v18, v18, v15
    v_cvt_pk_bf16_f32 v18, v18, v18
    v_lshlrev_b32 v18, 16, v18
    v_mul_f32 v100, v18, v18
    v_mul_f32 v100, 0x3d372713, v100
    v_fma_f32 v100, v100, v18, v18
    v_mul_f32 v100, 0x40135761, v100
    v_exp_f32 v100, v100
    s_nop 0
    v_add_f32 v100, 1.0, v100
    v_rcp_f32 v100, v100
    s_nop 0
    v_sub_f32 v100, 1.0, v100
    v_mul_f32 v18, v18, v100
    v_cvt_pk_bf16_f32 v19, v19, v19
    v_lshlrev_b32 v19, 16, v19
    v_and_b32 v15, 0xffff0000, v73
    v_add_f32 v19, v19, v15
    v_cvt_pk_bf16_f32 v19, v19, v19
    v_lshlrev_b32 v19, 16, v19
    v_mul_f32 v100, v19, v19
    v_mul_f32 v100, 0x3d372713, v100
    v_fma_f32 v100, v100, v19, v19
    v_mul_f32 v100, 0x40135761, v100
    v_exp_f32 v100, v100
    s_nop 0
    v_add_f32 v100, 1.0, v100
    v_rcp_f32 v100, v100
    s_nop 0
    v_sub_f32 v100, 1.0, v100
    v_mul_f32 v19, v19, v100
    v_cvt_pk_bf16_f32 v72, v16, v17
    v_cvt_pk_bf16_f32 v73, v18, v19
    buffer_store_dwordx2 v[72:73], v14, s[36:39], 0 offen offset:0
    v_cvt_pk_bf16_f32 v20, v20, v20
    v_lshlrev_b32 v20, 16, v20
    v_lshlrev_b32 v15, 16, v74
    v_add_f32 v20, v20, v15
    v_cvt_pk_bf16_f32 v20, v20, v20
    v_lshlrev_b32 v20, 16, v20
    v_mul_f32 v100, v20, v20
    v_mul_f32 v100, 0x3d372713, v100
    v_fma_f32 v100, v100, v20, v20
    v_mul_f32 v100, 0x40135761, v100
    v_exp_f32 v100, v100
    s_nop 0
    v_add_f32 v100, 1.0, v100
    v_rcp_f32 v100, v100
    s_nop 0
    v_sub_f32 v100, 1.0, v100
    v_mul_f32 v20, v20, v100
    v_cvt_pk_bf16_f32 v21, v21, v21
    v_lshlrev_b32 v21, 16, v21
    v_and_b32 v15, 0xffff0000, v74
    v_add_f32 v21, v21, v15
    v_cvt_pk_bf16_f32 v21, v21, v21
    v_lshlrev_b32 v21, 16, v21
    v_mul_f32 v100, v21, v21
    v_mul_f32 v100, 0x3d372713, v100
    v_fma_f32 v100, v100, v21, v21
    v_mul_f32 v100, 0x40135761, v100
    v_exp_f32 v100, v100
    s_nop 0
    v_add_f32 v100, 1.0, v100
    v_rcp_f32 v100, v100
    s_nop 0
    v_sub_f32 v100, 1.0, v100
    v_mul_f32 v21, v21, v100
    v_cvt_pk_bf16_f32 v22, v22, v22
    v_lshlrev_b32 v22, 16, v22
    v_lshlrev_b32 v15, 16, v75
    v_add_f32 v22, v22, v15
    v_cvt_pk_bf16_f32 v22, v22, v22
    v_lshlrev_b32 v22, 16, v22
    v_mul_f32 v100, v22, v22
    v_mul_f32 v100, 0x3d372713, v100
    v_fma_f32 v100, v100, v22, v22
    v_mul_f32 v100, 0x40135761, v100
    v_exp_f32 v100, v100
    s_nop 0
    v_add_f32 v100, 1.0, v100
    v_rcp_f32 v100, v100
    s_nop 0
    v_sub_f32 v100, 1.0, v100
    v_mul_f32 v22, v22, v100
    v_cvt_pk_bf16_f32 v23, v23, v23
    v_lshlrev_b32 v23, 16, v23
    v_and_b32 v15, 0xffff0000, v75
    v_add_f32 v23, v23, v15
    v_cvt_pk_bf16_f32 v23, v23, v23
    v_lshlrev_b32 v23, 16, v23
    v_mul_f32 v100, v23, v23
    v_mul_f32 v100, 0x3d372713, v100
    v_fma_f32 v100, v100, v23, v23
    v_mul_f32 v100, 0x40135761, v100
    v_exp_f32 v100, v100
    s_nop 0
    v_add_f32 v100, 1.0, v100
    v_rcp_f32 v100, v100
    s_nop 0
    v_sub_f32 v100, 1.0, v100
    v_mul_f32 v23, v23, v100
    v_cvt_pk_bf16_f32 v74, v20, v21
    v_cvt_pk_bf16_f32 v75, v22, v23
    buffer_store_dwordx2 v[74:75], v14, s[36:39], 0 offen offset:32
    v_cvt_pk_bf16_f32 v24, v24, v24
    v_lshlrev_b32 v24, 16, v24
    v_lshlrev_b32 v15, 16, v76
    v_add_f32 v24, v24, v15
    v_cvt_pk_bf16_f32 v24, v24, v24
    v_lshlrev_b32 v24, 16, v24
    v_mul_f32 v100, v24, v24
    v_mul_f32 v100, 0x3d372713, v100
    v_fma_f32 v100, v100, v24, v24
    v_mul_f32 v100, 0x40135761, v100
    v_exp_f32 v100, v100
    s_nop 0
    v_add_f32 v100, 1.0, v100
    v_rcp_f32 v100, v100
    s_nop 0
    v_sub_f32 v100, 1.0, v100
    v_mul_f32 v24, v24, v100
    v_cvt_pk_bf16_f32 v25, v25, v25
    v_lshlrev_b32 v25, 16, v25
    v_and_b32 v15, 0xffff0000, v76
    v_add_f32 v25, v25, v15
    v_cvt_pk_bf16_f32 v25, v25, v25
    v_lshlrev_b32 v25, 16, v25
    v_mul_f32 v100, v25, v25
    v_mul_f32 v100, 0x3d372713, v100
    v_fma_f32 v100, v100, v25, v25
    v_mul_f32 v100, 0x40135761, v100
    v_exp_f32 v100, v100
    s_nop 0
    v_add_f32 v100, 1.0, v100
    v_rcp_f32 v100, v100
    s_nop 0
    v_sub_f32 v100, 1.0, v100
    v_mul_f32 v25, v25, v100
    v_cvt_pk_bf16_f32 v26, v26, v26
    v_lshlrev_b32 v26, 16, v26
    v_lshlrev_b32 v15, 16, v77
    v_add_f32 v26, v26, v15
    v_cvt_pk_bf16_f32 v26, v26, v26
    v_lshlrev_b32 v26, 16, v26
    v_mul_f32 v100, v26, v26
    v_mul_f32 v100, 0x3d372713, v100
    v_fma_f32 v100, v100, v26, v26
    v_mul_f32 v100, 0x40135761, v100
    v_exp_f32 v100, v100
    s_nop 0
    v_add_f32 v100, 1.0, v100
    v_rcp_f32 v100, v100
    s_nop 0
    v_sub_f32 v100, 1.0, v100
    v_mul_f32 v26, v26, v100
    v_cvt_pk_bf16_f32 v27, v27, v27
    v_lshlrev_b32 v27, 16, v27
    v_and_b32 v15, 0xffff0000, v77
    v_add_f32 v27, v27, v15
    v_cvt_pk_bf16_f32 v27, v27, v27
    v_lshlrev_b32 v27, 16, v27
    v_mul_f32 v100, v27, v27
    v_mul_f32 v100, 0x3d372713, v100
    v_fma_f32 v100, v100, v27, v27
    v_mul_f32 v100, 0x40135761, v100
    v_exp_f32 v100, v100
    s_nop 0
    v_add_f32 v100, 1.0, v100
    v_rcp_f32 v100, v100
    s_nop 0
    v_sub_f32 v100, 1.0, v100
    v_mul_f32 v27, v27, v100
    v_cvt_pk_bf16_f32 v76, v24, v25
    v_cvt_pk_bf16_f32 v77, v26, v27
    buffer_store_dwordx2 v[76:77], v14, s[36:39], 0 offen offset:64
    v_cvt_pk_bf16_f32 v28, v28, v28
    v_lshlrev_b32 v28, 16, v28
    v_lshlrev_b32 v15, 16, v78
    v_add_f32 v28, v28, v15
    v_cvt_pk_bf16_f32 v28, v28, v28
    v_lshlrev_b32 v28, 16, v28
    v_mul_f32 v100, v28, v28
    v_mul_f32 v100, 0x3d372713, v100
    v_fma_f32 v100, v100, v28, v28
    v_mul_f32 v100, 0x40135761, v100
    v_exp_f32 v100, v100
    s_nop 0
    v_add_f32 v100, 1.0, v100
    v_rcp_f32 v100, v100
    s_nop 0
    v_sub_f32 v100, 1.0, v100
    v_mul_f32 v28, v28, v100
    v_cvt_pk_bf16_f32 v29, v29, v29
    v_lshlrev_b32 v29, 16, v29
    v_and_b32 v15, 0xffff0000, v78
    v_add_f32 v29, v29, v15
    v_cvt_pk_bf16_f32 v29, v29, v29
    v_lshlrev_b32 v29, 16, v29
    v_mul_f32 v100, v29, v29
    v_mul_f32 v100, 0x3d372713, v100
    v_fma_f32 v100, v100, v29, v29
    v_mul_f32 v100, 0x40135761, v100
    v_exp_f32 v100, v100
    s_nop 0
    v_add_f32 v100, 1.0, v100
    v_rcp_f32 v100, v100
    s_nop 0
    v_sub_f32 v100, 1.0, v100
    v_mul_f32 v29, v29, v100
    v_cvt_pk_bf16_f32 v30, v30, v30
    v_lshlrev_b32 v30, 16, v30
    v_lshlrev_b32 v15, 16, v79
    v_add_f32 v30, v30, v15
    v_cvt_pk_bf16_f32 v30, v30, v30
    v_lshlrev_b32 v30, 16, v30
    v_mul_f32 v100, v30, v30
    v_mul_f32 v100, 0x3d372713, v100
    v_fma_f32 v100, v100, v30, v30
    v_mul_f32 v100, 0x40135761, v100
    v_exp_f32 v100, v100
    s_nop 0
    v_add_f32 v100, 1.0, v100
    v_rcp_f32 v100, v100
    s_nop 0
    v_sub_f32 v100, 1.0, v100
    v_mul_f32 v30, v30, v100
    v_cvt_pk_bf16_f32 v31, v31, v31
    v_lshlrev_b32 v31, 16, v31
    v_and_b32 v15, 0xffff0000, v79
    v_add_f32 v31, v31, v15
    v_cvt_pk_bf16_f32 v31, v31, v31
    v_lshlrev_b32 v31, 16, v31
    v_mul_f32 v100, v31, v31
    v_mul_f32 v100, 0x3d372713, v100
    v_fma_f32 v100, v100, v31, v31
    v_mul_f32 v100, 0x40135761, v100
    v_exp_f32 v100, v100
    s_nop 0
    v_add_f32 v100, 1.0, v100
    v_rcp_f32 v100, v100
    s_nop 0
    v_sub_f32 v100, 1.0, v100
    v_mul_f32 v31, v31, v100
    v_cvt_pk_bf16_f32 v78, v28, v29
    v_cvt_pk_bf16_f32 v79, v30, v31
    buffer_store_dwordx2 v[78:79], v14, s[36:39], 0 offen offset:96
    v_cvt_pk_bf16_f32 v32, v32, v32
    v_lshlrev_b32 v32, 16, v32
    v_lshlrev_b32 v15, 16, v80
    v_add_f32 v32, v32, v15
    v_cvt_pk_bf16_f32 v32, v32, v32
    v_lshlrev_b32 v32, 16, v32
    v_mul_f32 v100, v32, v32
    v_mul_f32 v100, 0x3d372713, v100
    v_fma_f32 v100, v100, v32, v32
    v_mul_f32 v100, 0x40135761, v100
    v_exp_f32 v100, v100
    s_nop 0
    v_add_f32 v100, 1.0, v100
    v_rcp_f32 v100, v100
    s_nop 0
    v_sub_f32 v100, 1.0, v100
    v_mul_f32 v32, v32, v100
    v_cvt_pk_bf16_f32 v33, v33, v33
    v_lshlrev_b32 v33, 16, v33
    v_and_b32 v15, 0xffff0000, v80
    v_add_f32 v33, v33, v15
    v_cvt_pk_bf16_f32 v33, v33, v33
    v_lshlrev_b32 v33, 16, v33
    v_mul_f32 v100, v33, v33
    v_mul_f32 v100, 0x3d372713, v100
    v_fma_f32 v100, v100, v33, v33
    v_mul_f32 v100, 0x40135761, v100
    v_exp_f32 v100, v100
    s_nop 0
    v_add_f32 v100, 1.0, v100
    v_rcp_f32 v100, v100
    s_nop 0
    v_sub_f32 v100, 1.0, v100
    v_mul_f32 v33, v33, v100
    v_cvt_pk_bf16_f32 v34, v34, v34
    v_lshlrev_b32 v34, 16, v34
    v_lshlrev_b32 v15, 16, v81
    v_add_f32 v34, v34, v15
    v_cvt_pk_bf16_f32 v34, v34, v34
    v_lshlrev_b32 v34, 16, v34
    v_mul_f32 v100, v34, v34
    v_mul_f32 v100, 0x3d372713, v100
    v_fma_f32 v100, v100, v34, v34
    v_mul_f32 v100, 0x40135761, v100
    v_exp_f32 v100, v100
    s_nop 0
    v_add_f32 v100, 1.0, v100
    v_rcp_f32 v100, v100
    s_nop 0
    v_sub_f32 v100, 1.0, v100
    v_mul_f32 v34, v34, v100
    v_cvt_pk_bf16_f32 v35, v35, v35
    v_lshlrev_b32 v35, 16, v35
    v_and_b32 v15, 0xffff0000, v81
    v_add_f32 v35, v35, v15
    v_cvt_pk_bf16_f32 v35, v35, v35
    v_lshlrev_b32 v35, 16, v35
    v_mul_f32 v100, v35, v35
    v_mul_f32 v100, 0x3d372713, v100
    v_fma_f32 v100, v100, v35, v35
    v_mul_f32 v100, 0x40135761, v100
    v_exp_f32 v100, v100
    s_nop 0
    v_add_f32 v100, 1.0, v100
    v_rcp_f32 v100, v100
    s_nop 0
    v_sub_f32 v100, 1.0, v100
    v_mul_f32 v35, v35, v100
    v_cvt_pk_bf16_f32 v80, v32, v33
    v_cvt_pk_bf16_f32 v81, v34, v35
    buffer_store_dwordx2 v[80:81], v14, s[36:39], 0 offen offset:128
    v_cvt_pk_bf16_f32 v36, v36, v36
    v_lshlrev_b32 v36, 16, v36
    v_lshlrev_b32 v15, 16, v82
    v_add_f32 v36, v36, v15
    v_cvt_pk_bf16_f32 v36, v36, v36
    v_lshlrev_b32 v36, 16, v36
    v_mul_f32 v100, v36, v36
    v_mul_f32 v100, 0x3d372713, v100
    v_fma_f32 v100, v100, v36, v36
    v_mul_f32 v100, 0x40135761, v100
    v_exp_f32 v100, v100
    s_nop 0
    v_add_f32 v100, 1.0, v100
    v_rcp_f32 v100, v100
    s_nop 0
    v_sub_f32 v100, 1.0, v100
    v_mul_f32 v36, v36, v100
    v_cvt_pk_bf16_f32 v37, v37, v37
    v_lshlrev_b32 v37, 16, v37
    v_and_b32 v15, 0xffff0000, v82
    v_add_f32 v37, v37, v15
    v_cvt_pk_bf16_f32 v37, v37, v37
    v_lshlrev_b32 v37, 16, v37
    v_mul_f32 v100, v37, v37
    v_mul_f32 v100, 0x3d372713, v100
    v_fma_f32 v100, v100, v37, v37
    v_mul_f32 v100, 0x40135761, v100
    v_exp_f32 v100, v100
    s_nop 0
    v_add_f32 v100, 1.0, v100
    v_rcp_f32 v100, v100
    s_nop 0
    v_sub_f32 v100, 1.0, v100
    v_mul_f32 v37, v37, v100
    v_cvt_pk_bf16_f32 v38, v38, v38
    v_lshlrev_b32 v38, 16, v38
    v_lshlrev_b32 v15, 16, v83
    v_add_f32 v38, v38, v15
    v_cvt_pk_bf16_f32 v38, v38, v38
    v_lshlrev_b32 v38, 16, v38
    v_mul_f32 v100, v38, v38
    v_mul_f32 v100, 0x3d372713, v100
    v_fma_f32 v100, v100, v38, v38
    v_mul_f32 v100, 0x40135761, v100
    v_exp_f32 v100, v100
    s_nop 0
    v_add_f32 v100, 1.0, v100
    v_rcp_f32 v100, v100
    s_nop 0
    v_sub_f32 v100, 1.0, v100
    v_mul_f32 v38, v38, v100
    v_cvt_pk_bf16_f32 v39, v39, v39
    v_lshlrev_b32 v39, 16, v39
    v_and_b32 v15, 0xffff0000, v83
    v_add_f32 v39, v39, v15
    v_cvt_pk_bf16_f32 v39, v39, v39
    v_lshlrev_b32 v39, 16, v39
    v_mul_f32 v100, v39, v39
    v_mul_f32 v100, 0x3d372713, v100
    v_fma_f32 v100, v100, v39, v39
    v_mul_f32 v100, 0x40135761, v100
    v_exp_f32 v100, v100
    s_nop 0
    v_add_f32 v100, 1.0, v100
    v_rcp_f32 v100, v100
    s_nop 0
    v_sub_f32 v100, 1.0, v100
    v_mul_f32 v39, v39, v100
    v_cvt_pk_bf16_f32 v82, v36, v37
    v_cvt_pk_bf16_f32 v83, v38, v39
    buffer_store_dwordx2 v[82:83], v14, s[36:39], 0 offen offset:160
    v_cvt_pk_bf16_f32 v40, v40, v40
    v_lshlrev_b32 v40, 16, v40
    v_lshlrev_b32 v15, 16, v84
    v_add_f32 v40, v40, v15
    v_cvt_pk_bf16_f32 v40, v40, v40
    v_lshlrev_b32 v40, 16, v40
    v_mul_f32 v100, v40, v40
    v_mul_f32 v100, 0x3d372713, v100
    v_fma_f32 v100, v100, v40, v40
    v_mul_f32 v100, 0x40135761, v100
    v_exp_f32 v100, v100
    s_nop 0
    v_add_f32 v100, 1.0, v100
    v_rcp_f32 v100, v100
    s_nop 0
    v_sub_f32 v100, 1.0, v100
    v_mul_f32 v40, v40, v100
    v_cvt_pk_bf16_f32 v41, v41, v41
    v_lshlrev_b32 v41, 16, v41
    v_and_b32 v15, 0xffff0000, v84
    v_add_f32 v41, v41, v15
    v_cvt_pk_bf16_f32 v41, v41, v41
    v_lshlrev_b32 v41, 16, v41
    v_mul_f32 v100, v41, v41
    v_mul_f32 v100, 0x3d372713, v100
    v_fma_f32 v100, v100, v41, v41
    v_mul_f32 v100, 0x40135761, v100
    v_exp_f32 v100, v100
    s_nop 0
    v_add_f32 v100, 1.0, v100
    v_rcp_f32 v100, v100
    s_nop 0
    v_sub_f32 v100, 1.0, v100
    v_mul_f32 v41, v41, v100
    v_cvt_pk_bf16_f32 v42, v42, v42
    v_lshlrev_b32 v42, 16, v42
    v_lshlrev_b32 v15, 16, v85
    v_add_f32 v42, v42, v15
    v_cvt_pk_bf16_f32 v42, v42, v42
    v_lshlrev_b32 v42, 16, v42
    v_mul_f32 v100, v42, v42
    v_mul_f32 v100, 0x3d372713, v100
    v_fma_f32 v100, v100, v42, v42
    v_mul_f32 v100, 0x40135761, v100
    v_exp_f32 v100, v100
    s_nop 0
    v_add_f32 v100, 1.0, v100
    v_rcp_f32 v100, v100
    s_nop 0
    v_sub_f32 v100, 1.0, v100
    v_mul_f32 v42, v42, v100
    v_cvt_pk_bf16_f32 v43, v43, v43
    v_lshlrev_b32 v43, 16, v43
    v_and_b32 v15, 0xffff0000, v85
    v_add_f32 v43, v43, v15
    v_cvt_pk_bf16_f32 v43, v43, v43
    v_lshlrev_b32 v43, 16, v43
    v_mul_f32 v100, v43, v43
    v_mul_f32 v100, 0x3d372713, v100
    v_fma_f32 v100, v100, v43, v43
    v_mul_f32 v100, 0x40135761, v100
    v_exp_f32 v100, v100
    s_nop 0
    v_add_f32 v100, 1.0, v100
    v_rcp_f32 v100, v100
    s_nop 0
    v_sub_f32 v100, 1.0, v100
    v_mul_f32 v43, v43, v100
    v_cvt_pk_bf16_f32 v84, v40, v41
    v_cvt_pk_bf16_f32 v85, v42, v43
    buffer_store_dwordx2 v[84:85], v14, s[36:39], 0 offen offset:192
    v_cvt_pk_bf16_f32 v44, v44, v44
    v_lshlrev_b32 v44, 16, v44
    v_lshlrev_b32 v15, 16, v86
    v_add_f32 v44, v44, v15
    v_cvt_pk_bf16_f32 v44, v44, v44
    v_lshlrev_b32 v44, 16, v44
    v_mul_f32 v100, v44, v44
    v_mul_f32 v100, 0x3d372713, v100
    v_fma_f32 v100, v100, v44, v44
    v_mul_f32 v100, 0x40135761, v100
    v_exp_f32 v100, v100
    s_nop 0
    v_add_f32 v100, 1.0, v100
    v_rcp_f32 v100, v100
    s_nop 0
    v_sub_f32 v100, 1.0, v100
    v_mul_f32 v44, v44, v100
    v_cvt_pk_bf16_f32 v45, v45, v45
    v_lshlrev_b32 v45, 16, v45
    v_and_b32 v15, 0xffff0000, v86
    v_add_f32 v45, v45, v15
    v_cvt_pk_bf16_f32 v45, v45, v45
    v_lshlrev_b32 v45, 16, v45
    v_mul_f32 v100, v45, v45
    v_mul_f32 v100, 0x3d372713, v100
    v_fma_f32 v100, v100, v45, v45
    v_mul_f32 v100, 0x40135761, v100
    v_exp_f32 v100, v100
    s_nop 0
    v_add_f32 v100, 1.0, v100
    v_rcp_f32 v100, v100
    s_nop 0
    v_sub_f32 v100, 1.0, v100
    v_mul_f32 v45, v45, v100
    v_cvt_pk_bf16_f32 v46, v46, v46
    v_lshlrev_b32 v46, 16, v46
    v_lshlrev_b32 v15, 16, v87
    v_add_f32 v46, v46, v15
    v_cvt_pk_bf16_f32 v46, v46, v46
    v_lshlrev_b32 v46, 16, v46
    v_mul_f32 v100, v46, v46
    v_mul_f32 v100, 0x3d372713, v100
    v_fma_f32 v100, v100, v46, v46
    v_mul_f32 v100, 0x40135761, v100
    v_exp_f32 v100, v100
    s_nop 0
    v_add_f32 v100, 1.0, v100
    v_rcp_f32 v100, v100
    s_nop 0
    v_sub_f32 v100, 1.0, v100
    v_mul_f32 v46, v46, v100
    v_cvt_pk_bf16_f32 v47, v47, v47
    v_lshlrev_b32 v47, 16, v47
    v_and_b32 v15, 0xffff0000, v87
    v_add_f32 v47, v47, v15
    v_cvt_pk_bf16_f32 v47, v47, v47
    v_lshlrev_b32 v47, 16, v47
    v_mul_f32 v100, v47, v47
    v_mul_f32 v100, 0x3d372713, v100
    v_fma_f32 v100, v100, v47, v47
    v_mul_f32 v100, 0x40135761, v100
    v_exp_f32 v100, v100
    s_nop 0
    v_add_f32 v100, 1.0, v100
    v_rcp_f32 v100, v100
    s_nop 0
    v_sub_f32 v100, 1.0, v100
    v_mul_f32 v47, v47, v100
    v_cvt_pk_bf16_f32 v86, v44, v45
    v_cvt_pk_bf16_f32 v87, v46, v47
    buffer_store_dwordx2 v[86:87], v14, s[36:39], 0 offen offset:224
    v_cvt_pk_bf16_f32 v48, v48, v48
    v_lshlrev_b32 v48, 16, v48
    v_lshlrev_b32 v15, 16, v88
    v_add_f32 v48, v48, v15
    v_cvt_pk_bf16_f32 v48, v48, v48
    v_lshlrev_b32 v48, 16, v48
    v_mul_f32 v100, v48, v48
    v_mul_f32 v100, 0x3d372713, v100
    v_fma_f32 v100, v100, v48, v48
    v_mul_f32 v100, 0x40135761, v100
    v_exp_f32 v100, v100
    s_nop 0
    v_add_f32 v100, 1.0, v100
    v_rcp_f32 v100, v100
    s_nop 0
    v_sub_f32 v100, 1.0, v100
    v_mul_f32 v48, v48, v100
    v_cvt_pk_bf16_f32 v49, v49, v49
    v_lshlrev_b32 v49, 16, v49
    v_and_b32 v15, 0xffff0000, v88
    v_add_f32 v49, v49, v15
    v_cvt_pk_bf16_f32 v49, v49, v49
    v_lshlrev_b32 v49, 16, v49
    v_mul_f32 v100, v49, v49
    v_mul_f32 v100, 0x3d372713, v100
    v_fma_f32 v100, v100, v49, v49
    v_mul_f32 v100, 0x40135761, v100
    v_exp_f32 v100, v100
    s_nop 0
    v_add_f32 v100, 1.0, v100
    v_rcp_f32 v100, v100
    s_nop 0
    v_sub_f32 v100, 1.0, v100
    v_mul_f32 v49, v49, v100
    v_cvt_pk_bf16_f32 v50, v50, v50
    v_lshlrev_b32 v50, 16, v50
    v_lshlrev_b32 v15, 16, v89
    v_add_f32 v50, v50, v15
    v_cvt_pk_bf16_f32 v50, v50, v50
    v_lshlrev_b32 v50, 16, v50
    v_mul_f32 v100, v50, v50
    v_mul_f32 v100, 0x3d372713, v100
    v_fma_f32 v100, v100, v50, v50
    v_mul_f32 v100, 0x40135761, v100
    v_exp_f32 v100, v100
    s_nop 0
    v_add_f32 v100, 1.0, v100
    v_rcp_f32 v100, v100
    s_nop 0
    v_sub_f32 v100, 1.0, v100
    v_mul_f32 v50, v50, v100
    v_cvt_pk_bf16_f32 v51, v51, v51
    v_lshlrev_b32 v51, 16, v51
    v_and_b32 v15, 0xffff0000, v89
    v_add_f32 v51, v51, v15
    v_cvt_pk_bf16_f32 v51, v51, v51
    v_lshlrev_b32 v51, 16, v51
    v_mul_f32 v100, v51, v51
    v_mul_f32 v100, 0x3d372713, v100
    v_fma_f32 v100, v100, v51, v51
    v_mul_f32 v100, 0x40135761, v100
    v_exp_f32 v100, v100
    s_nop 0
    v_add_f32 v100, 1.0, v100
    v_rcp_f32 v100, v100
    s_nop 0
    v_sub_f32 v100, 1.0, v100
    v_mul_f32 v51, v51, v100
    v_cvt_pk_bf16_f32 v88, v48, v49
    v_cvt_pk_bf16_f32 v89, v50, v51
    buffer_store_dwordx2 v[88:89], v14, s[36:39], 0 offen offset:256
    v_cvt_pk_bf16_f32 v52, v52, v52
    v_lshlrev_b32 v52, 16, v52
    v_lshlrev_b32 v15, 16, v90
    v_add_f32 v52, v52, v15
    v_cvt_pk_bf16_f32 v52, v52, v52
    v_lshlrev_b32 v52, 16, v52
    v_mul_f32 v100, v52, v52
    v_mul_f32 v100, 0x3d372713, v100
    v_fma_f32 v100, v100, v52, v52
    v_mul_f32 v100, 0x40135761, v100
    v_exp_f32 v100, v100
    s_nop 0
    v_add_f32 v100, 1.0, v100
    v_rcp_f32 v100, v100
    s_nop 0
    v_sub_f32 v100, 1.0, v100
    v_mul_f32 v52, v52, v100
    v_cvt_pk_bf16_f32 v53, v53, v53
    v_lshlrev_b32 v53, 16, v53
    v_and_b32 v15, 0xffff0000, v90
    v_add_f32 v53, v53, v15
    v_cvt_pk_bf16_f32 v53, v53, v53
    v_lshlrev_b32 v53, 16, v53
    v_mul_f32 v100, v53, v53
    v_mul_f32 v100, 0x3d372713, v100
    v_fma_f32 v100, v100, v53, v53
    v_mul_f32 v100, 0x40135761, v100
    v_exp_f32 v100, v100
    s_nop 0
    v_add_f32 v100, 1.0, v100
    v_rcp_f32 v100, v100
    s_nop 0
    v_sub_f32 v100, 1.0, v100
    v_mul_f32 v53, v53, v100
    v_cvt_pk_bf16_f32 v54, v54, v54
    v_lshlrev_b32 v54, 16, v54
    v_lshlrev_b32 v15, 16, v91
    v_add_f32 v54, v54, v15
    v_cvt_pk_bf16_f32 v54, v54, v54
    v_lshlrev_b32 v54, 16, v54
    v_mul_f32 v100, v54, v54
    v_mul_f32 v100, 0x3d372713, v100
    v_fma_f32 v100, v100, v54, v54
    v_mul_f32 v100, 0x40135761, v100
    v_exp_f32 v100, v100
    s_nop 0
    v_add_f32 v100, 1.0, v100
    v_rcp_f32 v100, v100
    s_nop 0
    v_sub_f32 v100, 1.0, v100
    v_mul_f32 v54, v54, v100
    v_cvt_pk_bf16_f32 v55, v55, v55
    v_lshlrev_b32 v55, 16, v55
    v_and_b32 v15, 0xffff0000, v91
    v_add_f32 v55, v55, v15
    v_cvt_pk_bf16_f32 v55, v55, v55
    v_lshlrev_b32 v55, 16, v55
    v_mul_f32 v100, v55, v55
    v_mul_f32 v100, 0x3d372713, v100
    v_fma_f32 v100, v100, v55, v55
    v_mul_f32 v100, 0x40135761, v100
    v_exp_f32 v100, v100
    s_nop 0
    v_add_f32 v100, 1.0, v100
    v_rcp_f32 v100, v100
    s_nop 0
    v_sub_f32 v100, 1.0, v100
    v_mul_f32 v55, v55, v100
    v_cvt_pk_bf16_f32 v90, v52, v53
    v_cvt_pk_bf16_f32 v91, v54, v55
    buffer_store_dwordx2 v[90:91], v14, s[36:39], 0 offen offset:288
    v_cvt_pk_bf16_f32 v56, v56, v56
    v_lshlrev_b32 v56, 16, v56
    v_lshlrev_b32 v15, 16, v92
    v_add_f32 v56, v56, v15
    v_cvt_pk_bf16_f32 v56, v56, v56
    v_lshlrev_b32 v56, 16, v56
    v_mul_f32 v100, v56, v56
    v_mul_f32 v100, 0x3d372713, v100
    v_fma_f32 v100, v100, v56, v56
    v_mul_f32 v100, 0x40135761, v100
    v_exp_f32 v100, v100
    s_nop 0
    v_add_f32 v100, 1.0, v100
    v_rcp_f32 v100, v100
    s_nop 0
    v_sub_f32 v100, 1.0, v100
    v_mul_f32 v56, v56, v100
    v_cvt_pk_bf16_f32 v57, v57, v57
    v_lshlrev_b32 v57, 16, v57
    v_and_b32 v15, 0xffff0000, v92
    v_add_f32 v57, v57, v15
    v_cvt_pk_bf16_f32 v57, v57, v57
    v_lshlrev_b32 v57, 16, v57
    v_mul_f32 v100, v57, v57
    v_mul_f32 v100, 0x3d372713, v100
    v_fma_f32 v100, v100, v57, v57
    v_mul_f32 v100, 0x40135761, v100
    v_exp_f32 v100, v100
    s_nop 0
    v_add_f32 v100, 1.0, v100
    v_rcp_f32 v100, v100
    s_nop 0
    v_sub_f32 v100, 1.0, v100
    v_mul_f32 v57, v57, v100
    v_cvt_pk_bf16_f32 v58, v58, v58
    v_lshlrev_b32 v58, 16, v58
    v_lshlrev_b32 v15, 16, v93
    v_add_f32 v58, v58, v15
    v_cvt_pk_bf16_f32 v58, v58, v58
    v_lshlrev_b32 v58, 16, v58
    v_mul_f32 v100, v58, v58
    v_mul_f32 v100, 0x3d372713, v100
    v_fma_f32 v100, v100, v58, v58
    v_mul_f32 v100, 0x40135761, v100
    v_exp_f32 v100, v100
    s_nop 0
    v_add_f32 v100, 1.0, v100
    v_rcp_f32 v100, v100
    s_nop 0
    v_sub_f32 v100, 1.0, v100
    v_mul_f32 v58, v58, v100
    v_cvt_pk_bf16_f32 v59, v59, v59
    v_lshlrev_b32 v59, 16, v59
    v_and_b32 v15, 0xffff0000, v93
    v_add_f32 v59, v59, v15
    v_cvt_pk_bf16_f32 v59, v59, v59
    v_lshlrev_b32 v59, 16, v59
    v_mul_f32 v100, v59, v59
    v_mul_f32 v100, 0x3d372713, v100
    v_fma_f32 v100, v100, v59, v59
    v_mul_f32 v100, 0x40135761, v100
    v_exp_f32 v100, v100
    s_nop 0
    v_add_f32 v100, 1.0, v100
    v_rcp_f32 v100, v100
    s_nop 0
    v_sub_f32 v100, 1.0, v100
    v_mul_f32 v59, v59, v100
    v_cvt_pk_bf16_f32 v92, v56, v57
    v_cvt_pk_bf16_f32 v93, v58, v59
    buffer_store_dwordx2 v[92:93], v14, s[36:39], 0 offen offset:320
    v_cvt_pk_bf16_f32 v60, v60, v60
    v_lshlrev_b32 v60, 16, v60
    v_lshlrev_b32 v15, 16, v94
    v_add_f32 v60, v60, v15
    v_cvt_pk_bf16_f32 v60, v60, v60
    v_lshlrev_b32 v60, 16, v60
    v_mul_f32 v100, v60, v60
    v_mul_f32 v100, 0x3d372713, v100
    v_fma_f32 v100, v100, v60, v60
    v_mul_f32 v100, 0x40135761, v100
    v_exp_f32 v100, v100
    s_nop 0
    v_add_f32 v100, 1.0, v100
    v_rcp_f32 v100, v100
    s_nop 0
    v_sub_f32 v100, 1.0, v100
    v_mul_f32 v60, v60, v100
    v_cvt_pk_bf16_f32 v61, v61, v61
    v_lshlrev_b32 v61, 16, v61
    v_and_b32 v15, 0xffff0000, v94
    v_add_f32 v61, v61, v15
    v_cvt_pk_bf16_f32 v61, v61, v61
    v_lshlrev_b32 v61, 16, v61
    v_mul_f32 v100, v61, v61
    v_mul_f32 v100, 0x3d372713, v100
    v_fma_f32 v100, v100, v61, v61
    v_mul_f32 v100, 0x40135761, v100
    v_exp_f32 v100, v100
    s_nop 0
    v_add_f32 v100, 1.0, v100
    v_rcp_f32 v100, v100
    s_nop 0
    v_sub_f32 v100, 1.0, v100
    v_mul_f32 v61, v61, v100
    v_cvt_pk_bf16_f32 v62, v62, v62
    v_lshlrev_b32 v62, 16, v62
    v_lshlrev_b32 v15, 16, v95
    v_add_f32 v62, v62, v15
    v_cvt_pk_bf16_f32 v62, v62, v62
    v_lshlrev_b32 v62, 16, v62
    v_mul_f32 v100, v62, v62
    v_mul_f32 v100, 0x3d372713, v100
    v_fma_f32 v100, v100, v62, v62
    v_mul_f32 v100, 0x40135761, v100
    v_exp_f32 v100, v100
    s_nop 0
    v_add_f32 v100, 1.0, v100
    v_rcp_f32 v100, v100
    s_nop 0
    v_sub_f32 v100, 1.0, v100
    v_mul_f32 v62, v62, v100
    v_cvt_pk_bf16_f32 v63, v63, v63
    v_lshlrev_b32 v63, 16, v63
    v_and_b32 v15, 0xffff0000, v95
    v_add_f32 v63, v63, v15
    v_cvt_pk_bf16_f32 v63, v63, v63
    v_lshlrev_b32 v63, 16, v63
    v_mul_f32 v100, v63, v63
    v_mul_f32 v100, 0x3d372713, v100
    v_fma_f32 v100, v100, v63, v63
    v_mul_f32 v100, 0x40135761, v100
    v_exp_f32 v100, v100
    s_nop 0
    v_add_f32 v100, 1.0, v100
    v_rcp_f32 v100, v100
    s_nop 0
    v_sub_f32 v100, 1.0, v100
    v_mul_f32 v63, v63, v100
    v_cvt_pk_bf16_f32 v94, v60, v61
    v_cvt_pk_bf16_f32 v95, v62, v63
    buffer_store_dwordx2 v[94:95], v14, s[36:39], 0 offen offset:352
    v_cvt_pk_bf16_f32 v64, v64, v64
    v_lshlrev_b32 v64, 16, v64
    v_lshlrev_b32 v15, 16, v96
    v_add_f32 v64, v64, v15
    v_cvt_pk_bf16_f32 v64, v64, v64
    v_lshlrev_b32 v64, 16, v64
    v_mul_f32 v100, v64, v64
    v_mul_f32 v100, 0x3d372713, v100
    v_fma_f32 v100, v100, v64, v64
    v_mul_f32 v100, 0x40135761, v100
    v_exp_f32 v100, v100
    s_nop 0
    v_add_f32 v100, 1.0, v100
    v_rcp_f32 v100, v100
    s_nop 0
    v_sub_f32 v100, 1.0, v100
    v_mul_f32 v64, v64, v100
    v_cvt_pk_bf16_f32 v65, v65, v65
    v_lshlrev_b32 v65, 16, v65
    v_and_b32 v15, 0xffff0000, v96
    v_add_f32 v65, v65, v15
    v_cvt_pk_bf16_f32 v65, v65, v65
    v_lshlrev_b32 v65, 16, v65
    v_mul_f32 v100, v65, v65
    v_mul_f32 v100, 0x3d372713, v100
    v_fma_f32 v100, v100, v65, v65
    v_mul_f32 v100, 0x40135761, v100
    v_exp_f32 v100, v100
    s_nop 0
    v_add_f32 v100, 1.0, v100
    v_rcp_f32 v100, v100
    s_nop 0
    v_sub_f32 v100, 1.0, v100
    v_mul_f32 v65, v65, v100
    v_cvt_pk_bf16_f32 v66, v66, v66
    v_lshlrev_b32 v66, 16, v66
    v_lshlrev_b32 v15, 16, v97
    v_add_f32 v66, v66, v15
    v_cvt_pk_bf16_f32 v66, v66, v66
    v_lshlrev_b32 v66, 16, v66
    v_mul_f32 v100, v66, v66
    v_mul_f32 v100, 0x3d372713, v100
    v_fma_f32 v100, v100, v66, v66
    v_mul_f32 v100, 0x40135761, v100
    v_exp_f32 v100, v100
    s_nop 0
    v_add_f32 v100, 1.0, v100
    v_rcp_f32 v100, v100
    s_nop 0
    v_sub_f32 v100, 1.0, v100
    v_mul_f32 v66, v66, v100
    v_cvt_pk_bf16_f32 v67, v67, v67
    v_lshlrev_b32 v67, 16, v67
    v_and_b32 v15, 0xffff0000, v97
    v_add_f32 v67, v67, v15
    v_cvt_pk_bf16_f32 v67, v67, v67
    v_lshlrev_b32 v67, 16, v67
    v_mul_f32 v100, v67, v67
    v_mul_f32 v100, 0x3d372713, v100
    v_fma_f32 v100, v100, v67, v67
    v_mul_f32 v100, 0x40135761, v100
    v_exp_f32 v100, v100
    s_nop 0
    v_add_f32 v100, 1.0, v100
    v_rcp_f32 v100, v100
    s_nop 0
    v_sub_f32 v100, 1.0, v100
    v_mul_f32 v67, v67, v100
    v_cvt_pk_bf16_f32 v96, v64, v65
    v_cvt_pk_bf16_f32 v97, v66, v67
    buffer_store_dwordx2 v[96:97], v14, s[36:39], 0 offen offset:384
    v_cvt_pk_bf16_f32 v68, v68, v68
    v_lshlrev_b32 v68, 16, v68
    v_lshlrev_b32 v15, 16, v98
    v_add_f32 v68, v68, v15
    v_cvt_pk_bf16_f32 v68, v68, v68
    v_lshlrev_b32 v68, 16, v68
    v_mul_f32 v100, v68, v68
    v_mul_f32 v100, 0x3d372713, v100
    v_fma_f32 v100, v100, v68, v68
    v_mul_f32 v100, 0x40135761, v100
    v_exp_f32 v100, v100
    s_nop 0
    v_add_f32 v100, 1.0, v100
    v_rcp_f32 v100, v100
    s_nop 0
    v_sub_f32 v100, 1.0, v100
    v_mul_f32 v68, v68, v100
    v_cvt_pk_bf16_f32 v69, v69, v69
    v_lshlrev_b32 v69, 16, v69
    v_and_b32 v15, 0xffff0000, v98
    v_add_f32 v69, v69, v15
    v_cvt_pk_bf16_f32 v69, v69, v69
    v_lshlrev_b32 v69, 16, v69
    v_mul_f32 v100, v69, v69
    v_mul_f32 v100, 0x3d372713, v100
    v_fma_f32 v100, v100, v69, v69
    v_mul_f32 v100, 0x40135761, v100
    v_exp_f32 v100, v100
    s_nop 0
    v_add_f32 v100, 1.0, v100
    v_rcp_f32 v100, v100
    s_nop 0
    v_sub_f32 v100, 1.0, v100
    v_mul_f32 v69, v69, v100
    v_cvt_pk_bf16_f32 v70, v70, v70
    v_lshlrev_b32 v70, 16, v70
    v_lshlrev_b32 v15, 16, v99
    v_add_f32 v70, v70, v15
    v_cvt_pk_bf16_f32 v70, v70, v70
    v_lshlrev_b32 v70, 16, v70
    v_mul_f32 v100, v70, v70
    v_mul_f32 v100, 0x3d372713, v100
    v_fma_f32 v100, v100, v70, v70
    v_mul_f32 v100, 0x40135761, v100
    v_exp_f32 v100, v100
    s_nop 0
    v_add_f32 v100, 1.0, v100
    v_rcp_f32 v100, v100
    s_nop 0
    v_sub_f32 v100, 1.0, v100
    v_mul_f32 v70, v70, v100
    v_cvt_pk_bf16_f32 v71, v71, v71
    v_lshlrev_b32 v71, 16, v71
    v_and_b32 v15, 0xffff0000, v99
    v_add_f32 v71, v71, v15
    v_cvt_pk_bf16_f32 v71, v71, v71
    v_lshlrev_b32 v71, 16, v71
    v_mul_f32 v100, v71, v71
    v_mul_f32 v100, 0x3d372713, v100
    v_fma_f32 v100, v100, v71, v71
    v_mul_f32 v100, 0x40135761, v100
    v_exp_f32 v100, v100
    s_nop 0
    v_add_f32 v100, 1.0, v100
    v_rcp_f32 v100, v100
    s_nop 0
    v_sub_f32 v100, 1.0, v100
    v_mul_f32 v71, v71, v100
    v_cvt_pk_bf16_f32 v98, v68, v69
    v_cvt_pk_bf16_f32 v99, v70, v71
    buffer_store_dwordx2 v[98:99], v14, s[36:39], 0 offen offset:416
L_end_g1b_kernel:
    s_endpgm
.globl g2b_kernel
.p2align 8
.type g2b_kernel,@function
g2b_kernel:
    s_cmp_ge_u32 s2, 256
    s_cbranch_scc1 L_end_g2b_kernel
    s_load_dwordx16 s[4:19], s[0:1], 0
    s_load_dwordx4 s[20:23], s[0:1], 64
    s_load_dwordx2 s[24:25], s[0:1], 80
    s_waitcnt lgkmcnt(0)
    s_add_u32 s28, s24, 0x1500000
    s_addc_u32 s29, s25, 0
    s_mov_b32 s30, 0x6c0000
    s_mov_b32 s31, 0x00020000
    s_add_u32 s32, s24, 0xc00000
    s_addc_u32 s33, s25, 0
    s_mov_b32 s34, 0x21c000
    s_mov_b32 s35, 0x00020000
    s_add_u32 s44, s18, 0x0
    s_addc_u32 s45, s19, 0
    s_mov_b32 s46, 0x500
    s_mov_b32 s47, 0x00020000
    s_add_u32 s48, s24, 0x1f00000
    s_addc_u32 s49, s25, 0
    s_mov_b32 s50, 0x280000
    s_mov_b32 s51, 0x00020000
    s_add_u32 s36, s20, 0x0
    s_addc_u32 s37, s21, 0
    s_mov_b32 s38, 0x280000
    s_mov_b32 s39, 0x00020000
    v_and_b32 v1, 63, v0
    v_lshrrev_b32 v2, 6, v0
    s_nop 1
    v_readfirstlane_b32 s26, v2
    s_nop 3
    s_and_b32 s27, s2, 31
    s_lshr_b32 s40, s2, 5
    v_and_b32 v2, 15, v1
    v_lshrrev_b32 v3, 4, v1
    v_lshrrev_b32 v6, 3, v0
    v_and_b32 v7, 7, v0
    v_lshlrev_b32 v7, 4, v7
    v_mul_u32_u24 v4, 3456, v6
    v_add_u32 v4, v4, v7
    v_mul_u32_u24 v5, 144, v6
    v_add_u32 v5, v5, v7
    s_mul_i32 s52, s27, 221184
    s_add_u32 s53, s52, 110592
    s_mul_i32 s54, s40, 276480
    s_add_u32 s55, s54, 110592
    s_add_u32 s56, s54, 221184
    v_add_u32 v8, 20736, v5
    v_lshlrev_b32 v7, 4, v3
    v_mul_u32_u24 v10, 144, v2
    v_add_u32 v10, v10, v7
    s_mul_i32 s41, s26, 2304
    v_add_u32 v9, s41, v10
    v_add_u32 v10, 9216, v10
    v_add_u32 v11, 20736, v9
    v_add_u32 v12, 20736, v10
    v_mov_b32 v16, 0
    v_mov_b32 v17, 0
    v_mov_b32 v18, 0
    v_mov_b32 v19, 0
    v_mov_b32 v20, 0
    v_mov_b32 v21, 0
    v_mov_b32 v22, 0
    v_mov_b32 v23, 0
    v_mov_b32 v24, 0
    v_mov_b32 v25, 0
    v_mov_b32 v26, 0
    v_mov_b32 v27, 0
    v_mov_b32 v28, 0
    v_mov_b32 v29, 0
    v_mov_b32 v30, 0
    v_mov_b32 v31, 0
    v_mov_b32 v32, 0
    v_mov_b32 v33, 0
    v_mov_b32 v34, 0
    v_mov_b32 v35, 0
    s_mul_i32 s43, s40, 80
    v_lshlrev_b32 v14, 2, v3
    v_add_u32 v14, s43, v14
    v_lshlrev_b32 v14, 1, v14
    s_lshl_b32 s43, s27, 6
    s_lshl_b32 s41, s26, 4
    s_add_u32 s43, s43, s41
    v_add_u32 v13, s43, v2
    v_mul_u32_u24 v13, 1280, v13
    v_add_u32 v13, v13, v14
    buffer_load_dwordx2 v[204:205], v14, s[44:47], 0 offen offset:0
    buffer_load_dwordx2 v[214:215], v13, s[48:51], 0 offen offset:0
    buffer_load_dwordx2 v[206:207], v14, s[44:47], 0 offen offset:32
    buffer_load_dwordx2 v[216:217], v13, s[48:51], 0 offen offset:32
    buffer_load_dwordx2 v[208:209], v14, s[44:47], 0 offen offset:64
    buffer_load_dwordx2 v[218:219], v13, s[48:51], 0 offen offset:64
    buffer_load_dwordx2 v[210:211], v14, s[44:47], 0 offen offset:96
    buffer_load_dwordx2 v[220:221], v13, s[48:51], 0 offen offset:96
    buffer_load_dwordx2 v[212:213], v14, s[44:47], 0 offen offset:128
    buffer_load_dwordx2 v[222:223], v13, s[48:51], 0 offen offset:128
    buffer_load_dwordx4 v[36:39], v4, s[28:31], s52 offen offset:0
    buffer_load_dwordx4 v[40:43], v4, s[28:31], s53 offen offset:0
    buffer_load_dwordx4 v[44:47], v4, s[32:35], s54 offen offset:0
    buffer_load_dwordx4 v[48:51], v4, s[32:35], s55 offen offset:0
    buffer_load_dwordx4 v[52:55], v4, s[32:35], s56 offen offset:0
    buffer_load_dwordx4 v[96:99], v4, s[28:31], s52 offen offset:128
    buffer_load_dwordx4 v[100:103], v4, s[28:31], s53 offen offset:128
    buffer_load_dwordx4 v[104:107], v4, s[32:35], s54 offen offset:128
    buffer_load_dwordx4 v[108:111], v4, s[32:35], s55 offen offset:128
    buffer_load_dwordx4 v[112:115], v4, s[32:35], s56 offen offset:128
    s_waitcnt vmcnt(5)
    ds_write_b128 v5, v[36:39] offset:0
    ds_write_b128 v5, v[40:43] offset:4608
    ds_write_b128 v5, v[44:47] offset:9216
    ds_write_b128 v5, v[48:51] offset:13824
    s_cmp_ge_u32 s26, 2
    s_cbranch_scc1 L_112_g2b_kernel
    ds_write_b128 v5, v[52:55] offset:18432
L_112_g2b_kernel:
    s_waitcnt lgkmcnt(0)
    s_barrier
    s_mov_b32 s62, 0
L_loop_g2b_kernel:
    buffer_load_dwordx4 v[36:39], v4, s[28:31], s52 offen offset:256
    buffer_load_dwordx4 v[40:43], v4, s[28:31], s53 offen offset:256
    buffer_load_dwordx4 v[44:47], v4, s[32:35], s54 offen offset:256
    buffer_load_dwordx4 v[48:51], v4, s[32:35], s55 offen offset:256
    buffer_load_dwordx4 v[52:55], v4, s[32:35], s56 offen offset:256
    ds_read_b128 v[156:159], v9 offset:0
    ds_read_b128 v[160:163], v10 offset:0
    ds_read_b128 v[164:167], v10 offset:2304
    ds_read_b128 v[168:171], v10 offset:4608
    ds_read_b128 v[172:175], v10 offset:6912
    ds_read_b128 v[176:179], v10 offset:9216
    ds_read_b128 v[180:183], v9 offset:64
    ds_read_b128 v[184:187], v10 offset:64
    ds_read_b128 v[188:191], v10 offset:2368
    ds_read_b128 v[192:195], v10 offset:4672
    ds_read_b128 v[196:199], v10 offset:6976
    ds_read_b128 v[200:203], v10 offset:9280
    s_waitcnt lgkmcnt(6)
    v_mfma_f32_16x16x32_bf16 v[16:19], v[160:163], v[156:159], v[16:19]
    v_mfma_f32_16x16x32_bf16 v[20:23], v[164:167], v[156:159], v[20:23]
    v_mfma_f32_16x16x32_bf16 v[24:27], v[168:171], v[156:159], v[24:27]
    v_mfma_f32_16x16x32_bf16 v[28:31], v[172:175], v[156:159], v[28:31]
    v_mfma_f32_16x16x32_bf16 v[32:35], v[176:179], v[156:159], v[32:35]
    s_waitcnt lgkmcnt(0)
    v_mfma_f32_16x16x32_bf16 v[16:19], v[184:187], v[180:183], v[16:19]
    v_mfma_f32_16x16x32_bf16 v[20:23], v[188:191], v[180:183], v[20:23]
    v_mfma_f32_16x16x32_bf16 v[24:27], v[192:195], v[180:183], v[24:27]
    v_mfma_f32_16x16x32_bf16 v[28:31], v[196:199], v[180:183], v[28:31]
    v_mfma_f32_16x16x32_bf16 v[32:35], v[200:203], v[180:183], v[32:35]
    s_waitcnt vmcnt(5)
    ds_write_b128 v8, v[96:99] offset:0
    ds_write_b128 v8, v[100:103] offset:4608
    ds_write_b128 v8, v[104:107] offset:9216
    ds_write_b128 v8, v[108:111] offset:13824
    s_cmp_ge_u32 s26, 2
    s_cbranch_scc1 L_154_g2b_kernel
    ds_write_b128 v8, v[112:115] offset:18432
L_154_g2b_kernel:
    s_waitcnt lgkmcnt(0)
    s_barrier
    buffer_load_dwordx4 v[96:99], v4, s[28:31], s52 offen offset:384
    buffer_load_dwordx4 v[100:103], v4, s[28:31], s53 offen offset:384
    buffer_load_dwordx4 v[104:107], v4, s[32:35], s54 offen offset:384
    buffer_load_dwordx4 v[108:111], v4, s[32:35], s55 offen offset:384
    buffer_load_dwordx4 v[112:115], v4, s[32:35], s56 offen offset:384
    ds_read_b128 v[156:159], v11 offset:0
    ds_read_b128 v[160:163], v12 offset:0
    ds_read_b128 v[164:167], v12 offset:2304
    ds_read_b128 v[168:171], v12 offset:4608
    ds_read_b128 v[172:175], v12 offset:6912
    ds_read_b128 v[176:179], v12 offset:9216
    ds_read_b128 v[180:183], v11 offset:64
    ds_read_b128 v[184:187], v12 offset:64
    ds_read_b128 v[188:191], v12 offset:2368
    ds_read_b128 v[192:195], v12 offset:4672
    ds_read_b128 v[196:199], v12 offset:6976
    ds_read_b128 v[200:203], v12 offset:9280
    s_waitcnt lgkmcnt(6)
    v_mfma_f32_16x16x32_bf16 v[16:19], v[160:163], v[156:159], v[16:19]
    v_mfma_f32_16x16x32_bf16 v[20:23], v[164:167], v[156:159], v[20:23]
    v_mfma_f32_16x16x32_bf16 v[24:27], v[168:171], v[156:159], v[24:27]
    v_mfma_f32_16x16x32_bf16 v[28:31], v[172:175], v[156:159], v[28:31]
    v_mfma_f32_16x16x32_bf16 v[32:35], v[176:179], v[156:159], v[32:35]
    s_waitcnt lgkmcnt(0)
    v_mfma_f32_16x16x32_bf16 v[16:19], v[184:187], v[180:183], v[16:19]
    v_mfma_f32_16x16x32_bf16 v[20:23], v[188:191], v[180:183], v[20:23]
    v_mfma_f32_16x16x32_bf16 v[24:27], v[192:195], v[180:183], v[24:27]
    v_mfma_f32_16x16x32_bf16 v[28:31], v[196:199], v[180:183], v[28:31]
    v_mfma_f32_16x16x32_bf16 v[32:35], v[200:203], v[180:183], v[32:35]
    s_waitcnt vmcnt(5)
    ds_write_b128 v5, v[36:39] offset:0
    ds_write_b128 v5, v[40:43] offset:4608
    ds_write_b128 v5, v[44:47] offset:9216
    ds_write_b128 v5, v[48:51] offset:13824
    s_cmp_ge_u32 s26, 2
    s_cbranch_scc1 L_194_g2b_kernel
    ds_write_b128 v5, v[52:55] offset:18432
L_194_g2b_kernel:
    s_waitcnt lgkmcnt(0)
    s_barrier
    s_add_u32 s52, s52, 256
    s_add_u32 s53, s53, 256
    s_add_u32 s54, s54, 256
    s_add_u32 s55, s55, 256
    s_add_u32 s56, s56, 256
    s_add_u32 s62, s62, 1
    s_cmp_lt_u32 s62, 13
    s_cbranch_scc1 L_loop_g2b_kernel
    ds_read_b128 v[156:159], v9 offset:0
    ds_read_b128 v[160:163], v10 offset:0
    ds_read_b128 v[164:167], v10 offset:2304
    ds_read_b128 v[168:171], v10 offset:4608
    ds_read_b128 v[172:175], v10 offset:6912
    ds_read_b128 v[176:179], v10 offset:9216
    ds_read_b128 v[180:183], v9 offset:64
    ds_read_b128 v[184:187], v10 offset:64
    ds_read_b128 v[188:191], v10 offset:2368
    ds_read_b128 v[192:195], v10 offset:4672
    ds_read_b128 v[196:199], v10 offset:6976
    ds_read_b128 v[200:203], v10 offset:9280
    s_waitcnt lgkmcnt(6)
    v_mfma_f32_16x16x32_bf16 v[16:19], v[160:163], v[156:159], v[16:19]
    v_mfma_f32_16x16x32_bf16 v[20:23], v[164:167], v[156:159], v[20:23]
    v_mfma_f32_16x16x32_bf16 v[24:27], v[168:171], v[156:159], v[24:27]
    v_mfma_f32_16x16x32_bf16 v[28:31], v[172:175], v[156:159], v[28:31]
    v_mfma_f32_16x16x32_bf16 v[32:35], v[176:179], v[156:159], v[32:35]
    s_waitcnt lgkmcnt(0)
    v_mfma_f32_16x16x32_bf16 v[16:19], v[184:187], v[180:183], v[16:19]
    v_mfma_f32_16x16x32_bf16 v[20:23], v[188:191], v[180:183], v[20:23]
    v_mfma_f32_16x16x32_bf16 v[24:27], v[192:195], v[180:183], v[24:27]
    v_mfma_f32_16x16x32_bf16 v[28:31], v[196:199], v[180:183], v[28:31]
    v_mfma_f32_16x16x32_bf16 v[32:35], v[200:203], v[180:183], v[32:35]
    s_waitcnt vmcnt(0)
    s_nop 7
    s_nop 3
    v_cvt_pk_bf16_f32 v16, v16, v16
    v_lshlrev_b32 v16, 16, v16
    v_lshlrev_b32 v14, 16, v204
    v_add_f32 v16, v16, v14
    v_cvt_pk_bf16_f32 v16, v16, v16
    v_lshlrev_b32 v16, 16, v16
    v_lshlrev_b32 v14, 16, v214
    v_add_f32 v16, v16, v14
    v_cvt_pk_bf16_f32 v17, v17, v17
    v_lshlrev_b32 v17, 16, v17
    v_and_b32 v14, 0xffff0000, v204
    v_add_f32 v17, v17, v14
    v_cvt_pk_bf16_f32 v17, v17, v17
    v_lshlrev_b32 v17, 16, v17
    v_and_b32 v14, 0xffff0000, v214
    v_add_f32 v17, v17, v14
    v_cvt_pk_bf16_f32 v18, v18, v18
    v_lshlrev_b32 v18, 16, v18
    v_lshlrev_b32 v14, 16, v205
    v_add_f32 v18, v18, v14
    v_cvt_pk_bf16_f32 v18, v18, v18
    v_lshlrev_b32 v18, 16, v18
    v_lshlrev_b32 v14, 16, v215
    v_add_f32 v18, v18, v14
    v_cvt_pk_bf16_f32 v19, v19, v19
    v_lshlrev_b32 v19, 16, v19
    v_and_b32 v14, 0xffff0000, v205
    v_add_f32 v19, v19, v14
    v_cvt_pk_bf16_f32 v19, v19, v19
    v_lshlrev_b32 v19, 16, v19
    v_and_b32 v14, 0xffff0000, v215
    v_add_f32 v19, v19, v14
    v_cvt_pk_bf16_f32 v204, v16, v17
    v_cvt_pk_bf16_f32 v205, v18, v19
    buffer_store_dwordx2 v[204:205], v13, s[36:39], 0 offen offset:0
    v_cvt_pk_bf16_f32 v20, v20, v20
    v_lshlrev_b32 v20, 16, v20
    v_lshlrev_b32 v14, 16, v206
    v_add_f32 v20, v20, v14
    v_cvt_pk_bf16_f32 v20, v20, v20
    v_lshlrev_b32 v20, 16, v20
    v_lshlrev_b32 v14, 16, v216
    v_add_f32 v20, v20, v14
    v_cvt_pk_bf16_f32 v21, v21, v21
    v_lshlrev_b32 v21, 16, v21
    v_and_b32 v14, 0xffff0000, v206
    v_add_f32 v21, v21, v14
    v_cvt_pk_bf16_f32 v21, v21, v21
    v_lshlrev_b32 v21, 16, v21
    v_and_b32 v14, 0xffff0000, v216
    v_add_f32 v21, v21, v14
    v_cvt_pk_bf16_f32 v22, v22, v22
    v_lshlrev_b32 v22, 16, v22
    v_lshlrev_b32 v14, 16, v207
    v_add_f32 v22, v22, v14
    v_cvt_pk_bf16_f32 v22, v22, v22
    v_lshlrev_b32 v22, 16, v22
    v_lshlrev_b32 v14, 16, v217
    v_add_f32 v22, v22, v14
    v_cvt_pk_bf16_f32 v23, v23, v23
    v_lshlrev_b32 v23, 16, v23
    v_and_b32 v14, 0xffff0000, v207
    v_add_f32 v23, v23, v14
    v_cvt_pk_bf16_f32 v23, v23, v23
    v_lshlrev_b32 v23, 16, v23
    v_and_b32 v14, 0xffff0000, v217
    v_add_f32 v23, v23, v14
    v_cvt_pk_bf16_f32 v206, v20, v21
    v_cvt_pk_bf16_f32 v207, v22, v23
    buffer_store_dwordx2 v[206:207], v13, s[36:39], 0 offen offset:32
    v_cvt_pk_bf16_f32 v24, v24, v24
    v_lshlrev_b32 v24, 16, v24
    v_lshlrev_b32 v14, 16, v208
    v_add_f32 v24, v24, v14
    v_cvt_pk_bf16_f32 v24, v24, v24
    v_lshlrev_b32 v24, 16, v24
    v_lshlrev_b32 v14, 16, v218
    v_add_f32 v24, v24, v14
    v_cvt_pk_bf16_f32 v25, v25, v25
    v_lshlrev_b32 v25, 16, v25
    v_and_b32 v14, 0xffff0000, v208
    v_add_f32 v25, v25, v14
    v_cvt_pk_bf16_f32 v25, v25, v25
    v_lshlrev_b32 v25, 16, v25
    v_and_b32 v14, 0xffff0000, v218
    v_add_f32 v25, v25, v14
    v_cvt_pk_bf16_f32 v26, v26, v26
    v_lshlrev_b32 v26, 16, v26
    v_lshlrev_b32 v14, 16, v209
    v_add_f32 v26, v26, v14
    v_cvt_pk_bf16_f32 v26, v26, v26
    v_lshlrev_b32 v26, 16, v26
    v_lshlrev_b32 v14, 16, v219
    v_add_f32 v26, v26, v14
    v_cvt_pk_bf16_f32 v27, v27, v27
    v_lshlrev_b32 v27, 16, v27
    v_and_b32 v14, 0xffff0000, v209
    v_add_f32 v27, v27, v14
    v_cvt_pk_bf16_f32 v27, v27, v27
    v_lshlrev_b32 v27, 16, v27
    v_and_b32 v14, 0xffff0000, v219
    v_add_f32 v27, v27, v14
    v_cvt_pk_bf16_f32 v208, v24, v25
    v_cvt_pk_bf16_f32 v209, v26, v27
    buffer_store_dwordx2 v[208:209], v13, s[36:39], 0 offen offset:64
    v_cvt_pk_bf16_f32 v28, v28, v28
    v_lshlrev_b32 v28, 16, v28
    v_lshlrev_b32 v14, 16, v210
    v_add_f32 v28, v28, v14
    v_cvt_pk_bf16_f32 v28, v28, v28
    v_lshlrev_b32 v28, 16, v28
    v_lshlrev_b32 v14, 16, v220
    v_add_f32 v28, v28, v14
    v_cvt_pk_bf16_f32 v29, v29, v29
    v_lshlrev_b32 v29, 16, v29
    v_and_b32 v14, 0xffff0000, v210
    v_add_f32 v29, v29, v14
    v_cvt_pk_bf16_f32 v29, v29, v29
    v_lshlrev_b32 v29, 16, v29
    v_and_b32 v14, 0xffff0000, v220
    v_add_f32 v29, v29, v14
    v_cvt_pk_bf16_f32 v30, v30, v30
    v_lshlrev_b32 v30, 16, v30
    v_lshlrev_b32 v14, 16, v211
    v_add_f32 v30, v30, v14
    v_cvt_pk_bf16_f32 v30, v30, v30
    v_lshlrev_b32 v30, 16, v30
    v_lshlrev_b32 v14, 16, v221
    v_add_f32 v30, v30, v14
    v_cvt_pk_bf16_f32 v31, v31, v31
    v_lshlrev_b32 v31, 16, v31
    v_and_b32 v14, 0xffff0000, v211
    v_add_f32 v31, v31, v14
    v_cvt_pk_bf16_f32 v31, v31, v31
    v_lshlrev_b32 v31, 16, v31
    v_and_b32 v14, 0xffff0000, v221
    v_add_f32 v31, v31, v14
    v_cvt_pk_bf16_f32 v210, v28, v29
    v_cvt_pk_bf16_f32 v211, v30, v31
    buffer_store_dwordx2 v[210:211], v13, s[36:39], 0 offen offset:96
    v_cvt_pk_bf16_f32 v32, v32, v32
    v_lshlrev_b32 v32, 16, v32
    v_lshlrev_b32 v14, 16, v212
    v_add_f32 v32, v32, v14
    v_cvt_pk_bf16_f32 v32, v32, v32
    v_lshlrev_b32 v32, 16, v32
    v_lshlrev_b32 v14, 16, v222
    v_add_f32 v32, v32, v14
    v_cvt_pk_bf16_f32 v33, v33, v33
    v_lshlrev_b32 v33, 16, v33
    v_and_b32 v14, 0xffff0000, v212
    v_add_f32 v33, v33, v14
    v_cvt_pk_bf16_f32 v33, v33, v33
    v_lshlrev_b32 v33, 16, v33
    v_and_b32 v14, 0xffff0000, v222
    v_add_f32 v33, v33, v14
    v_cvt_pk_bf16_f32 v34, v34, v34
    v_lshlrev_b32 v34, 16, v34
    v_lshlrev_b32 v14, 16, v213
    v_add_f32 v34, v34, v14
    v_cvt_pk_bf16_f32 v34, v34, v34
    v_lshlrev_b32 v34, 16, v34
    v_lshlrev_b32 v14, 16, v223
    v_add_f32 v34, v34, v14
    v_cvt_pk_bf16_f32 v35, v35, v35
    v_lshlrev_b32 v35, 16, v35
    v_and_b32 v14, 0xffff0000, v213
    v_add_f32 v35, v35, v14
    v_cvt_pk_bf16_f32 v35, v35, v35
    v_lshlrev_b32 v35, 16, v35
    v_and_b32 v14, 0xffff0000, v223
    v_add_f32 v35, v35, v14
    v_cvt_pk_bf16_f32 v212, v32, v33
    v_cvt_pk_bf16_f32 v213, v34, v35
    buffer_store_dwordx2 v[212:213], v13, s[36:39], 0 offen offset:128
L_end_g2b_kernel:
    s_endpgm
.section .rodata,"a"
.p2align 6
.amdhsa_kernel rf1_kernel
  .amdhsa_next_free_vgpr 40
  .amdhsa_next_free_sgpr 102
  .amdhsa_accum_offset 40
  .amdhsa_group_segment_fixed_size 0
  .amdhsa_kernarg_size 88
  .amdhsa_user_sgpr_count 2
  .amdhsa_user_sgpr_kernarg_segment_ptr 1
  .amdhsa_system_sgpr_workgroup_id_x 1
.end_amdhsa_kernel
.p2align 6
.amdhsa_kernel col1_kernel
  .amdhsa_next_free_vgpr 48
  .amdhsa_next_free_sgpr 102
  .amdhsa_accum_offset 48
  .amdhsa_group_segment_fixed_size 0
  .amdhsa_kernarg_size 88
  .amdhsa_user_sgpr_count 2
  .amdhsa_user_sgpr_kernarg_segment_ptr 1
  .amdhsa_system_sgpr_workgroup_id_x 1
.end_amdhsa_kernel
.p2align 6
.amdhsa_kernel ri1_kernel
  .amdhsa_next_free_vgpr 48
  .amdhsa_next_free_sgpr 102
  .amdhsa_accum_offset 48
  .amdhsa_group_segment_fixed_size 0
  .amdhsa_kernarg_size 88
  .amdhsa_user_sgpr_count 2
  .amdhsa_user_sgpr_kernarg_segment_ptr 1
  .amdhsa_system_sgpr_workgroup_id_x 1
.end_amdhsa_kernel
.p2align 6
.amdhsa_kernel g1a_kernel
  .amdhsa_next_free_vgpr 208
  .amdhsa_next_free_sgpr 102
  .amdhsa_accum_offset 208
  .amdhsa_group_segment_fixed_size 0
  .amdhsa_kernarg_size 88
  .amdhsa_user_sgpr_count 2
  .amdhsa_user_sgpr_kernarg_segment_ptr 1
  .amdhsa_system_sgpr_workgroup_id_x 1
.end_amdhsa_kernel
.p2align 6
.amdhsa_kernel g2a_kernel
  .amdhsa_next_free_vgpr 224
  .amdhsa_next_free_sgpr 102
  .amdhsa_accum_offset 224
  .amdhsa_group_segment_fixed_size 0
  .amdhsa_kernarg_size 88
  .amdhsa_user_sgpr_count 2
  .amdhsa_user_sgpr_kernarg_segment_ptr 1
  .amdhsa_system_sgpr_workgroup_id_x 1
.end_amdhsa_kernel
.p2align 6
.amdhsa_kernel rf2_kernel
  .amdhsa_next_free_vgpr 40
  .amdhsa_next_free_sgpr 102
  .amdhsa_accum_offset 40
  .amdhsa_group_segment_fixed_size 0
  .amdhsa_kernarg_size 88
  .amdhsa_user_sgpr_count 2
  .amdhsa_user_sgpr_kernarg_segment_ptr 1
  .amdhsa_system_sgpr_workgroup_id_x 1
.end_amdhsa_kernel
.p2align 6
.amdhsa_kernel col2_kernel
  .amdhsa_next_free_vgpr 48
  .amdhsa_next_free_sgpr 102
  .amdhsa_accum_offset 48
  .amdhsa_group_segment_fixed_size 0
  .amdhsa_kernarg_size 88
  .amdhsa_user_sgpr_count 2
  .amdhsa_user_sgpr_kernarg_segment_ptr 1
  .amdhsa_system_sgpr_workgroup_id_x 1
.end_amdhsa_kernel
.p2align 6
.amdhsa_kernel ri2_kernel
  .amdhsa_next_free_vgpr 48
  .amdhsa_next_free_sgpr 102
  .amdhsa_accum_offset 48
  .amdhsa_group_segment_fixed_size 0
  .amdhsa_kernarg_size 88
  .amdhsa_user_sgpr_count 2
  .amdhsa_user_sgpr_kernarg_segment_ptr 1
  .amdhsa_system_sgpr_workgroup_id_x 1
.end_amdhsa_kernel
.p2align 6
.amdhsa_kernel g1b_kernel
  .amdhsa_next_free_vgpr 208
  .amdhsa_next_free_sgpr 102
  .amdhsa_accum_offset 208
  .amdhsa_group_segment_fixed_size 0
  .amdhsa_kernarg_size 88
  .amdhsa_user_sgpr_count 2
  .amdhsa_user_sgpr_kernarg_segment_ptr 1
  .amdhsa_system_sgpr_workgroup_id_x 1
.end_amdhsa_kernel
.p2align 6
.amdhsa_kernel g2b_kernel
  .amdhsa_next_free_vgpr 224
  .amdhsa_next_free_sgpr 102
  .amdhsa_accum_offset 224
  .amdhsa_group_segment_fixed_size 0
  .amdhsa_kernarg_size 88
  .amdhsa_user_sgpr_count 2
  .amdhsa_user_sgpr_kernarg_segment_ptr 1
  .amdhsa_system_sgpr_workgroup_id_x 1
.end_amdhsa_kernel
```
